```python
import torch

def _softmax(x, axis=-1):
    return torch.softmax(x, dim=axis)

def _gelu(x):
    return torch.nn.functional.gelu(x, approximate='tanh')

def _silu(x):
    return torch.nn.functional.silu(x)

def _sigmoid(x):
    return torch.sigmoid(x)

def _layernorm(x, axis=-1, eps=1e-05):
    m = x.mean(dim=axis, keepdim=True)
    v = x.var(dim=axis, keepdim=True, unbiased=False)
    return (x - m) / torch.sqrt(v + eps)

def _scatter_add(tgt, idx, src, axis=0):
    return tgt.clone().index_add_(axis, idx, src)

def _segment_sum(src, seg, n):
    out = torch.zeros((n,) + src.shape[1:], dtype=src.dtype)
    return out.index_add_(0, seg, src)

def _pad(x, pw):
    flat = tuple((v for pair in reversed(pw) for v in pair))
    return torch.nn.functional.pad(x, flat)
kernel_name = 'adaLN_cond__memory_aug_recurrent_mem_tr__swiglu_ffn__prompt'

def setup_inputs():

    _w = lambda a: (lambda t: t.to(torch.bfloat16) if t.is_floating_point() else t)(torch.as_tensor(a))

    def _A_setup():
        B, S, Dm = (1, 2048, 640)
        H, Dh = (32, 128)
        M, seg = (8, 32)
        seg = min(seg, S)
        S = S // seg * seg
        return {'x': _w((lambda *s: torch.randn(*s, dtype=torch.bfloat16) * 0.05)(B, S, Dm)), 'mem0': _w((lambda *s: torch.randn(*s, dtype=torch.bfloat16) * 0.4)(B, M, Dm)), 'Wq': _w((lambda *s: torch.randn(*s, dtype=torch.bfloat16) * 3.2)(Dm, H, Dh) * Dm ** (-0.5)), 'Wk': _w((lambda *s: torch.randn(*s, dtype=torch.bfloat16) * 3.2)(Dm, H, Dh) * Dm ** (-0.5)), 'Wv': _w((lambda *s: torch.randn(*s, dtype=torch.bfloat16) * 0.4)(Dm, H, Dh) * Dm ** (-0.5)), 'Wo': _w((lambda *s: torch.randn(*s, dtype=torch.bfloat16) * 0.4)(H, Dh, Dm) * (H * Dh) ** (-0.5)), 'seg_len': seg}
    _A_in = _A_setup()

    def _B_setup():
        B, S, D, F = (1, 2048, 640, 1728)
        return {'x': _w((lambda *s: torch.randn(*s, dtype=torch.bfloat16) * 0.05)(B, S, D)), 'w_gate': _w((lambda *s: torch.randn(*s, dtype=torch.bfloat16) * 0.05)(D, F)), 'w_up': _w((lambda *s: torch.randn(*s, dtype=torch.bfloat16) * 0.05)(D, F)), 'w_down': _w((lambda *s: torch.randn(*s, dtype=torch.bfloat16) * 0.05)(F, D))}
    _B_in = _B_setup()
    return {'A_x': _A_in['x'], 'A_mem0': _A_in['mem0'], 'A_Wq': _A_in['Wq'], 'A_Wk': _A_in['Wk'], 'A_Wv': _A_in['Wv'], 'A_Wo': _A_in['Wo'], 'A_seg_len': _A_in['seg_len'], 'B_x': _B_in['x'], 'B_w_gate': _B_in['w_gate'], 'B_w_up': _B_in['w_up'], 'B_w_down': _B_in['w_down'], 'c': _w((lambda *s: torch.randn(*s, dtype=torch.bfloat16) * 0.1)(1, 640) * 8.0), 'w_mod': _w((lambda *s: torch.randn(*s, dtype=torch.bfloat16) * 0.1)(640, 6 * 640) * 640 ** (-0.5) * 8.0)}

def reference(A_x, A_mem0, A_Wq, A_Wk, A_Wv, A_Wo, A_seg_len, B_x, B_w_gate, B_w_up, B_w_down, c, w_mod):

    def _A_ref(x, mem0, Wq, Wk, Wv, Wo, seg_len):
        B, S, Dm = x.shape
        H, Dh = (Wq.shape[1], Wq.shape[2])
        M = mem0.shape[1]
        scale = Dh ** (-0.5)
        n_seg = S // seg_len
        L = M + seg_len
        idx = torch.arange(L)
        mask = (idx[:, None] < M) | (idx[:, None] >= idx[None, :])
        mem = mem0
        outs = []
        for s in range(n_seg):
            xs = x[:, s * seg_len:(s + 1) * seg_len, :].clone()
            h = torch.concatenate([mem, xs], axis=1)
            q = torch.einsum('btd,dhe->bhte', h, Wq)
            k = torch.einsum('btd,dhe->bhte', h, Wk)
            v = torch.einsum('btd,dhe->bhte', h, Wv)
            scores = torch.einsum('bhqe,bhke->bhqk', q, k) * scale
            scores = torch.where(mask[None, None], scores, -1000000000.0)
            p = _softmax(scores, axis=-1)
            o = torch.einsum('bhqk,bhke->bhqe', p, v)
            o = torch.einsum('bhte,hed->btd', o, Wo)
            mem = o[:, :M, :].clone()
            outs.append(o[:, M:, :])
        return torch.concatenate(outs, axis=1)

    def _B_ref(x, w_gate, w_up, w_down):
        g = _silu(x @ w_gate)
        u = x @ w_up
        return g * u @ w_down
    x = A_x
    mod = (_silu(c) @ w_mod).reshape(c.shape[0], 6, 1, -1)
    sa, ca, ga, sb, cb, gb = (mod[:, 0].clone(), mod[:, 1].clone(), mod[:, 2].clone(), mod[:, 3].clone(), mod[:, 4].clone(), mod[:, 5].clone())
    h = _layernorm(x, axis=-1) * (1 + ca) + sa
    x = x + ga * _A_ref(h, A_mem0, A_Wq, A_Wk, A_Wv, A_Wo, A_seg_len)
    h = _layernorm(x, axis=-1) * (1 + cb) + sb
    x = x + gb * _B_ref(h, B_w_gate, B_w_up, B_w_down)
    return x
```

```asm
; @launch grid=(256,1,1) block=(256,1,1) lds=131072
.amdgcn_target "amdgcn-amd-amdhsa--gfx950"
.text
.globl adaLN_cond__memory_aug_recurrent_mem_tr__swiglu_ffn__prompt_kernel
.p2align 8
.type adaLN_cond__memory_aug_recurrent_mem_tr__swiglu_ffn__prompt_kernel,@function
adaLN_cond__memory_aug_recurrent_mem_tr__swiglu_ffn__prompt_kernel:
    s_cmp_ge_u32 s2, 256
    s_cbranch_scc1 r_end
    s_load_dwordx2 s[4:5], s[0:1], 120
    s_load_dwordx2 s[6:7], s[0:1], 112
    s_load_dwordx4 s[32:35], s[0:1], 16
    s_load_dwordx2 s[36:37], s[0:1], 0
    v_lshrrev_b32 v1, 6, v0
    v_and_b32 v2, 63, v0
    s_waitcnt lgkmcnt(0)

    s_mov_b32 s8, s4
    s_and_b32 s9, s5, 0xffff
    s_mov_b32 s10, 0x10000000
    s_mov_b32 s11, 0x00020000
    s_mov_b32 s12, s6
    s_and_b32 s13, s7, 0xffff
    s_mov_b32 s14, 0x100
    s_mov_b32 s15, 0x00020000
    s_mov_b32 s16, s32
    s_and_b32 s17, s33, 0xffff
    s_mov_b32 s18, 0x500000
    s_mov_b32 s19, 0x00020000
    s_mov_b32 s20, s34
    s_and_b32 s21, s35, 0xffff
    s_mov_b32 s22, 0x500000
    s_mov_b32 s23, 0x00020000
    s_mov_b32 s24, s36
    s_and_b32 s25, s37, 0xffff
    s_mov_b32 s26, 0x280000
    s_mov_b32 s27, 0x00020000
    v_readfirstlane_b32 s3, v1
    v_lshlrev_b32 v5, 4, v2
    v_add_u32 v6, 4096, v5
    v_add_u32 v7, 8192, v5
    v_mov_b32 v4, 0x4444
    v_mov_b32 v10, 0xeeee
    v_and_b32 v11, 8, v2
    v_cmp_ne_u32 vcc, 0, v11
    s_mov_b32 s30, 200000
    v_mov_b32 v9, 0x1f000
    v_cndmask_b32 v4, v4, v10, vcc
    s_cmp_lg_u32 s3, 0
    s_cbranch_scc1 r_warm
    s_getreg_b32 s40, hwreg(HW_REG_XCC_ID)
    s_and_b32 s40, s40, 7
    s_mov_b64 exec, 1
    s_lshl_b32 s43, s40, 2
    s_lshr_b32 s43, 0x76540321, s43
    s_and_b32 s43, s43, 7
    s_mov_b32 s48, 0

r_try:
    s_lshr_b32 s45, s43, 1
    s_lshl_b32 s45, s45, 2
    s_and_b32 s44, s43, 1
    s_lshl_b32 s44, s44, 7
    s_add_u32 s45, s45, s44
    v_mov_b32 v10, 1
    buffer_atomic_add v10, off, s[12:15], s45 sc0
    s_waitcnt vmcnt(0)
    v_readfirstlane_b32 s41, v10
    s_nop 3
    s_cmp_lt_u32 s41, 32
    s_cbranch_scc1 r_got
    s_add_u32 s48, s48, 1
    s_sub_u32 s43, s48, 1
    s_mov_b32 s42, 999
    s_cmp_ge_u32 s43, 8
    s_cbranch_scc1 r_role_done
    s_branch r_try

r_got:
    s_lshl_b32 s42, s43, 5
    s_add_u32 s42, s42, s41
    s_cmp_lt_u32 s43, 2
    s_cbranch_scc1 r_role_done
    s_cmp_ge_u32 s43, 4
    s_cbranch_scc1 r_got4
    s_sub_u32 s43, s43, 2
    s_mul_i32 s44, s43, 10
    s_add_u32 s42, s41, s44
    s_add_u32 s42, s42, 239
    s_cmp_lt_u32 s41, 10
    s_cbranch_scc1 r_role_done
    s_mul_i32 s44, s43, 20
    s_add_u32 s42, s41, s44
    s_add_u32 s42, s42, 54
    s_cmp_lt_u32 s41, 30
    s_cbranch_scc1 r_role_done
    s_lshl_b32 s44, s43, 1
    s_add_u32 s42, s41, s44
    s_add_u32 s42, s42, 174
    s_branch r_role_done

r_got4:
    s_sub_u32 s43, s43, 4
    s_lshl_b32 s44, s43, 3
    s_add_u32 s42, s41, s44
    s_add_u32 s42, s42, 112
    s_cmp_lt_u32 s41, 8
    s_cbranch_scc1 r_role_done
    s_add_u32 s42, s42, 24
    s_cmp_lt_u32 s41, 16
    s_cbranch_scc1 r_role_done
    s_add_u32 s42, s43, 208
    s_cmp_eq_u32 s41, 23
    s_cbranch_scc1 r_role_done
    s_lshl_b32 s44, s43, 1
    s_add_u32 s42, s41, s44
    s_add_u32 s42, s42, 160
    s_cmp_lt_u32 s41, 18
    s_cbranch_scc1 r_role_done
    s_mul_i32 s44, s43, 5
    s_add_u32 s42, s41, s44
    s_add_u32 s42, s42, 166
    s_cmp_lt_u32 s41, 23
    s_cbranch_scc1 r_role_done
    s_mul_i32 s44, s43, 7
    s_add_u32 s42, s41, s44
    s_add_u32 s42, s42, 188
    s_cmp_eq_u32 s42, 239
    s_cselect_b32 s42, 264, s42
    s_add_u32 s44, s43, 260
    s_cmp_eq_u32 s41, 31
    s_cselect_b32 s42, s44, s42

r_role_done:
    v_mov_b32 v10, s42
    ds_write_b32 v9, v10
    s_mov_b64 exec, -1
    s_waitcnt lgkmcnt(0)

    s_branch r_role_wait
r_warm:
r_role_wait:
    s_barrier
    ds_read_b32 v10, v9
    s_waitcnt lgkmcnt(0)
    v_readfirstlane_b32 s28, v10
    s_mov_b32 s29, 0
    s_mov_b32 s50, 0x3db504f3
    s_mov_b32 s51, 0x3fb8aa3b
    s_mov_b32 s62, s50
    s_mov_b32 s63, s50
    s_mov_b32 s100, 0
    s_mul_i32 s97, s28, 2304
    s_add_u32 s97, s97, 0xf000000
    s_barrier

    s_cmp_lt_u32 s28, 32
    s_cbranch_scc1 role_p
    s_cmp_lt_u32 s28, 64
    s_cbranch_scc1 role_vm
    s_cmp_lt_u32 s28, 112
    s_cbranch_scc1 boot
    s_cmp_lt_u32 s28, 144
    s_cbranch_scc1 role_t
    s_cmp_lt_u32 s28, 176
    s_cbranch_scc1 role_vo
    s_cmp_ge_u32 s28, 265
    s_cbranch_scc1 r_end
    s_branch boot
boot_done:
    s_cmp_lt_u32 s28, 112
    s_cbranch_scc1 role_u

    s_cmp_lt_u32 s28, 184
    s_cbranch_scc1 role_al
    s_cmp_lt_u32 s28, 204
    s_cbranch_scc1 role_c
    s_cmp_lt_u32 s28, 212
    s_cbranch_scc1 role_al
    s_cmp_lt_u32 s28, 259
    s_cbranch_scc1 role_f
    s_sub_u32 s28, s28, 56
    s_cmp_lt_u32 s28, 209
    s_cbranch_scc1 role_c
    s_endpgm

role_p:
    v_lshrrev_b32 v10, 4, v2
    v_and_b32 v11, 15, v2
    v_and_b32 v12, 1, v10
    s_lshl_b32 s40, s3, 1
    v_or_b32 v12, s40, v12
    v_lshlrev_b32 v12, 1, v12
    v_xor_b32 v11, v11, v12
    v_lshlrev_b32 v11, 4, v11
    s_lshl_b32 s40, s3, 2
    v_add_u32 v12, s40, v10
    v_lshl_add_u32 v11, v12, 13, v11
    s_lshl_b32 s41, s28, 8
    s_lshl_b32 s42, s3, 10
    v_bfe_u32 v12, v2, 2, 2
    v_and_b32 v13, 3, v2
    v_lshrrev_b32 v14, 1, v10
    v_lshlrev_b32 v14, 4, v14
    v_and_b32 v15, 1, v10
    v_lshl_add_u32 v14, v15, 2, v14
    v_and_b32 v16, 1, v12
    v_add_u32 v14, v14, v16
    v_lshrrev_b32 v17, 1, v12
    v_lshl_add_u32 v14, v17, 3, v14
    v_lshlrev_b32 v14, 8, v14
    v_lshl_add_u32 v14, v13, 3, v14
    v_lshl_or_b32 v16, v15, 1, v16
    v_lshl_or_b32 v16, v17, 2, v16
    v_lshl_or_b32 v14, v16, 5, v14
    s_lshl_b32 s40, s3, 6
    v_xor_b32 v18, s40, v14
    v_xor_b32 v19, 32, v18
    v_add_u32 v20, 0x10000, v18
    v_add_u32 v21, 0x10000, v19

    s_add_u32 s43, s42, 0
    s_mov_b32 m0, s43
    s_add_u32 s44, s41, 0
    buffer_load_dwordx4 v11, s[16:19], s44 offen lds

    s_add_u32 s43, s42, 4096
    s_mov_b32 m0, s43
    s_add_u32 s44, s41, 131072
    buffer_load_dwordx4 v11, s[16:19], s44 offen lds

    s_add_u32 s43, s42, 8192
    s_mov_b32 m0, s43
    s_add_u32 s44, s41, 262144
    buffer_load_dwordx4 v11, s[16:19], s44 offen lds

    s_add_u32 s43, s42, 12288
    s_mov_b32 m0, s43
    s_add_u32 s44, s41, 393216
    buffer_load_dwordx4 v11, s[16:19], s44 offen lds

    s_add_u32 s43, s42, 16384
    s_mov_b32 m0, s43
    s_add_u32 s44, s41, 0
    buffer_load_dwordx4 v11, s[20:23], s44 offen lds

    s_add_u32 s43, s42, 20480
    s_mov_b32 m0, s43
    s_add_u32 s44, s41, 131072
    buffer_load_dwordx4 v11, s[20:23], s44 offen lds

    s_add_u32 s43, s42, 24576
    s_mov_b32 m0, s43
    s_add_u32 s44, s41, 262144
    buffer_load_dwordx4 v11, s[20:23], s44 offen lds

    s_add_u32 s43, s42, 28672
    s_mov_b32 m0, s43
    s_add_u32 s44, s41, 393216
    buffer_load_dwordx4 v11, s[20:23], s44 offen lds

    s_add_u32 s43, s42, 32768
    s_mov_b32 m0, s43
    s_add_u32 s44, s41, 524288
    buffer_load_dwordx4 v11, s[16:19], s44 offen lds

    s_add_u32 s43, s42, 36864
    s_mov_b32 m0, s43
    s_add_u32 s44, s41, 655360
    buffer_load_dwordx4 v11, s[16:19], s44 offen lds

    s_add_u32 s43, s42, 40960
    s_mov_b32 m0, s43
    s_add_u32 s44, s41, 786432
    buffer_load_dwordx4 v11, s[16:19], s44 offen lds

    s_add_u32 s43, s42, 45056
    s_mov_b32 m0, s43
    s_add_u32 s44, s41, 917504
    buffer_load_dwordx4 v11, s[16:19], s44 offen lds

    s_add_u32 s43, s42, 49152
    s_mov_b32 m0, s43
    s_add_u32 s44, s41, 524288
    buffer_load_dwordx4 v11, s[20:23], s44 offen lds

    s_add_u32 s43, s42, 53248
    s_mov_b32 m0, s43
    s_add_u32 s44, s41, 655360
    buffer_load_dwordx4 v11, s[20:23], s44 offen lds

    s_add_u32 s43, s42, 57344
    s_mov_b32 m0, s43
    s_add_u32 s44, s41, 786432
    buffer_load_dwordx4 v11, s[20:23], s44 offen lds

    s_add_u32 s43, s42, 61440
    s_mov_b32 m0, s43
    s_add_u32 s44, s41, 917504
    buffer_load_dwordx4 v11, s[20:23], s44 offen lds

    s_waitcnt vmcnt(8)
    s_barrier
    s_add_u32 s43, s42, 65536
    s_mov_b32 m0, s43
    s_add_u32 s44, s41, 1048576
    buffer_load_dwordx4 v11, s[16:19], s44 offen lds

    s_add_u32 s43, s42, 69632
    s_mov_b32 m0, s43
    s_add_u32 s44, s41, 1179648
    buffer_load_dwordx4 v11, s[16:19], s44 offen lds

    s_add_u32 s43, s42, 73728
    s_mov_b32 m0, s43
    s_add_u32 s44, s41, 1310720
    buffer_load_dwordx4 v11, s[16:19], s44 offen lds

    s_add_u32 s43, s42, 77824
    s_mov_b32 m0, s43
    s_add_u32 s44, s41, 1441792
    buffer_load_dwordx4 v11, s[16:19], s44 offen lds

    s_add_u32 s43, s42, 81920
    s_mov_b32 m0, s43
    s_add_u32 s44, s41, 1048576
    buffer_load_dwordx4 v11, s[20:23], s44 offen lds

    s_add_u32 s43, s42, 86016
    s_mov_b32 m0, s43
    s_add_u32 s44, s41, 1179648
    buffer_load_dwordx4 v11, s[20:23], s44 offen lds

    s_add_u32 s43, s42, 90112
    s_mov_b32 m0, s43
    s_add_u32 s44, s41, 1310720
    buffer_load_dwordx4 v11, s[20:23], s44 offen lds

    s_add_u32 s43, s42, 94208
    s_mov_b32 m0, s43
    s_add_u32 s44, s41, 1441792
    buffer_load_dwordx4 v11, s[20:23], s44 offen lds

    ds_read_b64_tr_b16 a[0:1], v18 offset:0
    ds_read_b64_tr_b16 a[2:3], v18 offset:512
    ds_read_b64_tr_b16 a[4:5], v18 offset:8192
    ds_read_b64_tr_b16 a[6:7], v18 offset:8704
    ds_read_b64_tr_b16 a[80:81], v19 offset:0
    ds_read_b64_tr_b16 a[82:83], v19 offset:512
    ds_read_b64_tr_b16 a[84:85], v19 offset:8192
    ds_read_b64_tr_b16 a[86:87], v19 offset:8704
    s_waitcnt lgkmcnt(0)
    ds_read_b64_tr_b16 a[160:161], v18 offset:16384
    ds_read_b64_tr_b16 a[162:163], v18 offset:16896
    ds_read_b64_tr_b16 a[164:165], v18 offset:24576
    ds_read_b64_tr_b16 a[166:167], v18 offset:25088
    ds_read_b64_tr_b16 a[240:241], v19 offset:16384
    ds_read_b64_tr_b16 a[242:243], v19 offset:16896
    ds_read_b64_tr_b16 a[244:245], v19 offset:24576
    ds_read_b64_tr_b16 a[246:247], v19 offset:25088
    s_waitcnt lgkmcnt(0)
    s_waitcnt vmcnt(8)
    s_barrier
    s_add_u32 s43, s42, 98304
    s_mov_b32 m0, s43
    s_add_u32 s44, s41, 1572864
    buffer_load_dwordx4 v11, s[16:19], s44 offen lds

    s_add_u32 s43, s42, 102400
    s_mov_b32 m0, s43
    s_add_u32 s44, s41, 1703936
    buffer_load_dwordx4 v11, s[16:19], s44 offen lds

    s_add_u32 s43, s42, 106496
    s_mov_b32 m0, s43
    s_add_u32 s44, s41, 1835008
    buffer_load_dwordx4 v11, s[16:19], s44 offen lds

    s_add_u32 s43, s42, 110592
    s_mov_b32 m0, s43
    s_add_u32 s44, s41, 1966080
    buffer_load_dwordx4 v11, s[16:19], s44 offen lds

    s_add_u32 s43, s42, 114688
    s_mov_b32 m0, s43
    s_add_u32 s44, s41, 1572864
    buffer_load_dwordx4 v11, s[20:23], s44 offen lds

    s_add_u32 s43, s42, 118784
    s_mov_b32 m0, s43
    s_add_u32 s44, s41, 1703936
    buffer_load_dwordx4 v11, s[20:23], s44 offen lds

    s_add_u32 s43, s42, 122880
    s_mov_b32 m0, s43
    s_add_u32 s44, s41, 1835008
    buffer_load_dwordx4 v11, s[20:23], s44 offen lds

    s_add_u32 s43, s42, 126976
    s_mov_b32 m0, s43
    s_add_u32 s44, s41, 1966080
    buffer_load_dwordx4 v11, s[20:23], s44 offen lds

    ds_read_b64_tr_b16 a[8:9], v18 offset:32768
    ds_read_b64_tr_b16 a[10:11], v18 offset:33280
    ds_read_b64_tr_b16 a[12:13], v18 offset:40960
    ds_read_b64_tr_b16 a[14:15], v18 offset:41472
    ds_read_b64_tr_b16 a[88:89], v19 offset:32768
    ds_read_b64_tr_b16 a[90:91], v19 offset:33280
    ds_read_b64_tr_b16 a[92:93], v19 offset:40960
    ds_read_b64_tr_b16 a[94:95], v19 offset:41472
    s_waitcnt lgkmcnt(0)
    ds_read_b64_tr_b16 a[168:169], v18 offset:49152
    ds_read_b64_tr_b16 a[170:171], v18 offset:49664
    ds_read_b64_tr_b16 a[172:173], v18 offset:57344
    ds_read_b64_tr_b16 a[174:175], v18 offset:57856
    ds_read_b64_tr_b16 a[248:249], v19 offset:49152
    ds_read_b64_tr_b16 a[250:251], v19 offset:49664
    ds_read_b64_tr_b16 a[252:253], v19 offset:57344
    ds_read_b64_tr_b16 a[254:255], v19 offset:57856
    s_waitcnt lgkmcnt(0)
    s_waitcnt vmcnt(8)
    s_barrier
    s_add_u32 s43, s42, 0
    s_mov_b32 m0, s43
    s_add_u32 s44, s41, 2097152
    buffer_load_dwordx4 v11, s[16:19], s44 offen lds

    s_add_u32 s43, s42, 4096
    s_mov_b32 m0, s43
    s_add_u32 s44, s41, 2228224
    buffer_load_dwordx4 v11, s[16:19], s44 offen lds

    s_add_u32 s43, s42, 8192
    s_mov_b32 m0, s43
    s_add_u32 s44, s41, 2359296
    buffer_load_dwordx4 v11, s[16:19], s44 offen lds

    s_add_u32 s43, s42, 12288
    s_mov_b32 m0, s43
    s_add_u32 s44, s41, 2490368
    buffer_load_dwordx4 v11, s[16:19], s44 offen lds

    s_add_u32 s43, s42, 16384
    s_mov_b32 m0, s43
    s_add_u32 s44, s41, 2097152
    buffer_load_dwordx4 v11, s[20:23], s44 offen lds

    s_add_u32 s43, s42, 20480
    s_mov_b32 m0, s43
    s_add_u32 s44, s41, 2228224
    buffer_load_dwordx4 v11, s[20:23], s44 offen lds

    s_add_u32 s43, s42, 24576
    s_mov_b32 m0, s43
    s_add_u32 s44, s41, 2359296
    buffer_load_dwordx4 v11, s[20:23], s44 offen lds

    s_add_u32 s43, s42, 28672
    s_mov_b32 m0, s43
    s_add_u32 s44, s41, 2490368
    buffer_load_dwordx4 v11, s[20:23], s44 offen lds

    ds_read_b64_tr_b16 a[16:17], v20 offset:0
    ds_read_b64_tr_b16 a[18:19], v20 offset:512
    ds_read_b64_tr_b16 a[20:21], v20 offset:8192
    ds_read_b64_tr_b16 a[22:23], v20 offset:8704
    ds_read_b64_tr_b16 a[96:97], v21 offset:0
    ds_read_b64_tr_b16 a[98:99], v21 offset:512
    ds_read_b64_tr_b16 a[100:101], v21 offset:8192
    ds_read_b64_tr_b16 a[102:103], v21 offset:8704
    s_waitcnt lgkmcnt(0)
    ds_read_b64_tr_b16 a[176:177], v20 offset:16384
    ds_read_b64_tr_b16 a[178:179], v20 offset:16896
    ds_read_b64_tr_b16 a[180:181], v20 offset:24576
    ds_read_b64_tr_b16 a[182:183], v20 offset:25088
    ds_read_b64_tr_b16 v[192:193], v21 offset:16384
    ds_read_b64_tr_b16 v[194:195], v21 offset:16896
    ds_read_b64_tr_b16 v[196:197], v21 offset:24576
    ds_read_b64_tr_b16 v[198:199], v21 offset:25088
    s_waitcnt lgkmcnt(0)
    s_waitcnt vmcnt(8)
    s_barrier
    s_add_u32 s43, s42, 32768
    s_mov_b32 m0, s43
    s_add_u32 s44, s41, 2621440
    buffer_load_dwordx4 v11, s[16:19], s44 offen lds

    s_add_u32 s43, s42, 36864
    s_mov_b32 m0, s43
    s_add_u32 s44, s41, 2752512
    buffer_load_dwordx4 v11, s[16:19], s44 offen lds

    s_add_u32 s43, s42, 40960
    s_mov_b32 m0, s43
    s_add_u32 s44, s41, 2883584
    buffer_load_dwordx4 v11, s[16:19], s44 offen lds

    s_add_u32 s43, s42, 45056
    s_mov_b32 m0, s43
    s_add_u32 s44, s41, 3014656
    buffer_load_dwordx4 v11, s[16:19], s44 offen lds

    s_add_u32 s43, s42, 49152
    s_mov_b32 m0, s43
    s_add_u32 s44, s41, 2621440
    buffer_load_dwordx4 v11, s[20:23], s44 offen lds

    s_add_u32 s43, s42, 53248
    s_mov_b32 m0, s43
    s_add_u32 s44, s41, 2752512
    buffer_load_dwordx4 v11, s[20:23], s44 offen lds

    s_add_u32 s43, s42, 57344
    s_mov_b32 m0, s43
    s_add_u32 s44, s41, 2883584
    buffer_load_dwordx4 v11, s[20:23], s44 offen lds

    s_add_u32 s43, s42, 61440
    s_mov_b32 m0, s43
    s_add_u32 s44, s41, 3014656
    buffer_load_dwordx4 v11, s[20:23], s44 offen lds

    ds_read_b64_tr_b16 a[24:25], v20 offset:32768
    ds_read_b64_tr_b16 a[26:27], v20 offset:33280
    ds_read_b64_tr_b16 a[28:29], v20 offset:40960
    ds_read_b64_tr_b16 a[30:31], v20 offset:41472
    ds_read_b64_tr_b16 a[104:105], v21 offset:32768
    ds_read_b64_tr_b16 a[106:107], v21 offset:33280
    ds_read_b64_tr_b16 a[108:109], v21 offset:40960
    ds_read_b64_tr_b16 a[110:111], v21 offset:41472
    s_waitcnt lgkmcnt(0)
    ds_read_b64_tr_b16 a[184:185], v20 offset:49152
    ds_read_b64_tr_b16 a[186:187], v20 offset:49664
    ds_read_b64_tr_b16 a[188:189], v20 offset:57344
    ds_read_b64_tr_b16 a[190:191], v20 offset:57856
    ds_read_b64_tr_b16 v[200:201], v21 offset:49152
    ds_read_b64_tr_b16 v[202:203], v21 offset:49664
    ds_read_b64_tr_b16 v[204:205], v21 offset:57344
    ds_read_b64_tr_b16 v[206:207], v21 offset:57856
    s_waitcnt lgkmcnt(0)
    s_waitcnt vmcnt(8)
    s_barrier
    s_add_u32 s43, s42, 65536
    s_mov_b32 m0, s43
    s_add_u32 s44, s41, 3145728
    buffer_load_dwordx4 v11, s[16:19], s44 offen lds

    s_add_u32 s43, s42, 69632
    s_mov_b32 m0, s43
    s_add_u32 s44, s41, 3276800
    buffer_load_dwordx4 v11, s[16:19], s44 offen lds

    s_add_u32 s43, s42, 73728
    s_mov_b32 m0, s43
    s_add_u32 s44, s41, 3407872
    buffer_load_dwordx4 v11, s[16:19], s44 offen lds

    s_add_u32 s43, s42, 77824
    s_mov_b32 m0, s43
    s_add_u32 s44, s41, 3538944
    buffer_load_dwordx4 v11, s[16:19], s44 offen lds

    s_add_u32 s43, s42, 81920
    s_mov_b32 m0, s43
    s_add_u32 s44, s41, 3145728
    buffer_load_dwordx4 v11, s[20:23], s44 offen lds

    s_add_u32 s43, s42, 86016
    s_mov_b32 m0, s43
    s_add_u32 s44, s41, 3276800
    buffer_load_dwordx4 v11, s[20:23], s44 offen lds

    s_add_u32 s43, s42, 90112
    s_mov_b32 m0, s43
    s_add_u32 s44, s41, 3407872
    buffer_load_dwordx4 v11, s[20:23], s44 offen lds

    s_add_u32 s43, s42, 94208
    s_mov_b32 m0, s43
    s_add_u32 s44, s41, 3538944
    buffer_load_dwordx4 v11, s[20:23], s44 offen lds

    ds_read_b64_tr_b16 a[32:33], v18 offset:0
    ds_read_b64_tr_b16 a[34:35], v18 offset:512
    ds_read_b64_tr_b16 a[36:37], v18 offset:8192
    ds_read_b64_tr_b16 a[38:39], v18 offset:8704
    ds_read_b64_tr_b16 a[112:113], v19 offset:0
    ds_read_b64_tr_b16 a[114:115], v19 offset:512
    ds_read_b64_tr_b16 a[116:117], v19 offset:8192
    ds_read_b64_tr_b16 a[118:119], v19 offset:8704
    s_waitcnt lgkmcnt(0)
    ds_read_b64_tr_b16 a[192:193], v18 offset:16384
    ds_read_b64_tr_b16 a[194:195], v18 offset:16896
    ds_read_b64_tr_b16 a[196:197], v18 offset:24576
    ds_read_b64_tr_b16 a[198:199], v18 offset:25088
    ds_read_b64_tr_b16 v[208:209], v19 offset:16384
    ds_read_b64_tr_b16 v[210:211], v19 offset:16896
    ds_read_b64_tr_b16 v[212:213], v19 offset:24576
    ds_read_b64_tr_b16 v[214:215], v19 offset:25088
    s_waitcnt lgkmcnt(0)
    s_waitcnt vmcnt(8)
    s_barrier
    s_add_u32 s43, s42, 98304
    s_mov_b32 m0, s43
    s_add_u32 s44, s41, 3670016
    buffer_load_dwordx4 v11, s[16:19], s44 offen lds

    s_add_u32 s43, s42, 102400
    s_mov_b32 m0, s43
    s_add_u32 s44, s41, 3801088
    buffer_load_dwordx4 v11, s[16:19], s44 offen lds

    s_add_u32 s43, s42, 106496
    s_mov_b32 m0, s43
    s_add_u32 s44, s41, 3932160
    buffer_load_dwordx4 v11, s[16:19], s44 offen lds

    s_add_u32 s43, s42, 110592
    s_mov_b32 m0, s43
    s_add_u32 s44, s41, 4063232
    buffer_load_dwordx4 v11, s[16:19], s44 offen lds

    s_add_u32 s43, s42, 114688
    s_mov_b32 m0, s43
    s_add_u32 s44, s41, 3670016
    buffer_load_dwordx4 v11, s[20:23], s44 offen lds

    s_add_u32 s43, s42, 118784
    s_mov_b32 m0, s43
    s_add_u32 s44, s41, 3801088
    buffer_load_dwordx4 v11, s[20:23], s44 offen lds

    s_add_u32 s43, s42, 122880
    s_mov_b32 m0, s43
    s_add_u32 s44, s41, 3932160
    buffer_load_dwordx4 v11, s[20:23], s44 offen lds

    s_add_u32 s43, s42, 126976
    s_mov_b32 m0, s43
    s_add_u32 s44, s41, 4063232
    buffer_load_dwordx4 v11, s[20:23], s44 offen lds

    ds_read_b64_tr_b16 a[40:41], v18 offset:32768
    ds_read_b64_tr_b16 a[42:43], v18 offset:33280
    ds_read_b64_tr_b16 a[44:45], v18 offset:40960
    ds_read_b64_tr_b16 a[46:47], v18 offset:41472
    ds_read_b64_tr_b16 a[120:121], v19 offset:32768
    ds_read_b64_tr_b16 a[122:123], v19 offset:33280
    ds_read_b64_tr_b16 a[124:125], v19 offset:40960
    ds_read_b64_tr_b16 a[126:127], v19 offset:41472
    s_waitcnt lgkmcnt(0)
    ds_read_b64_tr_b16 a[200:201], v18 offset:49152
    ds_read_b64_tr_b16 a[202:203], v18 offset:49664
    ds_read_b64_tr_b16 a[204:205], v18 offset:57344
    ds_read_b64_tr_b16 a[206:207], v18 offset:57856
    ds_read_b64_tr_b16 v[216:217], v19 offset:49152
    ds_read_b64_tr_b16 v[218:219], v19 offset:49664
    ds_read_b64_tr_b16 v[220:221], v19 offset:57344
    ds_read_b64_tr_b16 v[222:223], v19 offset:57856
    s_waitcnt lgkmcnt(0)
    s_waitcnt vmcnt(8)
    s_barrier
    s_add_u32 s43, s42, 0
    s_mov_b32 m0, s43
    s_add_u32 s44, s41, 4194304
    buffer_load_dwordx4 v11, s[16:19], s44 offen lds

    s_add_u32 s43, s42, 4096
    s_mov_b32 m0, s43
    s_add_u32 s44, s41, 4325376
    buffer_load_dwordx4 v11, s[16:19], s44 offen lds

    s_add_u32 s43, s42, 8192
    s_mov_b32 m0, s43
    s_add_u32 s44, s41, 4456448
    buffer_load_dwordx4 v11, s[16:19], s44 offen lds

    s_add_u32 s43, s42, 12288
    s_mov_b32 m0, s43
    s_add_u32 s44, s41, 4587520
    buffer_load_dwordx4 v11, s[16:19], s44 offen lds

    s_add_u32 s43, s42, 16384
    s_mov_b32 m0, s43
    s_add_u32 s44, s41, 4194304
    buffer_load_dwordx4 v11, s[20:23], s44 offen lds

    s_add_u32 s43, s42, 20480
    s_mov_b32 m0, s43
    s_add_u32 s44, s41, 4325376
    buffer_load_dwordx4 v11, s[20:23], s44 offen lds

    s_add_u32 s43, s42, 24576
    s_mov_b32 m0, s43
    s_add_u32 s44, s41, 4456448
    buffer_load_dwordx4 v11, s[20:23], s44 offen lds

    s_add_u32 s43, s42, 28672
    s_mov_b32 m0, s43
    s_add_u32 s44, s41, 4587520
    buffer_load_dwordx4 v11, s[20:23], s44 offen lds

    ds_read_b64_tr_b16 a[48:49], v20 offset:0
    ds_read_b64_tr_b16 a[50:51], v20 offset:512
    ds_read_b64_tr_b16 a[52:53], v20 offset:8192
    ds_read_b64_tr_b16 a[54:55], v20 offset:8704
    ds_read_b64_tr_b16 a[128:129], v21 offset:0
    ds_read_b64_tr_b16 a[130:131], v21 offset:512
    ds_read_b64_tr_b16 a[132:133], v21 offset:8192
    ds_read_b64_tr_b16 a[134:135], v21 offset:8704
    s_waitcnt lgkmcnt(0)
    ds_read_b64_tr_b16 a[208:209], v20 offset:16384
    ds_read_b64_tr_b16 a[210:211], v20 offset:16896
    ds_read_b64_tr_b16 a[212:213], v20 offset:24576
    ds_read_b64_tr_b16 a[214:215], v20 offset:25088
    ds_read_b64_tr_b16 v[224:225], v21 offset:16384
    ds_read_b64_tr_b16 v[226:227], v21 offset:16896
    ds_read_b64_tr_b16 v[228:229], v21 offset:24576
    ds_read_b64_tr_b16 v[230:231], v21 offset:25088
    s_waitcnt lgkmcnt(0)
    s_waitcnt vmcnt(8)
    s_barrier
    s_add_u32 s43, s42, 32768
    s_mov_b32 m0, s43
    s_add_u32 s44, s41, 4718592
    buffer_load_dwordx4 v11, s[16:19], s44 offen lds

    s_add_u32 s43, s42, 36864
    s_mov_b32 m0, s43
    s_add_u32 s44, s41, 4849664
    buffer_load_dwordx4 v11, s[16:19], s44 offen lds

    s_add_u32 s43, s42, 40960
    s_mov_b32 m0, s43
    s_add_u32 s44, s41, 4980736
    buffer_load_dwordx4 v11, s[16:19], s44 offen lds

    s_add_u32 s43, s42, 45056
    s_mov_b32 m0, s43
    s_add_u32 s44, s41, 5111808
    buffer_load_dwordx4 v11, s[16:19], s44 offen lds

    s_add_u32 s43, s42, 49152
    s_mov_b32 m0, s43
    s_add_u32 s44, s41, 4718592
    buffer_load_dwordx4 v11, s[20:23], s44 offen lds

    s_add_u32 s43, s42, 53248
    s_mov_b32 m0, s43
    s_add_u32 s44, s41, 4849664
    buffer_load_dwordx4 v11, s[20:23], s44 offen lds

    s_add_u32 s43, s42, 57344
    s_mov_b32 m0, s43
    s_add_u32 s44, s41, 4980736
    buffer_load_dwordx4 v11, s[20:23], s44 offen lds

    s_add_u32 s43, s42, 61440
    s_mov_b32 m0, s43
    s_add_u32 s44, s41, 5111808
    buffer_load_dwordx4 v11, s[20:23], s44 offen lds

    ds_read_b64_tr_b16 a[56:57], v20 offset:32768
    ds_read_b64_tr_b16 a[58:59], v20 offset:33280
    ds_read_b64_tr_b16 a[60:61], v20 offset:40960
    ds_read_b64_tr_b16 a[62:63], v20 offset:41472
    ds_read_b64_tr_b16 a[136:137], v21 offset:32768
    ds_read_b64_tr_b16 a[138:139], v21 offset:33280
    ds_read_b64_tr_b16 a[140:141], v21 offset:40960
    ds_read_b64_tr_b16 a[142:143], v21 offset:41472
    s_waitcnt lgkmcnt(0)
    ds_read_b64_tr_b16 a[216:217], v20 offset:49152
    ds_read_b64_tr_b16 a[218:219], v20 offset:49664
    ds_read_b64_tr_b16 a[220:221], v20 offset:57344
    ds_read_b64_tr_b16 a[222:223], v20 offset:57856
    ds_read_b64_tr_b16 v[232:233], v21 offset:49152
    ds_read_b64_tr_b16 v[234:235], v21 offset:49664
    ds_read_b64_tr_b16 v[236:237], v21 offset:57344
    ds_read_b64_tr_b16 v[238:239], v21 offset:57856
    s_waitcnt lgkmcnt(0)
    s_waitcnt vmcnt(8)
    s_barrier
    ds_read_b64_tr_b16 a[64:65], v18 offset:0
    ds_read_b64_tr_b16 a[66:67], v18 offset:512
    ds_read_b64_tr_b16 a[68:69], v18 offset:8192
    ds_read_b64_tr_b16 a[70:71], v18 offset:8704
    ds_read_b64_tr_b16 a[144:145], v19 offset:0
    ds_read_b64_tr_b16 a[146:147], v19 offset:512
    ds_read_b64_tr_b16 a[148:149], v19 offset:8192
    ds_read_b64_tr_b16 a[150:151], v19 offset:8704
    s_waitcnt lgkmcnt(0)
    ds_read_b64_tr_b16 a[224:225], v18 offset:16384
    ds_read_b64_tr_b16 a[226:227], v18 offset:16896
    ds_read_b64_tr_b16 a[228:229], v18 offset:24576
    ds_read_b64_tr_b16 a[230:231], v18 offset:25088
    ds_read_b64_tr_b16 v[240:241], v19 offset:16384
    ds_read_b64_tr_b16 v[242:243], v19 offset:16896
    ds_read_b64_tr_b16 v[244:245], v19 offset:24576
    ds_read_b64_tr_b16 v[246:247], v19 offset:25088
    s_waitcnt lgkmcnt(0)
    s_waitcnt vmcnt(0)
    s_barrier
    ds_read_b64_tr_b16 a[72:73], v18 offset:32768
    ds_read_b64_tr_b16 a[74:75], v18 offset:33280
    ds_read_b64_tr_b16 a[76:77], v18 offset:40960
    ds_read_b64_tr_b16 a[78:79], v18 offset:41472
    ds_read_b64_tr_b16 a[152:153], v19 offset:32768
    ds_read_b64_tr_b16 a[154:155], v19 offset:33280
    ds_read_b64_tr_b16 a[156:157], v19 offset:40960
    ds_read_b64_tr_b16 a[158:159], v19 offset:41472
    s_waitcnt lgkmcnt(0)
    ds_read_b64_tr_b16 a[232:233], v18 offset:49152
    ds_read_b64_tr_b16 a[234:235], v18 offset:49664
    ds_read_b64_tr_b16 a[236:237], v18 offset:57344
    ds_read_b64_tr_b16 a[238:239], v18 offset:57856
    ds_read_b64_tr_b16 v[248:249], v19 offset:49152
    ds_read_b64_tr_b16 v[250:251], v19 offset:49664
    ds_read_b64_tr_b16 v[252:253], v19 offset:57344
    ds_read_b64_tr_b16 v[254:255], v19 offset:57856
    s_waitcnt lgkmcnt(0)
    s_barrier
    v_and_b32 v10, 15, v2
    v_lshrrev_b32 v11, 4, v2
    v_lshrrev_b32 v12, 1, v11
    v_lshl_add_u32 v10, v12, 4, v10
    s_lshl_b32 s40, s3, 5
    v_add_u32 v10, s40, v10
    v_lshlrev_b32 v10, 4, v10
    v_and_b32 v12, 1, v11
    v_lshl_add_u32 v10, v12, 3, v10
    v_add_u32 v8, 0x14000, v10
    v_bfe_u32 v12, v2, 2, 2
    v_lshl_add_u32 v12, v11, 2, v12
    v_lshlrev_b32 v12, 4, v12
    v_and_b32 v13, 1, v2
    v_lshl_add_u32 v12, v13, 3, v12
    v_add_u32 v9, 0x14000, v12

    v_bfe_u32 v10, v2, 3, 1
    v_and_b32 v11, 7, v2
    v_lshrrev_b32 v14, 4, v2
    v_lshlrev_b32 v12, 8, v10
    v_lshl_add_u32 v12, v11, 5, v12
    v_lshl_add_u32 v12, v14, 3, v12
    v_lshlrev_b32 v13, 3, v11
    v_and_b32 v15, 1, v14
    v_lshl_add_u32 v13, v15, 2, v13
    v_lshrrev_b32 v15, 1, v14
    v_lshl_add_u32 v13, v15, 6, v13
    v_add_u32 v13, 512, v13
    v_mov_b32 v15, 0x7ffffff0
    v_cmp_ne_u32 vcc, 0, v10
    s_mov_b32 s52, 0xff00ff00
    s_mov_b32 s53, 0xff00ff00
    v_cndmask_b32 v13, v13, v15, vcc
    s_mov_b32 s54, 0
    s_mov_b32 s55, -1
    s_lshl_b32 s33, s28, 13
    s_add_u32 s33, s33, 0x3800000
    s_lshl_b32 s34, s28, 7
    s_add_u32 s34, s34, 0x10080
    s_mov_b32 s35, 0
    s_mov_b32 s56, 0x10000
    v_lshlrev_b32 v189, 7, v14
    v_lshl_add_u32 v189, v11, 4, v189
    v_cndmask_b32 v189, v189, v15, vcc
    s_lshl_b32 s57, s28, 11
    s_add_u32 s57, s57, 0xe00000
    s_lshl_b32 s58, s28, 2
    s_add_u32 s58, s58, s3
    s_lshl_b32 s60, s28, 7
    s_add_u32 s60, s60, 0x15800
    v_cmp_gt_u32 vcc, 40, v2
    v_mov_b32 v180, -1
    v_mov_b32 v181, -1
    v_mov_b32 v182, -1
    v_mov_b32 v183, -1
    v_cndmask_b32 v186, v15, v5, vcc

    s_cmp_lg_u32 s3, 0
    s_cbranch_scc1 dwg_1

dw_2:
    buffer_load_dword v148, off, s[12:15], 0 offset:160 sc1
    s_waitcnt vmcnt(0)
    v_readfirstlane_b32 s44, v148
    s_sub_u32 s30, s30, 1
    s_cmp_lt_i32 s30, 0
    s_cbranch_scc1 dwd_3
    s_cmp_ge_u32 s44, 1
    s_cbranch_scc1 dwd_3
    s_sleep 6
    s_branch dw_2

dwd_3:
dw_4:
    buffer_load_dword v148, off, s[12:15], 0 offset:176 sc1
    s_waitcnt vmcnt(0)
    v_readfirstlane_b32 s44, v148
    s_sub_u32 s30, s30, 1
    s_cmp_lt_i32 s30, 0
    s_cbranch_scc1 dwd_5
    s_cmp_ge_u32 s44, 1
    s_cbranch_scc1 dwd_5
    s_sleep 6
    s_branch dw_4

dwd_5:
dw_6:
    buffer_load_dword v148, off, s[12:15], 0 offset:180 sc1
    s_waitcnt vmcnt(0)
    v_readfirstlane_b32 s44, v148
    s_sub_u32 s30, s30, 1
    s_cmp_lt_i32 s30, 0
    s_cbranch_scc1 dwd_7
    s_cmp_ge_u32 s44, 1
    s_cbranch_scc1 dwd_7
    s_sleep 6
    s_branch dw_6

dwd_7:
dwg_1:
    s_barrier
    buffer_load_dwordx2 v[184:185], off, s[12:15], 0 offset:176 sc1
    s_waitcnt vmcnt(0)
    v_readfirstlane_b32 s98, v184
    v_readfirstlane_b32 s99, v185
    s_nop 3
    s_and_b32 s98, s98, 2
    s_lshl_b32 s98, s98, 12
    s_and_b32 s99, s99, 2
    s_lshl_b32 s99, s99, 12
    v_add_u32 v187, 16384, v5

    s_lshl_b32 s40, s3, 10
    v_add_u32 v176, s40, v5
    v_add_u32 v177, 4096, v176
    v_add_u32 v178, 16384, v176
    v_add_u32 v179, 0x18000, v176
    v_add_u32 v175, 0x18000, v5
    s_cmp_lt_u32 s3, 2
    s_cbranch_scc1 ms_8_ok
    v_mov_b32 v178, 0x7ffffff0

ms_8_ok:
    s_add_u32 s59, s99, 0x6280000
    s_add_u32 s64, s99, 0x6200000
    s_lshr_b32 s40, s28, 3
    s_lshl_b32 s40, s40, 14
    s_and_b32 s41, s28, 7
    s_mul_i32 s41, s41, 640
    s_add_u32 s65, s40, s41
    s_add_u32 s65, s65, s64
    s_add_u32 s65, s65, 65536
    s_mov_b32 s61, 0x3e0293ee

p_loop:
    s_and_b32 s40, s29, 3
    s_lshl_b32 s40, s40, 17
    s_add_u32 s31, s40, s64
    s_add_u32 s32, s40, s65
    s_xor_b32 s40, s40, 0x40000
    s_add_u32 s66, s40, s65
    s_cmp_lg_u32 s3, 0
    s_cbranch_scc1 p_sync
    s_add_u32 s36, s29, 1

wf_9:
    s_cmp_ge_u32 s35, s36
    s_cbranch_scc1 wfd_10
    buffer_load_dword v148, off, s[8:11], s34 sc1
    s_waitcnt vmcnt(0)
    v_readfirstlane_b32 s35, v148
    s_nop 3
    s_cmp_ge_u32 s35, s36
    s_cbranch_scc1 wfd_10
    s_sub_u32 s30, s30, 1
    s_cmp_lt_i32 s30, 0
    s_cbranch_scc1 wfd_10
    s_sleep 8
    s_branch wf_9

wfd_10:
    buffer_load_dwordx4 v[72:75], v5, s[8:11], s33 offen offset:0 sc1
    buffer_load_dwordx4 v[76:79], v5, s[8:11], s33 offen offset:1024 sc1
    buffer_load_dwordx4 v[80:83], v5, s[8:11], s33 offen offset:2048 sc1
    buffer_load_dwordx4 v[84:87], v5, s[8:11], s33 offen offset:3072 sc1
    buffer_load_dwordx4 v[88:91], v6, s[8:11], s33 offen offset:0 sc1
    buffer_load_dwordx4 v[92:95], v6, s[8:11], s33 offen offset:1024 sc1
    buffer_load_dwordx4 v[96:99], v6, s[8:11], s33 offen offset:2048 sc1
    buffer_load_dwordx4 v[100:103], v6, s[8:11], s33 offen offset:3072 sc1
    buffer_load_dword v190, off, s[8:11], s34 sc1
    s_cmp_eq_u32 s29, 0
    s_cbranch_scc1 p_sync
    s_sleep 36

p_sync:
    s_barrier
    s_add_u32 s40, s29, 1
    v_mov_b32 v188, s40

mq_11:
    buffer_load_dwordx4 v[160:163], v176, s[8:11], s31 offen sc1
    buffer_load_dwordx4 v[164:167], v177, s[8:11], s31 offen sc1
    buffer_load_dwordx4 v[168:171], v178, s[8:11], s31 offen sc1
    v_mov_b32 v56, 0
    v_mov_b32 v57, 0
    v_mov_b32 v58, 0
    v_mov_b32 v59, 0
    v_mov_b32 v60, 0
    v_mov_b32 v61, 0
    v_mov_b32 v62, 0
    v_mov_b32 v63, 0
    v_mov_b32 v64, 0
    v_mov_b32 v65, 0
    v_mov_b32 v66, 0
    v_mov_b32 v67, 0
    v_mov_b32 v68, 0
    v_mov_b32 v69, 0
    v_mov_b32 v70, 0
    v_mov_b32 v71, 0
    s_waitcnt vmcnt(2)
    ds_write_b128 v179, v[160:163]
    v_max3_u32 v148, v160, v161, v162
    s_waitcnt vmcnt(1)
    ds_write_b128 v179, v[164:167] offset:4096
    v_max3_u32 v148, v148, v163, v164
    v_max3_u32 v148, v148, v165, v166
    s_waitcnt vmcnt(0)
    ds_write_b128 v179, v[168:171] offset:8192
    v_max3_u32 v148, v148, v167, v168
    v_max3_u32 v148, v148, v169, v170
    v_max_u32 v148, v148, v171
    v_cmp_eq_u32 vcc, -1, v148
    s_cbranch_vccz pok_12
    s_sub_u32 s30, s30, 1
    s_cmp_lt_i32 s30, 0
    s_cbranch_scc1 pok_12
    s_sleep 1
    s_branch mq_11

pok_12:
    s_cmp_ge_u32 s3, 2
    s_cbranch_scc1 mw_16
    s_cmp_eq_u32 s3, 1
    s_cbranch_scc1 mw_15

mw_14:
    s_waitcnt lgkmcnt(0)
    s_barrier
    ds_read_b128 v[20:23], v175 offset:1024
    ds_read_b128 v[24:27], v175 offset:2048
    ds_read_b128 v[28:31], v175 offset:3072
    ds_read_b128 v[36:39], v175 offset:5120
    ds_read_b128 v[40:43], v175 offset:6144
    ds_read_b128 v[44:47], v175 offset:7168
    ds_read_b128 v[52:55], v175 offset:9216
    v_smfmac_f32_16x16x64_bf16 v[56:59], v[160:163], a[0:7], v4
    v_smfmac_f32_16x16x64_bf16 v[60:63], v[160:163], a[80:87], v4
    v_smfmac_f32_16x16x64_bf16 v[56:59], v[164:167], a[32:39], v4
    v_smfmac_f32_16x16x64_bf16 v[60:63], v[164:167], a[112:119], v4
    v_smfmac_f32_16x16x64_bf16 v[56:59], v[168:171], a[64:71], v4
    v_smfmac_f32_16x16x64_bf16 v[60:63], v[168:171], a[144:151], v4
    v_smfmac_f32_16x16x64_bf16 v[64:67], v[160:163], a[160:167], v4
    v_smfmac_f32_16x16x64_bf16 v[68:71], v[160:163], a[240:247], v4
    v_smfmac_f32_16x16x64_bf16 v[64:67], v[164:167], a[192:199], v4
    v_smfmac_f32_16x16x64_bf16 v[68:71], v[164:167], v[208:215], v4
    v_smfmac_f32_16x16x64_bf16 v[64:67], v[168:171], a[224:231], v4
    v_smfmac_f32_16x16x64_bf16 v[68:71], v[168:171], v[240:247], v4
    s_waitcnt lgkmcnt(6)
    v_smfmac_f32_16x16x64_bf16 v[56:59], v[20:23], a[8:15], v4
    v_smfmac_f32_16x16x64_bf16 v[60:63], v[20:23], a[88:95], v4
    s_waitcnt lgkmcnt(5)
    v_smfmac_f32_16x16x64_bf16 v[56:59], v[24:27], a[16:23], v4
    v_smfmac_f32_16x16x64_bf16 v[60:63], v[24:27], a[96:103], v4
    s_waitcnt lgkmcnt(4)
    v_smfmac_f32_16x16x64_bf16 v[56:59], v[28:31], a[24:31], v4
    v_smfmac_f32_16x16x64_bf16 v[60:63], v[28:31], a[104:111], v4
    s_waitcnt lgkmcnt(3)
    v_smfmac_f32_16x16x64_bf16 v[56:59], v[36:39], a[40:47], v4
    v_smfmac_f32_16x16x64_bf16 v[60:63], v[36:39], a[120:127], v4
    s_waitcnt lgkmcnt(2)
    v_smfmac_f32_16x16x64_bf16 v[56:59], v[40:43], a[48:55], v4
    v_smfmac_f32_16x16x64_bf16 v[60:63], v[40:43], a[128:135], v4
    s_waitcnt lgkmcnt(1)
    v_smfmac_f32_16x16x64_bf16 v[56:59], v[44:47], a[56:63], v4
    v_smfmac_f32_16x16x64_bf16 v[60:63], v[44:47], a[136:143], v4
    s_waitcnt lgkmcnt(0)
    v_smfmac_f32_16x16x64_bf16 v[56:59], v[52:55], a[72:79], v4
    v_smfmac_f32_16x16x64_bf16 v[60:63], v[52:55], a[152:159], v4
    v_smfmac_f32_16x16x64_bf16 v[64:67], v[20:23], a[168:175], v4
    v_smfmac_f32_16x16x64_bf16 v[68:71], v[20:23], a[248:255], v4
    s_nop 5
    v_permlane32_swap_b32 v56, v60
    v_permlane32_swap_b32 v57, v61
    v_smfmac_f32_16x16x64_bf16 v[64:67], v[24:27], a[176:183], v4
    v_permlane32_swap_b32 v58, v62
    v_permlane32_swap_b32 v59, v63
    v_smfmac_f32_16x16x64_bf16 v[68:71], v[24:27], v[192:199], v4
    v_pk_add_f32 v[56:57], v[56:57], v[60:61]
    v_pk_add_f32 v[58:59], v[58:59], v[62:63]
    v_smfmac_f32_16x16x64_bf16 v[64:67], v[28:31], a[184:191], v4
    v_cvt_pk_bf16_f32 v150, v56, v57
    v_cvt_pk_bf16_f32 v151, v58, v59
    v_smfmac_f32_16x16x64_bf16 v[68:71], v[28:31], v[200:207], v4
    ds_write_b64 v8, v[150:151]
    v_smfmac_f32_16x16x64_bf16 v[64:67], v[36:39], a[200:207], v4
    s_nop 0
    v_smfmac_f32_16x16x64_bf16 v[68:71], v[36:39], v[216:223], v4
    s_nop 0
    v_smfmac_f32_16x16x64_bf16 v[64:67], v[40:43], a[208:215], v4
    s_waitcnt lgkmcnt(0)
    s_barrier
    v_smfmac_f32_16x16x64_bf16 v[68:71], v[40:43], v[224:231], v4
    ds_read_b64_tr_b16 v[104:105], v9 offset:0
    ds_read_b64_tr_b16 v[106:107], v9 offset:256
    v_smfmac_f32_16x16x64_bf16 v[64:67], v[44:47], a[216:223], v4
    ds_read_b64_tr_b16 v[108:109], v9 offset:512
    ds_read_b64_tr_b16 v[110:111], v9 offset:768
    v_smfmac_f32_16x16x64_bf16 v[68:71], v[44:47], v[232:239], v4
    ds_read_b64_tr_b16 v[112:113], v9 offset:1024
    ds_read_b64_tr_b16 v[114:115], v9 offset:1280
    v_smfmac_f32_16x16x64_bf16 v[64:67], v[52:55], a[232:239], v4
    ds_read_b64_tr_b16 v[116:117], v9 offset:1536
    ds_read_b64_tr_b16 v[118:119], v9 offset:1792
    v_smfmac_f32_16x16x64_bf16 v[68:71], v[52:55], v[248:255], v4
    s_branch mj_13
mw_15:
    s_waitcnt lgkmcnt(0)
    s_barrier
    ds_read_b128 v[16:19], v175 offset:0
    ds_read_b128 v[24:27], v175 offset:2048
    ds_read_b128 v[28:31], v175 offset:3072
    ds_read_b128 v[32:35], v175 offset:4096
    ds_read_b128 v[40:43], v175 offset:6144
    ds_read_b128 v[44:47], v175 offset:7168
    ds_read_b128 v[48:51], v175 offset:8192
    v_smfmac_f32_16x16x64_bf16 v[56:59], v[160:163], a[8:15], v4
    v_smfmac_f32_16x16x64_bf16 v[60:63], v[160:163], a[88:95], v4
    v_smfmac_f32_16x16x64_bf16 v[56:59], v[164:167], a[40:47], v4
    v_smfmac_f32_16x16x64_bf16 v[60:63], v[164:167], a[120:127], v4
    v_smfmac_f32_16x16x64_bf16 v[56:59], v[168:171], a[72:79], v4
    v_smfmac_f32_16x16x64_bf16 v[60:63], v[168:171], a[152:159], v4
    v_smfmac_f32_16x16x64_bf16 v[64:67], v[160:163], a[168:175], v4
    v_smfmac_f32_16x16x64_bf16 v[68:71], v[160:163], a[248:255], v4
    v_smfmac_f32_16x16x64_bf16 v[64:67], v[164:167], a[200:207], v4
    v_smfmac_f32_16x16x64_bf16 v[68:71], v[164:167], v[216:223], v4
    v_smfmac_f32_16x16x64_bf16 v[64:67], v[168:171], a[232:239], v4
    v_smfmac_f32_16x16x64_bf16 v[68:71], v[168:171], v[248:255], v4
    s_waitcnt lgkmcnt(6)
    v_smfmac_f32_16x16x64_bf16 v[56:59], v[16:19], a[0:7], v4
    v_smfmac_f32_16x16x64_bf16 v[60:63], v[16:19], a[80:87], v4
    s_waitcnt lgkmcnt(5)
    v_smfmac_f32_16x16x64_bf16 v[56:59], v[24:27], a[16:23], v4
    v_smfmac_f32_16x16x64_bf16 v[60:63], v[24:27], a[96:103], v4
    s_waitcnt lgkmcnt(4)
    v_smfmac_f32_16x16x64_bf16 v[56:59], v[28:31], a[24:31], v4
    v_smfmac_f32_16x16x64_bf16 v[60:63], v[28:31], a[104:111], v4
    s_waitcnt lgkmcnt(3)
    v_smfmac_f32_16x16x64_bf16 v[56:59], v[32:35], a[32:39], v4
    v_smfmac_f32_16x16x64_bf16 v[60:63], v[32:35], a[112:119], v4
    s_waitcnt lgkmcnt(2)
    v_smfmac_f32_16x16x64_bf16 v[56:59], v[40:43], a[48:55], v4
    v_smfmac_f32_16x16x64_bf16 v[60:63], v[40:43], a[128:135], v4
    s_waitcnt lgkmcnt(1)
    v_smfmac_f32_16x16x64_bf16 v[56:59], v[44:47], a[56:63], v4
    v_smfmac_f32_16x16x64_bf16 v[60:63], v[44:47], a[136:143], v4
    s_waitcnt lgkmcnt(0)
    v_smfmac_f32_16x16x64_bf16 v[56:59], v[48:51], a[64:71], v4
    v_smfmac_f32_16x16x64_bf16 v[60:63], v[48:51], a[144:151], v4
    v_smfmac_f32_16x16x64_bf16 v[64:67], v[16:19], a[160:167], v4
    v_smfmac_f32_16x16x64_bf16 v[68:71], v[16:19], a[240:247], v4
    s_nop 5
    v_permlane32_swap_b32 v56, v60
    v_permlane32_swap_b32 v57, v61
    v_smfmac_f32_16x16x64_bf16 v[64:67], v[24:27], a[176:183], v4
    v_permlane32_swap_b32 v58, v62
    v_permlane32_swap_b32 v59, v63
    v_smfmac_f32_16x16x64_bf16 v[68:71], v[24:27], v[192:199], v4
    v_pk_add_f32 v[56:57], v[56:57], v[60:61]
    v_pk_add_f32 v[58:59], v[58:59], v[62:63]
    v_smfmac_f32_16x16x64_bf16 v[64:67], v[28:31], a[184:191], v4
    v_cvt_pk_bf16_f32 v150, v56, v57
    v_cvt_pk_bf16_f32 v151, v58, v59
    v_smfmac_f32_16x16x64_bf16 v[68:71], v[28:31], v[200:207], v4
    ds_write_b64 v8, v[150:151]
    v_smfmac_f32_16x16x64_bf16 v[64:67], v[32:35], a[192:199], v4
    s_nop 0
    v_smfmac_f32_16x16x64_bf16 v[68:71], v[32:35], v[208:215], v4
    s_nop 0
    v_smfmac_f32_16x16x64_bf16 v[64:67], v[40:43], a[208:215], v4
    s_waitcnt lgkmcnt(0)
    s_barrier
    v_smfmac_f32_16x16x64_bf16 v[68:71], v[40:43], v[224:231], v4
    ds_read_b64_tr_b16 v[104:105], v9 offset:0
    ds_read_b64_tr_b16 v[106:107], v9 offset:256
    v_smfmac_f32_16x16x64_bf16 v[64:67], v[44:47], a[216:223], v4
    ds_read_b64_tr_b16 v[108:109], v9 offset:512
    ds_read_b64_tr_b16 v[110:111], v9 offset:768
    v_smfmac_f32_16x16x64_bf16 v[68:71], v[44:47], v[232:239], v4
    ds_read_b64_tr_b16 v[112:113], v9 offset:1024
    ds_read_b64_tr_b16 v[114:115], v9 offset:1280
    v_smfmac_f32_16x16x64_bf16 v[64:67], v[48:51], a[224:231], v4
    ds_read_b64_tr_b16 v[116:117], v9 offset:1536
    ds_read_b64_tr_b16 v[118:119], v9 offset:1792
    v_smfmac_f32_16x16x64_bf16 v[68:71], v[48:51], v[240:247], v4
    s_branch mj_13
mw_16:
    s_cmp_eq_u32 s3, 3
    s_cbranch_scc1 mw_17

    s_waitcnt lgkmcnt(0)
    s_barrier
    ds_read_b128 v[16:19], v175 offset:0
    ds_read_b128 v[20:23], v175 offset:1024
    ds_read_b128 v[28:31], v175 offset:3072
    ds_read_b128 v[32:35], v175 offset:4096
    ds_read_b128 v[36:39], v175 offset:5120
    ds_read_b128 v[44:47], v175 offset:7168
    ds_read_b128 v[48:51], v175 offset:8192
    ds_read_b128 v[52:55], v175 offset:9216
    v_smfmac_f32_16x16x64_bf16 v[56:59], v[160:163], a[16:23], v4
    v_smfmac_f32_16x16x64_bf16 v[60:63], v[160:163], a[96:103], v4
    v_smfmac_f32_16x16x64_bf16 v[56:59], v[164:167], a[48:55], v4
    v_smfmac_f32_16x16x64_bf16 v[60:63], v[164:167], a[128:135], v4
    v_smfmac_f32_16x16x64_bf16 v[64:67], v[160:163], a[176:183], v4
    v_smfmac_f32_16x16x64_bf16 v[68:71], v[160:163], v[192:199], v4
    v_smfmac_f32_16x16x64_bf16 v[64:67], v[164:167], a[208:215], v4
    v_smfmac_f32_16x16x64_bf16 v[68:71], v[164:167], v[224:231], v4
    s_waitcnt lgkmcnt(7)
    v_smfmac_f32_16x16x64_bf16 v[56:59], v[16:19], a[0:7], v4
    v_smfmac_f32_16x16x64_bf16 v[60:63], v[16:19], a[80:87], v4
    s_waitcnt lgkmcnt(6)
    v_smfmac_f32_16x16x64_bf16 v[56:59], v[20:23], a[8:15], v4
    v_smfmac_f32_16x16x64_bf16 v[60:63], v[20:23], a[88:95], v4
    s_waitcnt lgkmcnt(5)
    v_smfmac_f32_16x16x64_bf16 v[56:59], v[28:31], a[24:31], v4
    v_smfmac_f32_16x16x64_bf16 v[60:63], v[28:31], a[104:111], v4
    s_waitcnt lgkmcnt(4)
    v_smfmac_f32_16x16x64_bf16 v[56:59], v[32:35], a[32:39], v4
    v_smfmac_f32_16x16x64_bf16 v[60:63], v[32:35], a[112:119], v4
    s_waitcnt lgkmcnt(3)
    v_smfmac_f32_16x16x64_bf16 v[56:59], v[36:39], a[40:47], v4
    v_smfmac_f32_16x16x64_bf16 v[60:63], v[36:39], a[120:127], v4
    s_waitcnt lgkmcnt(2)
    v_smfmac_f32_16x16x64_bf16 v[56:59], v[44:47], a[56:63], v4
    v_smfmac_f32_16x16x64_bf16 v[60:63], v[44:47], a[136:143], v4
    s_waitcnt lgkmcnt(1)
    v_smfmac_f32_16x16x64_bf16 v[56:59], v[48:51], a[64:71], v4
    v_smfmac_f32_16x16x64_bf16 v[60:63], v[48:51], a[144:151], v4
    s_waitcnt lgkmcnt(0)
    v_smfmac_f32_16x16x64_bf16 v[56:59], v[52:55], a[72:79], v4
    v_smfmac_f32_16x16x64_bf16 v[60:63], v[52:55], a[152:159], v4
    v_smfmac_f32_16x16x64_bf16 v[64:67], v[16:19], a[160:167], v4
    v_smfmac_f32_16x16x64_bf16 v[68:71], v[16:19], a[240:247], v4
    s_nop 5
    v_permlane32_swap_b32 v56, v60
    v_permlane32_swap_b32 v57, v61
    v_smfmac_f32_16x16x64_bf16 v[64:67], v[20:23], a[168:175], v4
    v_permlane32_swap_b32 v58, v62
    v_permlane32_swap_b32 v59, v63
    v_smfmac_f32_16x16x64_bf16 v[68:71], v[20:23], a[248:255], v4
    v_pk_add_f32 v[56:57], v[56:57], v[60:61]
    v_pk_add_f32 v[58:59], v[58:59], v[62:63]
    v_smfmac_f32_16x16x64_bf16 v[64:67], v[28:31], a[184:191], v4
    v_cvt_pk_bf16_f32 v150, v56, v57
    v_cvt_pk_bf16_f32 v151, v58, v59
    v_smfmac_f32_16x16x64_bf16 v[68:71], v[28:31], v[200:207], v4
    ds_write_b64 v8, v[150:151]
    v_smfmac_f32_16x16x64_bf16 v[64:67], v[32:35], a[192:199], v4
    s_nop 0
    v_smfmac_f32_16x16x64_bf16 v[68:71], v[32:35], v[208:215], v4
    s_nop 0
    v_smfmac_f32_16x16x64_bf16 v[64:67], v[36:39], a[200:207], v4
    s_waitcnt lgkmcnt(0)
    s_barrier
    v_smfmac_f32_16x16x64_bf16 v[68:71], v[36:39], v[216:223], v4
    ds_read_b64_tr_b16 v[104:105], v9 offset:0
    ds_read_b64_tr_b16 v[106:107], v9 offset:256
    v_smfmac_f32_16x16x64_bf16 v[64:67], v[44:47], a[216:223], v4
    ds_read_b64_tr_b16 v[108:109], v9 offset:512
    ds_read_b64_tr_b16 v[110:111], v9 offset:768
    v_smfmac_f32_16x16x64_bf16 v[68:71], v[44:47], v[232:239], v4
    ds_read_b64_tr_b16 v[112:113], v9 offset:1024
    ds_read_b64_tr_b16 v[114:115], v9 offset:1280
    v_smfmac_f32_16x16x64_bf16 v[64:67], v[48:51], a[224:231], v4
    ds_read_b64_tr_b16 v[116:117], v9 offset:1536
    ds_read_b64_tr_b16 v[118:119], v9 offset:1792
    v_smfmac_f32_16x16x64_bf16 v[68:71], v[48:51], v[240:247], v4
    v_smfmac_f32_16x16x64_bf16 v[64:67], v[52:55], a[232:239], v4
    v_smfmac_f32_16x16x64_bf16 v[68:71], v[52:55], v[248:255], v4
    s_branch mj_13
mw_17:
    s_waitcnt lgkmcnt(0)
    s_barrier
    ds_read_b128 v[16:19], v175 offset:0
    ds_read_b128 v[20:23], v175 offset:1024
    ds_read_b128 v[24:27], v175 offset:2048
    ds_read_b128 v[32:35], v175 offset:4096
    ds_read_b128 v[36:39], v175 offset:5120
    ds_read_b128 v[40:43], v175 offset:6144
    ds_read_b128 v[48:51], v175 offset:8192
    ds_read_b128 v[52:55], v175 offset:9216
    v_smfmac_f32_16x16x64_bf16 v[56:59], v[160:163], a[24:31], v4
    v_smfmac_f32_16x16x64_bf16 v[60:63], v[160:163], a[104:111], v4
    v_smfmac_f32_16x16x64_bf16 v[56:59], v[164:167], a[56:63], v4
    v_smfmac_f32_16x16x64_bf16 v[60:63], v[164:167], a[136:143], v4
    v_smfmac_f32_16x16x64_bf16 v[64:67], v[160:163], a[184:191], v4
    v_smfmac_f32_16x16x64_bf16 v[68:71], v[160:163], v[200:207], v4
    v_smfmac_f32_16x16x64_bf16 v[64:67], v[164:167], a[216:223], v4
    v_smfmac_f32_16x16x64_bf16 v[68:71], v[164:167], v[232:239], v4
    s_waitcnt lgkmcnt(7)
    v_smfmac_f32_16x16x64_bf16 v[56:59], v[16:19], a[0:7], v4
    v_smfmac_f32_16x16x64_bf16 v[60:63], v[16:19], a[80:87], v4
    s_waitcnt lgkmcnt(6)
    v_smfmac_f32_16x16x64_bf16 v[56:59], v[20:23], a[8:15], v4
    v_smfmac_f32_16x16x64_bf16 v[60:63], v[20:23], a[88:95], v4
    s_waitcnt lgkmcnt(5)
    v_smfmac_f32_16x16x64_bf16 v[56:59], v[24:27], a[16:23], v4
    v_smfmac_f32_16x16x64_bf16 v[60:63], v[24:27], a[96:103], v4
    s_waitcnt lgkmcnt(4)
    v_smfmac_f32_16x16x64_bf16 v[56:59], v[32:35], a[32:39], v4
    v_smfmac_f32_16x16x64_bf16 v[60:63], v[32:35], a[112:119], v4
    s_waitcnt lgkmcnt(3)
    v_smfmac_f32_16x16x64_bf16 v[56:59], v[36:39], a[40:47], v4
    v_smfmac_f32_16x16x64_bf16 v[60:63], v[36:39], a[120:127], v4
    s_waitcnt lgkmcnt(2)
    v_smfmac_f32_16x16x64_bf16 v[56:59], v[40:43], a[48:55], v4
    v_smfmac_f32_16x16x64_bf16 v[60:63], v[40:43], a[128:135], v4
    s_cmp_lg_u32 s58, 3
    s_cbranch_scc1 p_nodoor
    s_mov_b64 exec, 1
    buffer_store_dword v188, off, s[8:11], s59 sc1
    s_mov_b64 exec, -1
p_nodoor:

    s_waitcnt lgkmcnt(1)
    v_smfmac_f32_16x16x64_bf16 v[56:59], v[48:51], a[64:71], v4
    v_smfmac_f32_16x16x64_bf16 v[60:63], v[48:51], a[144:151], v4
    s_waitcnt lgkmcnt(0)
    v_smfmac_f32_16x16x64_bf16 v[56:59], v[52:55], a[72:79], v4
    v_smfmac_f32_16x16x64_bf16 v[60:63], v[52:55], a[152:159], v4
    v_smfmac_f32_16x16x64_bf16 v[64:67], v[16:19], a[160:167], v4
    v_smfmac_f32_16x16x64_bf16 v[68:71], v[16:19], a[240:247], v4
    s_nop 5
    v_permlane32_swap_b32 v56, v60
    v_permlane32_swap_b32 v57, v61
    v_smfmac_f32_16x16x64_bf16 v[64:67], v[20:23], a[168:175], v4
    v_permlane32_swap_b32 v58, v62
    v_permlane32_swap_b32 v59, v63
    v_smfmac_f32_16x16x64_bf16 v[68:71], v[20:23], a[248:255], v4
    v_pk_add_f32 v[56:57], v[56:57], v[60:61]
    v_pk_add_f32 v[58:59], v[58:59], v[62:63]
    v_smfmac_f32_16x16x64_bf16 v[64:67], v[24:27], a[176:183], v4
    v_cvt_pk_bf16_f32 v150, v56, v57
    v_cvt_pk_bf16_f32 v151, v58, v59
    v_smfmac_f32_16x16x64_bf16 v[68:71], v[24:27], v[192:199], v4
    ds_write_b64 v8, v[150:151]
    v_smfmac_f32_16x16x64_bf16 v[64:67], v[32:35], a[192:199], v4
    s_nop 0
    v_smfmac_f32_16x16x64_bf16 v[68:71], v[32:35], v[208:215], v4
    s_nop 0
    v_smfmac_f32_16x16x64_bf16 v[64:67], v[36:39], a[200:207], v4
    s_waitcnt lgkmcnt(0)
    s_barrier
    v_smfmac_f32_16x16x64_bf16 v[68:71], v[36:39], v[216:223], v4
    ds_read_b64_tr_b16 v[104:105], v9 offset:0
    ds_read_b64_tr_b16 v[106:107], v9 offset:256
    v_smfmac_f32_16x16x64_bf16 v[64:67], v[40:43], a[208:215], v4
    ds_read_b64_tr_b16 v[108:109], v9 offset:512
    ds_read_b64_tr_b16 v[110:111], v9 offset:768
    v_smfmac_f32_16x16x64_bf16 v[68:71], v[40:43], v[224:231], v4
    ds_read_b64_tr_b16 v[112:113], v9 offset:1024
    ds_read_b64_tr_b16 v[114:115], v9 offset:1280
    v_smfmac_f32_16x16x64_bf16 v[64:67], v[48:51], a[224:231], v4
    ds_read_b64_tr_b16 v[116:117], v9 offset:1536
    ds_read_b64_tr_b16 v[118:119], v9 offset:1792
    v_smfmac_f32_16x16x64_bf16 v[68:71], v[48:51], v[240:247], v4
    v_smfmac_f32_16x16x64_bf16 v[64:67], v[52:55], a[232:239], v4
    v_smfmac_f32_16x16x64_bf16 v[68:71], v[52:55], v[248:255], v4
mj_13:
    s_waitcnt lgkmcnt(6)
    v_mfma_f32_16x16x32_bf16 v[136:139], v[72:75], v[104:107], 0
    v_mfma_f32_16x16x32_bf16 v[140:143], v[88:91], v[104:107], 0
    s_nop 4
    v_permlane32_swap_b32 v64, v68
    v_permlane32_swap_b32 v65, v69
    v_permlane32_swap_b32 v66, v70
    s_waitcnt lgkmcnt(4)
    v_mfma_f32_16x16x32_bf16 v[136:139], v[76:79], v[108:111], v[136:139]
    v_permlane32_swap_b32 v67, v71
    v_pk_add_f32 v[64:65], v[64:65], v[68:69]
    v_pk_add_f32 v[66:67], v[66:67], v[70:71]
    v_mfma_f32_16x16x32_bf16 v[140:143], v[92:95], v[108:111], v[140:143]
    v_cvt_pk_bf16_f32 v152, v64, v65
    v_cvt_pk_bf16_f32 v153, v66, v67
    ds_write_b64 v8, v[152:153] offset:2048
    s_waitcnt lgkmcnt(3)
    v_mfma_f32_16x16x32_bf16 v[136:139], v[80:83], v[112:115], v[136:139]
    v_mfma_f32_16x16x32_bf16 v[140:143], v[96:99], v[112:115], v[140:143]
    s_waitcnt lgkmcnt(1)
    v_mfma_f32_16x16x32_bf16 v[136:139], v[84:87], v[116:119], v[136:139]
    v_mfma_f32_16x16x32_bf16 v[140:143], v[100:103], v[116:119], v[140:143]
    s_waitcnt lgkmcnt(0)
    s_barrier
    s_cmp_lg_u32 s3, 0
    s_cbranch_scc1 p_other

    ds_read_b64_tr_b16 v[120:121], v9 offset:2048
    ds_read_b64_tr_b16 v[122:123], v9 offset:2304
    ds_read_b64_tr_b16 v[124:125], v9 offset:2560
    ds_read_b64_tr_b16 v[126:127], v9 offset:2816
    ds_read_b64_tr_b16 v[128:129], v9 offset:3072
    ds_read_b64_tr_b16 v[130:131], v9 offset:3328
    ds_read_b64_tr_b16 v[132:133], v9 offset:3584
    ds_read_b64_tr_b16 v[134:135], v9 offset:3840
    v_cndmask_b32 v148, v136, v140, s[52:53]
    v_cndmask_b32 v149, v137, v141, s[52:53]
    v_cndmask_b32 v150, v138, v142, s[52:53]
    v_cndmask_b32 v151, v139, v143, s[52:53]
    v_max3_f32 v154, v148, v149, v150
    v_max_f32 v154, v154, v151
    s_waitcnt lgkmcnt(6)
    v_mfma_f32_16x16x32_bf16 v[144:147], v[120:123], v[104:107], 0
    v_max_f32_dpp v154, v154, v154 row_ror:8 row_mask:0xf bank_mask:0xf
    v_mov_b32 v155, v154
    s_waitcnt lgkmcnt(4)
    v_mfma_f32_16x16x32_bf16 v[144:147], v[124:127], v[108:111], v[144:147]
    v_permlane32_swap_b32 v154, v155
    s_waitcnt lgkmcnt(2)
    v_mfma_f32_16x16x32_bf16 v[144:147], v[128:131], v[112:115], v[144:147]
    v_max_f32 v154, v154, v155
    s_waitcnt lgkmcnt(0)
    v_mfma_f32_16x16x32_bf16 v[144:147], v[132:135], v[116:119], v[144:147]
    s_nop 7
    v_max3_f32 v154, v154, v144, v145
    v_max3_f32 v154, v154, v146, v147
    v_mov_b32 v155, v154
    v_cndmask_b32 v152, v144, v145, s[52:53]
    v_cndmask_b32 v172, v146, v147, s[52:53]
    v_permlane16_swap_b32 v154, v155
    v_cndmask_b32 v152, v152, v172, s[54:55]
    v_max_f32 v154, v154, v155
    v_mul_f32 v154, s61, v154
    v_fma_f32 v152, v152, s61, -v154
    v_fma_f32 v148, v148, s61, -v154
    v_exp_f32 v152, v152
    v_fma_f32 v149, v149, s61, -v154
    v_exp_f32 v148, v148
    v_fma_f32 v150, v150, s61, -v154
    v_exp_f32 v149, v149
    v_fma_f32 v151, v151, s61, -v154
    v_exp_f32 v150, v150
    v_add_f32 v159, v148, v152
    v_exp_f32 v151, v151
    v_add_f32 v159, v159, v149
    v_add_f32 v159, v159, v150
    v_add_f32 v159, v159, v151
    v_mov_b32_dpp v153, v152 row_ror:8 row_mask:0xf bank_mask:0xf
    s_nop 0
    v_add_f32_dpp v159, v159, v159 row_ror:8 row_mask:0xf bank_mask:0xf
    v_mov_b32 v155, v159
    s_nop 1
    v_permlane16_swap_b32 v159, v155
    v_add_f32 v159, v159, v155
    v_mov_b32 v155, v159
    s_nop 1
    v_permlane32_swap_b32 v159, v155
    v_add_f32 v159, v159, v155
    v_rcp_f32 v159, v159
    s_nop 0
    v_mul_f32 v148, v148, v159
    v_mul_f32 v149, v149, v159
    v_mul_f32 v150, v150, v159
    v_mul_f32 v151, v151, v159
    v_cvt_pk_bf16_f32 v156, v148, v149
    v_cvt_pk_bf16_f32 v157, v150, v151
    v_mul_f32 v152, v152, v159
    v_min_u32 v156, -2, v156
    v_min_u32 v157, -2, v157
    v_mul_f32 v153, v153, v159
    buffer_store_dwordx2 v[156:157], v12, s[8:11], s32 offen sc1
    v_cvt_pk_bf16_f32 v158, v152, v153
    v_min_u32 v158, -2, v158
    buffer_store_dword v158, v13, s[8:11], s32 offen sc1
    v_readfirstlane_b32 s35, v190
    s_branch p_next

p_other:
    s_cmp_lg_u32 s3, 1
    s_cbranch_scc1 p_w23

    ds_read_b64_tr_b16 v[120:121], v9 offset:2048
    ds_read_b64_tr_b16 v[122:123], v9 offset:2304
    ds_read_b64_tr_b16 v[124:125], v9 offset:2560
    ds_read_b64_tr_b16 v[126:127], v9 offset:2816
    ds_read_b64_tr_b16 v[128:129], v9 offset:3072
    ds_read_b64_tr_b16 v[130:131], v9 offset:3328
    ds_read_b64_tr_b16 v[132:133], v9 offset:3584
    ds_read_b64_tr_b16 v[134:135], v9 offset:3840
    s_waitcnt lgkmcnt(0)
    v_min_u32 v120, -2, v120
    v_min_u32 v121, -2, v121
    v_min_u32 v122, -2, v122
    v_min_u32 v123, -2, v123
    v_min_u32 v124, -2, v124
    v_min_u32 v125, -2, v125
    v_min_u32 v126, -2, v126
    v_min_u32 v127, -2, v127
    v_min_u32 v128, -2, v128
    v_min_u32 v129, -2, v129
    v_min_u32 v130, -2, v130
    v_min_u32 v131, -2, v131
    v_min_u32 v132, -2, v132
    v_min_u32 v133, -2, v133
    v_min_u32 v134, -2, v134
    v_min_u32 v135, -2, v135
    buffer_store_dwordx4 v[120:123], v189, s[8:11], s57 offen offset:0 sc1
    buffer_store_dwordx4 v[124:127], v189, s[8:11], s57 offen offset:512 sc1
    buffer_store_dwordx4 v[128:131], v189, s[8:11], s57 offen offset:1024 sc1
    buffer_store_dwordx4 v[132:135], v189, s[8:11], s57 offen offset:1536 sc1
    s_waitcnt vmcnt(0)
    s_mov_b64 exec, 1
    buffer_store_dword v188, off, s[8:11], s60 sc1
    s_mov_b64 exec, -1
    s_branch p_next

p_w23:
    s_cmp_lg_u32 s3, 2
    s_cbranch_scc1 p_next
    buffer_store_dwordx4 v[180:183], v186, s[8:11], s66 offen sc1
    s_cmp_lg_u32 s28, 0
    s_cbranch_scc1 p_next
    s_add_u32 s40, s29, 1
    v_mov_b32 v148, s40
    s_mov_b64 exec, 1
    buffer_store_dword v148, off, s[8:11], s56 sc1
    s_mov_b64 exec, -1

p_next:
    s_add_u32 s33, s33, 262144
    s_add_u32 s57, s57, 65536
    s_add_u32 s29, s29, 1
    s_cmp_lt_u32 s29, 64
    s_cbranch_scc1 p_loop
    s_endpgm

role_vm:
    s_sub_u32 s28, s28, 32
    s_load_dwordx4 s[64:67], s[0:1], 32
    s_waitcnt lgkmcnt(0)

    s_mov_b32 s16, s64
    s_and_b32 s17, s65, 0xffff
    s_mov_b32 s18, 0x500000
    s_mov_b32 s19, 0x00020000
    s_mov_b32 s20, s66
    s_and_b32 s21, s67, 0xffff
    s_mov_b32 s22, 0x500000
    s_mov_b32 s23, 0x00020000
    v_add_u32 v10, 0, v2
    v_mul_u32_u24 v11, 3277, v10
    v_lshrrev_b32 v11, 16, v11
    v_mul_u32_u24 v12, 20, v11
    v_sub_u32 v10, v10, v12
    v_mul_u32_u24 v11, 1280, v11
    v_lshl_add_u32 v24, v10, 4, v11

    v_add_u32 v10, 64, v2
    v_mul_u32_u24 v11, 3277, v10
    v_lshrrev_b32 v11, 16, v11
    v_mul_u32_u24 v12, 20, v11
    v_sub_u32 v10, v10, v12
    v_mul_u32_u24 v11, 1280, v11
    v_lshl_add_u32 v25, v10, 4, v11

    v_add_u32 v10, 128, v2
    v_mul_u32_u24 v11, 3277, v10
    v_lshrrev_b32 v11, 16, v11
    v_mul_u32_u24 v12, 20, v11
    v_sub_u32 v10, v10, v12
    v_mul_u32_u24 v11, 1280, v11
    v_lshl_add_u32 v26, v10, 4, v11

    v_add_u32 v10, 192, v2
    v_mul_u32_u24 v11, 3277, v10
    v_lshrrev_b32 v11, 16, v11
    v_mul_u32_u24 v12, 20, v11
    v_sub_u32 v10, v10, v12
    v_mul_u32_u24 v11, 1280, v11
    v_lshl_add_u32 v27, v10, 4, v11

    v_add_u32 v10, 256, v2
    v_mul_u32_u24 v11, 3277, v10
    v_lshrrev_b32 v11, 16, v11
    v_mul_u32_u24 v12, 20, v11
    v_sub_u32 v10, v10, v12
    v_mul_u32_u24 v11, 1280, v11
    v_lshl_add_u32 v28, v10, 4, v11

    s_mul_i32 s46, s28, 163840
    s_mul_i32 s40, s3, 320
    s_add_u32 s46, s46, s40
    s_mul_i32 s47, s3, 20480
    s_add_u32 s47, s47, 49152
    v_lshrrev_b32 v10, 4, v2
    v_bfe_u32 v11, v2, 2, 2
    v_lshl_add_u32 v10, v10, 2, v11
    v_mul_u32_u24 v10, 320, v10
    v_and_b32 v11, 3, v2
    v_lshl_add_u32 v10, v11, 3, v10
    v_add_u32 v29, s47, v10

    v_lshrrev_b32 v10, 4, v2
    v_and_b32 v11, 15, v2
    v_and_b32 v12, 1, v10
    s_lshl_b32 s40, s3, 1
    v_or_b32 v12, s40, v12
    v_lshlrev_b32 v12, 1, v12
    v_xor_b32 v11, v11, v12
    v_lshlrev_b32 v11, 4, v11
    s_lshl_b32 s40, s3, 2
    v_add_u32 v12, s40, v10
    v_lshl_add_u32 v11, v12, 13, v11
    s_lshl_b32 s41, s28, 8
    s_lshl_b32 s42, s3, 10
    v_bfe_u32 v12, v2, 2, 2
    v_and_b32 v13, 3, v2
    v_lshrrev_b32 v14, 1, v10
    v_lshlrev_b32 v14, 4, v14
    v_and_b32 v15, 1, v10
    v_lshl_add_u32 v14, v15, 2, v14
    v_and_b32 v16, 1, v12
    v_add_u32 v14, v14, v16
    v_lshrrev_b32 v17, 1, v12
    v_lshl_add_u32 v14, v17, 3, v14
    v_lshlrev_b32 v14, 8, v14
    v_lshl_add_u32 v14, v13, 3, v14
    v_lshl_or_b32 v16, v15, 1, v16
    v_lshl_or_b32 v16, v17, 2, v16
    v_lshl_or_b32 v14, v16, 5, v14
    s_lshl_b32 s40, s3, 6
    v_xor_b32 v18, s40, v14
    v_xor_b32 v19, 32, v18
    v_add_u32 v20, 0x10000, v18
    v_add_u32 v21, 0x10000, v19

    s_add_u32 s43, s42, 0
    s_mov_b32 m0, s43
    s_add_u32 s44, s41, 0
    buffer_load_dwordx4 v11, s[16:19], s44 offen lds

    s_add_u32 s43, s42, 4096
    s_mov_b32 m0, s43
    s_add_u32 s44, s41, 131072
    buffer_load_dwordx4 v11, s[16:19], s44 offen lds

    s_add_u32 s43, s42, 8192
    s_mov_b32 m0, s43
    s_add_u32 s44, s41, 262144
    buffer_load_dwordx4 v11, s[16:19], s44 offen lds

    s_add_u32 s43, s42, 12288
    s_mov_b32 m0, s43
    s_add_u32 s44, s41, 393216
    buffer_load_dwordx4 v11, s[16:19], s44 offen lds

    s_add_u32 s43, s42, 16384
    s_mov_b32 m0, s43
    s_add_u32 s44, s41, 524288
    buffer_load_dwordx4 v11, s[16:19], s44 offen lds

    s_add_u32 s43, s42, 20480
    s_mov_b32 m0, s43
    s_add_u32 s44, s41, 655360
    buffer_load_dwordx4 v11, s[16:19], s44 offen lds

    s_add_u32 s43, s42, 24576
    s_mov_b32 m0, s43
    s_add_u32 s44, s41, 786432
    buffer_load_dwordx4 v11, s[16:19], s44 offen lds

    s_add_u32 s43, s42, 28672
    s_mov_b32 m0, s43
    s_add_u32 s44, s41, 917504
    buffer_load_dwordx4 v11, s[16:19], s44 offen lds

    s_mov_b32 s45, s47
    s_mov_b32 m0, s45
    s_add_u32 s45, s45, 1024
    buffer_load_dwordx4 v24, s[20:23], s46 offen lds

    s_mov_b32 m0, s45
    s_add_u32 s45, s45, 1024
    buffer_load_dwordx4 v25, s[20:23], s46 offen lds

    s_mov_b32 m0, s45
    s_add_u32 s45, s45, 1024
    buffer_load_dwordx4 v26, s[20:23], s46 offen lds

    s_mov_b32 m0, s45
    s_add_u32 s45, s45, 1024
    buffer_load_dwordx4 v27, s[20:23], s46 offen lds

    s_mov_b32 m0, s45
    s_add_u32 s45, s45, 1024
    buffer_load_dwordx4 v28, s[20:23], s46 offen lds

    s_add_u32 s46, s46, 20480
    s_mov_b32 m0, s45
    s_add_u32 s45, s45, 1024
    buffer_load_dwordx4 v24, s[20:23], s46 offen lds

    s_mov_b32 m0, s45
    s_add_u32 s45, s45, 1024
    buffer_load_dwordx4 v25, s[20:23], s46 offen lds

    s_mov_b32 m0, s45
    s_add_u32 s45, s45, 1024
    buffer_load_dwordx4 v26, s[20:23], s46 offen lds

    s_mov_b32 m0, s45
    s_add_u32 s45, s45, 1024
    buffer_load_dwordx4 v27, s[20:23], s46 offen lds

    s_mov_b32 m0, s45
    s_add_u32 s45, s45, 1024
    buffer_load_dwordx4 v28, s[20:23], s46 offen lds

    s_add_u32 s46, s46, 20480
    s_mov_b32 m0, s45
    s_add_u32 s45, s45, 1024
    buffer_load_dwordx4 v24, s[20:23], s46 offen lds

    s_mov_b32 m0, s45
    s_add_u32 s45, s45, 1024
    buffer_load_dwordx4 v25, s[20:23], s46 offen lds

    s_mov_b32 m0, s45
    s_add_u32 s45, s45, 1024
    buffer_load_dwordx4 v26, s[20:23], s46 offen lds

    s_mov_b32 m0, s45
    s_add_u32 s45, s45, 1024
    buffer_load_dwordx4 v27, s[20:23], s46 offen lds

    s_mov_b32 m0, s45
    s_add_u32 s45, s45, 1024
    buffer_load_dwordx4 v28, s[20:23], s46 offen lds

    s_add_u32 s46, s46, 20480
    s_mov_b32 m0, s45
    s_add_u32 s45, s45, 1024
    buffer_load_dwordx4 v24, s[20:23], s46 offen lds

    s_mov_b32 m0, s45
    s_add_u32 s45, s45, 1024
    buffer_load_dwordx4 v25, s[20:23], s46 offen lds

    s_mov_b32 m0, s45
    s_add_u32 s45, s45, 1024
    buffer_load_dwordx4 v26, s[20:23], s46 offen lds

    s_mov_b32 m0, s45
    s_add_u32 s45, s45, 1024
    buffer_load_dwordx4 v27, s[20:23], s46 offen lds

    s_mov_b32 m0, s45
    s_add_u32 s45, s45, 1024
    buffer_load_dwordx4 v28, s[20:23], s46 offen lds

    s_add_u32 s46, s46, 20480
    s_waitcnt vmcnt(24)
    s_barrier
    s_add_u32 s43, s42, 32768
    s_mov_b32 m0, s43
    s_add_u32 s44, s41, 1048576
    buffer_load_dwordx4 v11, s[16:19], s44 offen lds

    s_add_u32 s43, s42, 36864
    s_mov_b32 m0, s43
    s_add_u32 s44, s41, 1179648
    buffer_load_dwordx4 v11, s[16:19], s44 offen lds

    s_add_u32 s43, s42, 40960
    s_mov_b32 m0, s43
    s_add_u32 s44, s41, 1310720
    buffer_load_dwordx4 v11, s[16:19], s44 offen lds

    s_add_u32 s43, s42, 45056
    s_mov_b32 m0, s43
    s_add_u32 s44, s41, 1441792
    buffer_load_dwordx4 v11, s[16:19], s44 offen lds

    ds_read_b64_tr_b16 a[0:1], v18 offset:0
    ds_read_b64_tr_b16 a[2:3], v18 offset:512
    ds_read_b64_tr_b16 a[4:5], v18 offset:8192
    ds_read_b64_tr_b16 a[6:7], v18 offset:8704
    ds_read_b64_tr_b16 a[80:81], v19 offset:0
    ds_read_b64_tr_b16 a[82:83], v19 offset:512
    ds_read_b64_tr_b16 a[84:85], v19 offset:8192
    ds_read_b64_tr_b16 a[86:87], v19 offset:8704
    s_waitcnt lgkmcnt(0)
    s_waitcnt vmcnt(24)
    s_barrier
    s_add_u32 s43, s42, 0
    s_mov_b32 m0, s43
    s_add_u32 s44, s41, 1572864
    buffer_load_dwordx4 v11, s[16:19], s44 offen lds

    s_add_u32 s43, s42, 4096
    s_mov_b32 m0, s43
    s_add_u32 s44, s41, 1703936
    buffer_load_dwordx4 v11, s[16:19], s44 offen lds

    s_add_u32 s43, s42, 8192
    s_mov_b32 m0, s43
    s_add_u32 s44, s41, 1835008
    buffer_load_dwordx4 v11, s[16:19], s44 offen lds

    s_add_u32 s43, s42, 12288
    s_mov_b32 m0, s43
    s_add_u32 s44, s41, 1966080
    buffer_load_dwordx4 v11, s[16:19], s44 offen lds

    ds_read_b64_tr_b16 a[8:9], v18 offset:16384
    ds_read_b64_tr_b16 a[10:11], v18 offset:16896
    ds_read_b64_tr_b16 a[12:13], v18 offset:24576
    ds_read_b64_tr_b16 a[14:15], v18 offset:25088
    ds_read_b64_tr_b16 a[88:89], v19 offset:16384
    ds_read_b64_tr_b16 a[90:91], v19 offset:16896
    ds_read_b64_tr_b16 a[92:93], v19 offset:24576
    ds_read_b64_tr_b16 a[94:95], v19 offset:25088
    s_waitcnt lgkmcnt(0)
    s_waitcnt vmcnt(4)
    s_barrier
    s_add_u32 s43, s42, 16384
    s_mov_b32 m0, s43
    s_add_u32 s44, s41, 2097152
    buffer_load_dwordx4 v11, s[16:19], s44 offen lds

    s_add_u32 s43, s42, 20480
    s_mov_b32 m0, s43
    s_add_u32 s44, s41, 2228224
    buffer_load_dwordx4 v11, s[16:19], s44 offen lds

    s_add_u32 s43, s42, 24576
    s_mov_b32 m0, s43
    s_add_u32 s44, s41, 2359296
    buffer_load_dwordx4 v11, s[16:19], s44 offen lds

    s_add_u32 s43, s42, 28672
    s_mov_b32 m0, s43
    s_add_u32 s44, s41, 2490368
    buffer_load_dwordx4 v11, s[16:19], s44 offen lds

    ds_read_b64_tr_b16 a[16:17], v18 offset:32768
    ds_read_b64_tr_b16 a[18:19], v18 offset:33280
    ds_read_b64_tr_b16 a[20:21], v18 offset:40960
    ds_read_b64_tr_b16 a[22:23], v18 offset:41472
    ds_read_b64_tr_b16 a[96:97], v19 offset:32768
    ds_read_b64_tr_b16 a[98:99], v19 offset:33280
    ds_read_b64_tr_b16 a[100:101], v19 offset:40960
    ds_read_b64_tr_b16 a[102:103], v19 offset:41472
    s_waitcnt lgkmcnt(0)
    ds_read_b64_tr_b16 a[160:161], v29 offset:0
    ds_read_b64_tr_b16 a[162:163], v29 offset:5120
    ds_read_b64_tr_b16 a[164:165], v29 offset:10240
    ds_read_b64_tr_b16 a[166:167], v29 offset:15360
    ds_read_b64_tr_b16 a[176:177], v29 offset:32
    ds_read_b64_tr_b16 a[178:179], v29 offset:5152
    ds_read_b64_tr_b16 a[180:181], v29 offset:10272
    ds_read_b64_tr_b16 a[182:183], v29 offset:15392
    s_waitcnt lgkmcnt(0)
    ds_read_b64_tr_b16 a[192:193], v29 offset:64
    ds_read_b64_tr_b16 a[194:195], v29 offset:5184
    ds_read_b64_tr_b16 a[196:197], v29 offset:10304
    ds_read_b64_tr_b16 a[198:199], v29 offset:15424
    ds_read_b64_tr_b16 a[208:209], v29 offset:96
    ds_read_b64_tr_b16 a[210:211], v29 offset:5216
    ds_read_b64_tr_b16 a[212:213], v29 offset:10336
    ds_read_b64_tr_b16 a[214:215], v29 offset:15456
    s_waitcnt lgkmcnt(0)
    ds_read_b64_tr_b16 a[224:225], v29 offset:128
    ds_read_b64_tr_b16 a[226:227], v29 offset:5248
    ds_read_b64_tr_b16 a[228:229], v29 offset:10368
    ds_read_b64_tr_b16 a[230:231], v29 offset:15488
    ds_read_b64_tr_b16 a[240:241], v29 offset:160
    ds_read_b64_tr_b16 a[242:243], v29 offset:5280
    ds_read_b64_tr_b16 a[244:245], v29 offset:10400
    ds_read_b64_tr_b16 a[246:247], v29 offset:15520
    s_waitcnt lgkmcnt(0)
    ds_read_b64_tr_b16 v[192:193], v29 offset:192
    ds_read_b64_tr_b16 v[194:195], v29 offset:5312
    ds_read_b64_tr_b16 v[196:197], v29 offset:10432
    ds_read_b64_tr_b16 v[198:199], v29 offset:15552
    ds_read_b64_tr_b16 v[208:209], v29 offset:224
    ds_read_b64_tr_b16 v[210:211], v29 offset:5344
    ds_read_b64_tr_b16 v[212:213], v29 offset:10464
    ds_read_b64_tr_b16 v[214:215], v29 offset:15584
    s_waitcnt lgkmcnt(0)
    ds_read_b64_tr_b16 v[224:225], v29 offset:256
    ds_read_b64_tr_b16 v[226:227], v29 offset:5376
    ds_read_b64_tr_b16 v[228:229], v29 offset:10496
    ds_read_b64_tr_b16 v[230:231], v29 offset:15616
    ds_read_b64_tr_b16 v[240:241], v29 offset:288
    ds_read_b64_tr_b16 v[242:243], v29 offset:5408
    ds_read_b64_tr_b16 v[244:245], v29 offset:10528
    ds_read_b64_tr_b16 v[246:247], v29 offset:15648
    s_waitcnt lgkmcnt(0)
    s_mov_b32 s45, s47
    s_mov_b32 m0, s45
    s_add_u32 s45, s45, 1024
    buffer_load_dwordx4 v24, s[20:23], s46 offen lds

    s_mov_b32 m0, s45
    s_add_u32 s45, s45, 1024
    buffer_load_dwordx4 v25, s[20:23], s46 offen lds

    s_mov_b32 m0, s45
    s_add_u32 s45, s45, 1024
    buffer_load_dwordx4 v26, s[20:23], s46 offen lds

    s_mov_b32 m0, s45
    s_add_u32 s45, s45, 1024
    buffer_load_dwordx4 v27, s[20:23], s46 offen lds

    s_mov_b32 m0, s45
    s_add_u32 s45, s45, 1024
    buffer_load_dwordx4 v28, s[20:23], s46 offen lds

    s_add_u32 s46, s46, 20480
    s_mov_b32 m0, s45
    s_add_u32 s45, s45, 1024
    buffer_load_dwordx4 v24, s[20:23], s46 offen lds

    s_mov_b32 m0, s45
    s_add_u32 s45, s45, 1024
    buffer_load_dwordx4 v25, s[20:23], s46 offen lds

    s_mov_b32 m0, s45
    s_add_u32 s45, s45, 1024
    buffer_load_dwordx4 v26, s[20:23], s46 offen lds

    s_mov_b32 m0, s45
    s_add_u32 s45, s45, 1024
    buffer_load_dwordx4 v27, s[20:23], s46 offen lds

    s_mov_b32 m0, s45
    s_add_u32 s45, s45, 1024
    buffer_load_dwordx4 v28, s[20:23], s46 offen lds

    s_add_u32 s46, s46, 20480
    s_mov_b32 m0, s45
    s_add_u32 s45, s45, 1024
    buffer_load_dwordx4 v24, s[20:23], s46 offen lds

    s_mov_b32 m0, s45
    s_add_u32 s45, s45, 1024
    buffer_load_dwordx4 v25, s[20:23], s46 offen lds

    s_mov_b32 m0, s45
    s_add_u32 s45, s45, 1024
    buffer_load_dwordx4 v26, s[20:23], s46 offen lds

    s_mov_b32 m0, s45
    s_add_u32 s45, s45, 1024
    buffer_load_dwordx4 v27, s[20:23], s46 offen lds

    s_mov_b32 m0, s45
    s_add_u32 s45, s45, 1024
    buffer_load_dwordx4 v28, s[20:23], s46 offen lds

    s_add_u32 s46, s46, 20480
    s_mov_b32 m0, s45
    s_add_u32 s45, s45, 1024
    buffer_load_dwordx4 v24, s[20:23], s46 offen lds

    s_mov_b32 m0, s45
    s_add_u32 s45, s45, 1024
    buffer_load_dwordx4 v25, s[20:23], s46 offen lds

    s_mov_b32 m0, s45
    s_add_u32 s45, s45, 1024
    buffer_load_dwordx4 v26, s[20:23], s46 offen lds

    s_mov_b32 m0, s45
    s_add_u32 s45, s45, 1024
    buffer_load_dwordx4 v27, s[20:23], s46 offen lds

    s_mov_b32 m0, s45
    s_add_u32 s45, s45, 1024
    buffer_load_dwordx4 v28, s[20:23], s46 offen lds

    s_add_u32 s46, s46, 20480
    s_waitcnt vmcnt(4)
    s_barrier
    s_add_u32 s43, s42, 32768
    s_mov_b32 m0, s43
    s_add_u32 s44, s41, 2621440
    buffer_load_dwordx4 v11, s[16:19], s44 offen lds

    s_add_u32 s43, s42, 36864
    s_mov_b32 m0, s43
    s_add_u32 s44, s41, 2752512
    buffer_load_dwordx4 v11, s[16:19], s44 offen lds

    s_add_u32 s43, s42, 40960
    s_mov_b32 m0, s43
    s_add_u32 s44, s41, 2883584
    buffer_load_dwordx4 v11, s[16:19], s44 offen lds

    s_add_u32 s43, s42, 45056
    s_mov_b32 m0, s43
    s_add_u32 s44, s41, 3014656
    buffer_load_dwordx4 v11, s[16:19], s44 offen lds

    ds_read_b64_tr_b16 a[24:25], v18 offset:0
    ds_read_b64_tr_b16 a[26:27], v18 offset:512
    ds_read_b64_tr_b16 a[28:29], v18 offset:8192
    ds_read_b64_tr_b16 a[30:31], v18 offset:8704
    ds_read_b64_tr_b16 a[104:105], v19 offset:0
    ds_read_b64_tr_b16 a[106:107], v19 offset:512
    ds_read_b64_tr_b16 a[108:109], v19 offset:8192
    ds_read_b64_tr_b16 a[110:111], v19 offset:8704
    s_waitcnt lgkmcnt(0)
    s_waitcnt vmcnt(4)
    s_barrier
    s_add_u32 s43, s42, 0
    s_mov_b32 m0, s43
    s_add_u32 s44, s41, 3145728
    buffer_load_dwordx4 v11, s[16:19], s44 offen lds

    s_add_u32 s43, s42, 4096
    s_mov_b32 m0, s43
    s_add_u32 s44, s41, 3276800
    buffer_load_dwordx4 v11, s[16:19], s44 offen lds

    s_add_u32 s43, s42, 8192
    s_mov_b32 m0, s43
    s_add_u32 s44, s41, 3407872
    buffer_load_dwordx4 v11, s[16:19], s44 offen lds

    s_add_u32 s43, s42, 12288
    s_mov_b32 m0, s43
    s_add_u32 s44, s41, 3538944
    buffer_load_dwordx4 v11, s[16:19], s44 offen lds

    ds_read_b64_tr_b16 a[32:33], v18 offset:16384
    ds_read_b64_tr_b16 a[34:35], v18 offset:16896
    ds_read_b64_tr_b16 a[36:37], v18 offset:24576
    ds_read_b64_tr_b16 a[38:39], v18 offset:25088
    ds_read_b64_tr_b16 a[112:113], v19 offset:16384
    ds_read_b64_tr_b16 a[114:115], v19 offset:16896
    ds_read_b64_tr_b16 a[116:117], v19 offset:24576
    ds_read_b64_tr_b16 a[118:119], v19 offset:25088
    s_waitcnt lgkmcnt(0)
    s_waitcnt vmcnt(4)
    s_barrier
    s_add_u32 s43, s42, 16384
    s_mov_b32 m0, s43
    s_add_u32 s44, s41, 3670016
    buffer_load_dwordx4 v11, s[16:19], s44 offen lds

    s_add_u32 s43, s42, 20480
    s_mov_b32 m0, s43
    s_add_u32 s44, s41, 3801088
    buffer_load_dwordx4 v11, s[16:19], s44 offen lds

    s_add_u32 s43, s42, 24576
    s_mov_b32 m0, s43
    s_add_u32 s44, s41, 3932160
    buffer_load_dwordx4 v11, s[16:19], s44 offen lds

    s_add_u32 s43, s42, 28672
    s_mov_b32 m0, s43
    s_add_u32 s44, s41, 4063232
    buffer_load_dwordx4 v11, s[16:19], s44 offen lds

    ds_read_b64_tr_b16 a[40:41], v18 offset:32768
    ds_read_b64_tr_b16 a[42:43], v18 offset:33280
    ds_read_b64_tr_b16 a[44:45], v18 offset:40960
    ds_read_b64_tr_b16 a[46:47], v18 offset:41472
    ds_read_b64_tr_b16 a[120:121], v19 offset:32768
    ds_read_b64_tr_b16 a[122:123], v19 offset:33280
    ds_read_b64_tr_b16 a[124:125], v19 offset:40960
    ds_read_b64_tr_b16 a[126:127], v19 offset:41472
    s_waitcnt lgkmcnt(0)
    s_waitcnt vmcnt(4)
    s_barrier
    s_add_u32 s43, s42, 32768
    s_mov_b32 m0, s43
    s_add_u32 s44, s41, 4194304
    buffer_load_dwordx4 v11, s[16:19], s44 offen lds

    s_add_u32 s43, s42, 36864
    s_mov_b32 m0, s43
    s_add_u32 s44, s41, 4325376
    buffer_load_dwordx4 v11, s[16:19], s44 offen lds

    s_add_u32 s43, s42, 40960
    s_mov_b32 m0, s43
    s_add_u32 s44, s41, 4456448
    buffer_load_dwordx4 v11, s[16:19], s44 offen lds

    s_add_u32 s43, s42, 45056
    s_mov_b32 m0, s43
    s_add_u32 s44, s41, 4587520
    buffer_load_dwordx4 v11, s[16:19], s44 offen lds

    ds_read_b64_tr_b16 a[48:49], v18 offset:0
    ds_read_b64_tr_b16 a[50:51], v18 offset:512
    ds_read_b64_tr_b16 a[52:53], v18 offset:8192
    ds_read_b64_tr_b16 a[54:55], v18 offset:8704
    ds_read_b64_tr_b16 a[128:129], v19 offset:0
    ds_read_b64_tr_b16 a[130:131], v19 offset:512
    ds_read_b64_tr_b16 a[132:133], v19 offset:8192
    ds_read_b64_tr_b16 a[134:135], v19 offset:8704
    s_waitcnt lgkmcnt(0)
    s_waitcnt vmcnt(4)
    s_barrier
    s_add_u32 s43, s42, 0
    s_mov_b32 m0, s43
    s_add_u32 s44, s41, 4718592
    buffer_load_dwordx4 v11, s[16:19], s44 offen lds

    s_add_u32 s43, s42, 4096
    s_mov_b32 m0, s43
    s_add_u32 s44, s41, 4849664
    buffer_load_dwordx4 v11, s[16:19], s44 offen lds

    s_add_u32 s43, s42, 8192
    s_mov_b32 m0, s43
    s_add_u32 s44, s41, 4980736
    buffer_load_dwordx4 v11, s[16:19], s44 offen lds

    s_add_u32 s43, s42, 12288
    s_mov_b32 m0, s43
    s_add_u32 s44, s41, 5111808
    buffer_load_dwordx4 v11, s[16:19], s44 offen lds

    ds_read_b64_tr_b16 a[56:57], v18 offset:16384
    ds_read_b64_tr_b16 a[58:59], v18 offset:16896
    ds_read_b64_tr_b16 a[60:61], v18 offset:24576
    ds_read_b64_tr_b16 a[62:63], v18 offset:25088
    ds_read_b64_tr_b16 a[136:137], v19 offset:16384
    ds_read_b64_tr_b16 a[138:139], v19 offset:16896
    ds_read_b64_tr_b16 a[140:141], v19 offset:24576
    ds_read_b64_tr_b16 a[142:143], v19 offset:25088
    s_waitcnt lgkmcnt(0)
    s_waitcnt vmcnt(4)
    s_barrier
    ds_read_b64_tr_b16 a[64:65], v18 offset:32768
    ds_read_b64_tr_b16 a[66:67], v18 offset:33280
    ds_read_b64_tr_b16 a[68:69], v18 offset:40960
    ds_read_b64_tr_b16 a[70:71], v18 offset:41472
    ds_read_b64_tr_b16 a[144:145], v19 offset:32768
    ds_read_b64_tr_b16 a[146:147], v19 offset:33280
    ds_read_b64_tr_b16 a[148:149], v19 offset:40960
    ds_read_b64_tr_b16 a[150:151], v19 offset:41472
    s_waitcnt lgkmcnt(0)
    s_waitcnt vmcnt(0)
    s_barrier
    ds_read_b64_tr_b16 a[72:73], v18 offset:0
    ds_read_b64_tr_b16 a[74:75], v18 offset:512
    ds_read_b64_tr_b16 a[76:77], v18 offset:8192
    ds_read_b64_tr_b16 a[78:79], v18 offset:8704
    ds_read_b64_tr_b16 a[152:153], v19 offset:0
    ds_read_b64_tr_b16 a[154:155], v19 offset:512
    ds_read_b64_tr_b16 a[156:157], v19 offset:8192
    ds_read_b64_tr_b16 a[158:159], v19 offset:8704
    s_waitcnt lgkmcnt(0)
    s_barrier
    ds_read_b64_tr_b16 a[168:169], v29 offset:0
    ds_read_b64_tr_b16 a[170:171], v29 offset:5120
    ds_read_b64_tr_b16 a[172:173], v29 offset:10240
    ds_read_b64_tr_b16 a[174:175], v29 offset:15360
    ds_read_b64_tr_b16 a[184:185], v29 offset:32
    ds_read_b64_tr_b16 a[186:187], v29 offset:5152
    ds_read_b64_tr_b16 a[188:189], v29 offset:10272
    ds_read_b64_tr_b16 a[190:191], v29 offset:15392
    s_waitcnt lgkmcnt(0)
    ds_read_b64_tr_b16 a[200:201], v29 offset:64
    ds_read_b64_tr_b16 a[202:203], v29 offset:5184
    ds_read_b64_tr_b16 a[204:205], v29 offset:10304
    ds_read_b64_tr_b16 a[206:207], v29 offset:15424
    ds_read_b64_tr_b16 a[216:217], v29 offset:96
    ds_read_b64_tr_b16 a[218:219], v29 offset:5216
    ds_read_b64_tr_b16 a[220:221], v29 offset:10336
    ds_read_b64_tr_b16 a[222:223], v29 offset:15456
    s_waitcnt lgkmcnt(0)
    ds_read_b64_tr_b16 a[232:233], v29 offset:128
    ds_read_b64_tr_b16 a[234:235], v29 offset:5248
    ds_read_b64_tr_b16 a[236:237], v29 offset:10368
    ds_read_b64_tr_b16 a[238:239], v29 offset:15488
    ds_read_b64_tr_b16 a[248:249], v29 offset:160
    ds_read_b64_tr_b16 a[250:251], v29 offset:5280
    ds_read_b64_tr_b16 a[252:253], v29 offset:10400
    ds_read_b64_tr_b16 a[254:255], v29 offset:15520
    s_waitcnt lgkmcnt(0)
    ds_read_b64_tr_b16 v[200:201], v29 offset:192
    ds_read_b64_tr_b16 v[202:203], v29 offset:5312
    ds_read_b64_tr_b16 v[204:205], v29 offset:10432
    ds_read_b64_tr_b16 v[206:207], v29 offset:15552
    ds_read_b64_tr_b16 v[216:217], v29 offset:224
    ds_read_b64_tr_b16 v[218:219], v29 offset:5344
    ds_read_b64_tr_b16 v[220:221], v29 offset:10464
    ds_read_b64_tr_b16 v[222:223], v29 offset:15584
    s_waitcnt lgkmcnt(0)
    ds_read_b64_tr_b16 v[232:233], v29 offset:256
    ds_read_b64_tr_b16 v[234:235], v29 offset:5376
    ds_read_b64_tr_b16 v[236:237], v29 offset:10496
    ds_read_b64_tr_b16 v[238:239], v29 offset:15616
    ds_read_b64_tr_b16 v[248:249], v29 offset:288
    ds_read_b64_tr_b16 v[250:251], v29 offset:5408
    ds_read_b64_tr_b16 v[252:253], v29 offset:10528
    ds_read_b64_tr_b16 v[254:255], v29 offset:15648
    s_waitcnt lgkmcnt(0)
    s_barrier
    v_and_b32 v10, 15, v2
    v_lshrrev_b32 v11, 4, v2
    v_lshrrev_b32 v12, 1, v11
    v_lshl_add_u32 v10, v12, 4, v10
    s_lshl_b32 s40, s3, 5
    v_add_u32 v10, s40, v10
    v_lshlrev_b32 v10, 4, v10
    v_and_b32 v12, 1, v11
    v_lshl_add_u32 v10, v12, 3, v10
    v_add_u32 v8, 0x14000, v10
    v_bfe_u32 v12, v2, 2, 2
    v_lshl_add_u32 v12, v11, 2, v12
    v_lshlrev_b32 v12, 4, v12
    v_and_b32 v13, 1, v2
    v_lshl_add_u32 v12, v13, 3, v12
    v_add_u32 v9, 0x14000, v12

    v_lshrrev_b32 v10, 5, v2
    v_lshlrev_b32 v10, 5, v10
    v_bfe_u32 v11, v2, 3, 1
    v_lshl_add_u32 v10, v11, 4, v10
    v_bfe_u32 v11, v2, 4, 1
    v_lshl_add_u32 v10, v11, 3, v10
    v_bfe_u32 v11, v2, 1, 1
    v_lshl_add_u32 v10, v11, 1, v10
    v_bfe_u32 v11, v2, 2, 1
    v_add_u32 v10, v10, v11
    v_lshlrev_b32 v10, 4, v10
    v_and_b32 v11, 1, v2
    v_lshl_add_u32 v10, v11, 3, v10
    v_add_u32 v9, 0x14000, v10
    v_lshlrev_b32 v12, 3, v2
    v_and_b32 v13, 31, v2
    v_lshlrev_b32 v13, 3, v13
    v_lshrrev_b32 v10, 5, v2
    v_lshl_add_u32 v13, v10, 14, v13
    v_mov_b32 v132, -1
    v_mov_b32 v133, -1
    v_mov_b32 v134, 0
    s_mul_i32 s57, s28, 10240
    s_mul_i32 s40, s3, 2560
    s_add_u32 s57, s57, s40
    s_add_u32 s57, s57, 0x6800000
    s_lshl_b32 s61, s28, 7
    s_lshl_b32 s40, s3, 2
    s_add_u32 s61, s61, s40
    s_add_u32 s61, s61, 0x13000

    s_cmp_lg_u32 s3, 0
    s_cbranch_scc1 dwg_18

dw_19:
    buffer_load_dword v135, off, s[12:15], 0 offset:160 sc1
    s_waitcnt vmcnt(0)
    v_readfirstlane_b32 s44, v135
    s_sub_u32 s30, s30, 1
    s_cmp_lt_i32 s30, 0
    s_cbranch_scc1 dwd_20
    s_cmp_ge_u32 s44, 1
    s_cbranch_scc1 dwd_20
    s_sleep 6
    s_branch dw_19

dwd_20:
dw_21:
    buffer_load_dword v135, off, s[12:15], 0 offset:176 sc1
    s_waitcnt vmcnt(0)
    v_readfirstlane_b32 s44, v135
    s_sub_u32 s30, s30, 1
    s_cmp_lt_i32 s30, 0
    s_cbranch_scc1 dwd_22
    s_cmp_ge_u32 s44, 1
    s_cbranch_scc1 dwd_22
    s_sleep 6
    s_branch dw_21

dwd_22:
dw_23:
    buffer_load_dword v135, off, s[12:15], 0 offset:180 sc1
    s_waitcnt vmcnt(0)
    v_readfirstlane_b32 s44, v135
    s_sub_u32 s30, s30, 1
    s_cmp_lt_i32 s30, 0
    s_cbranch_scc1 dwd_24
    s_cmp_ge_u32 s44, 1
    s_cbranch_scc1 dwd_24
    s_sleep 6
    s_branch dw_23

dwd_24:
dwg_18:
    s_barrier
    buffer_load_dwordx2 v[184:185], off, s[12:15], 0 offset:176 sc1
    s_waitcnt vmcnt(0)
    v_readfirstlane_b32 s98, v184
    v_readfirstlane_b32 s99, v185
    s_nop 3
    s_and_b32 s98, s98, 2
    s_lshl_b32 s98, s98, 12
    s_and_b32 s99, s99, 2
    s_lshl_b32 s99, s99, 12
    v_add_u32 v187, 16384, v5

    s_lshl_b32 s40, s3, 10
    v_add_u32 v176, s40, v5
    v_add_u32 v177, 4096, v176
    v_add_u32 v178, 16384, v176
    v_add_u32 v179, 0x18000, v176
    v_add_u32 v175, 0x18000, v5
    s_cmp_lt_u32 s3, 2
    s_cbranch_scc1 ms_25_ok
    v_mov_b32 v178, 0x7ffffff0

ms_25_ok:
    s_add_u32 s64, s99, 0x6208000
    s_mul_i32 s65, s3, 163840
    s_lshl_b32 s40, s28, 8
    s_add_u32 s65, s65, s40
    s_add_u32 s65, s65, s98
    s_add_u32 s65, s65, 0x6000000
    s_mov_b32 s66, 0
    s_mov_b32 s67, 1310720

vm_loop:
    v_mov_b32 v80, 0
    v_mov_b32 v81, 0
    v_mov_b32 v82, 0
    v_mov_b32 v83, 0
    v_mov_b32 v84, 0
    v_mov_b32 v85, 0
    v_mov_b32 v86, 0
    v_mov_b32 v87, 0
    v_mov_b32 v88, 0
    v_mov_b32 v89, 0
    v_mov_b32 v90, 0
    v_mov_b32 v91, 0
    v_mov_b32 v92, 0
    v_mov_b32 v93, 0
    v_mov_b32 v94, 0
    v_mov_b32 v95, 0
    v_mov_b32 v96, 0
    v_mov_b32 v97, 0
    v_mov_b32 v98, 0
    v_mov_b32 v99, 0
    v_mov_b32 v100, 0
    v_mov_b32 v101, 0
    v_mov_b32 v102, 0
    v_mov_b32 v103, 0
    v_mov_b32 v104, 0
    v_mov_b32 v105, 0
    v_mov_b32 v106, 0
    v_mov_b32 v107, 0
    v_mov_b32 v108, 0
    v_mov_b32 v109, 0
    v_mov_b32 v110, 0
    v_mov_b32 v111, 0
    v_mov_b32 v112, 0
    v_mov_b32 v113, 0
    v_mov_b32 v114, 0
    v_mov_b32 v115, 0
    v_mov_b32 v116, 0
    v_mov_b32 v117, 0
    v_mov_b32 v118, 0
    v_mov_b32 v119, 0
    s_and_b32 s40, s29, 3
    s_lshl_b32 s40, s40, 17
    s_add_u32 s31, s40, s64
    s_add_u32 s58, s65, s66
    s_cmp_eq_u32 s29, 0
    s_cbranch_scc1 vm_sync
    s_sleep 4
vm_sync:
    s_barrier

mq_26:
    buffer_load_dwordx4 v[160:163], v176, s[8:11], s31 offen sc1
    buffer_load_dwordx4 v[164:167], v177, s[8:11], s31 offen sc1
    buffer_load_dwordx4 v[168:171], v178, s[8:11], s31 offen sc1
    v_mov_b32 v56, 0
    v_mov_b32 v57, 0
    v_mov_b32 v58, 0
    v_mov_b32 v59, 0
    v_mov_b32 v60, 0
    v_mov_b32 v61, 0
    v_mov_b32 v62, 0
    v_mov_b32 v63, 0
    s_waitcnt vmcnt(2)
    ds_write_b128 v179, v[160:163]
    v_max3_u32 v135, v160, v161, v162
    s_waitcnt vmcnt(1)
    ds_write_b128 v179, v[164:167] offset:4096
    v_max3_u32 v135, v135, v163, v164
    v_max3_u32 v135, v135, v165, v166
    s_waitcnt vmcnt(0)
    ds_write_b128 v179, v[168:171] offset:8192
    v_max3_u32 v135, v135, v167, v168
    v_max3_u32 v135, v135, v169, v170
    v_max_u32 v135, v135, v171
    v_cmp_eq_u32 vcc, -1, v135
    s_cbranch_vccz pok_27
    s_sub_u32 s30, s30, 1
    s_cmp_lt_i32 s30, 0
    s_cbranch_scc1 pok_27
    s_sleep 1
    s_branch mq_26

pok_27:
    s_cmp_ge_u32 s3, 2
    s_cbranch_scc1 mw_31
    s_cmp_eq_u32 s3, 1
    s_cbranch_scc1 mw_30

mw_29:
    s_waitcnt lgkmcnt(0)
    s_barrier
    ds_read_b128 v[20:23], v175 offset:1024
    ds_read_b128 v[24:27], v175 offset:2048
    ds_read_b128 v[28:31], v175 offset:3072
    ds_read_b128 v[36:39], v175 offset:5120
    ds_read_b128 v[40:43], v175 offset:6144
    ds_read_b128 v[44:47], v175 offset:7168
    ds_read_b128 v[52:55], v175 offset:9216
    v_smfmac_f32_16x16x64_bf16 v[56:59], v[160:163], a[0:7], v4
    v_smfmac_f32_16x16x64_bf16 v[60:63], v[160:163], a[80:87], v4
    v_smfmac_f32_16x16x64_bf16 v[56:59], v[164:167], a[32:39], v4
    v_smfmac_f32_16x16x64_bf16 v[60:63], v[164:167], a[112:119], v4
    v_smfmac_f32_16x16x64_bf16 v[56:59], v[168:171], a[64:71], v4
    v_smfmac_f32_16x16x64_bf16 v[60:63], v[168:171], a[144:151], v4
    s_waitcnt lgkmcnt(6)
    v_smfmac_f32_16x16x64_bf16 v[56:59], v[20:23], a[8:15], v4
    v_smfmac_f32_16x16x64_bf16 v[60:63], v[20:23], a[88:95], v4
    s_waitcnt lgkmcnt(5)
    v_smfmac_f32_16x16x64_bf16 v[56:59], v[24:27], a[16:23], v4
    v_smfmac_f32_16x16x64_bf16 v[60:63], v[24:27], a[96:103], v4
    s_waitcnt lgkmcnt(4)
    v_smfmac_f32_16x16x64_bf16 v[56:59], v[28:31], a[24:31], v4
    v_smfmac_f32_16x16x64_bf16 v[60:63], v[28:31], a[104:111], v4
    s_waitcnt lgkmcnt(3)
    v_smfmac_f32_16x16x64_bf16 v[56:59], v[36:39], a[40:47], v4
    v_smfmac_f32_16x16x64_bf16 v[60:63], v[36:39], a[120:127], v4
    s_waitcnt lgkmcnt(2)
    v_smfmac_f32_16x16x64_bf16 v[56:59], v[40:43], a[48:55], v4
    v_smfmac_f32_16x16x64_bf16 v[60:63], v[40:43], a[128:135], v4
    s_waitcnt lgkmcnt(1)
    v_smfmac_f32_16x16x64_bf16 v[56:59], v[44:47], a[56:63], v4
    v_smfmac_f32_16x16x64_bf16 v[60:63], v[44:47], a[136:143], v4
    s_waitcnt lgkmcnt(0)
    v_smfmac_f32_16x16x64_bf16 v[56:59], v[52:55], a[72:79], v4
    v_smfmac_f32_16x16x64_bf16 v[60:63], v[52:55], a[152:159], v4
    s_branch mj_28
mw_30:
    s_waitcnt lgkmcnt(0)
    s_barrier
    ds_read_b128 v[16:19], v175 offset:0
    ds_read_b128 v[24:27], v175 offset:2048
    ds_read_b128 v[28:31], v175 offset:3072
    ds_read_b128 v[32:35], v175 offset:4096
    ds_read_b128 v[40:43], v175 offset:6144
    ds_read_b128 v[44:47], v175 offset:7168
    ds_read_b128 v[48:51], v175 offset:8192
    v_smfmac_f32_16x16x64_bf16 v[56:59], v[160:163], a[8:15], v4
    v_smfmac_f32_16x16x64_bf16 v[60:63], v[160:163], a[88:95], v4
    v_smfmac_f32_16x16x64_bf16 v[56:59], v[164:167], a[40:47], v4
    v_smfmac_f32_16x16x64_bf16 v[60:63], v[164:167], a[120:127], v4
    v_smfmac_f32_16x16x64_bf16 v[56:59], v[168:171], a[72:79], v4
    v_smfmac_f32_16x16x64_bf16 v[60:63], v[168:171], a[152:159], v4
    s_waitcnt lgkmcnt(6)
    v_smfmac_f32_16x16x64_bf16 v[56:59], v[16:19], a[0:7], v4
    v_smfmac_f32_16x16x64_bf16 v[60:63], v[16:19], a[80:87], v4
    s_waitcnt lgkmcnt(5)
    v_smfmac_f32_16x16x64_bf16 v[56:59], v[24:27], a[16:23], v4
    v_smfmac_f32_16x16x64_bf16 v[60:63], v[24:27], a[96:103], v4
    s_waitcnt lgkmcnt(4)
    v_smfmac_f32_16x16x64_bf16 v[56:59], v[28:31], a[24:31], v4
    v_smfmac_f32_16x16x64_bf16 v[60:63], v[28:31], a[104:111], v4
    s_waitcnt lgkmcnt(3)
    v_smfmac_f32_16x16x64_bf16 v[56:59], v[32:35], a[32:39], v4
    v_smfmac_f32_16x16x64_bf16 v[60:63], v[32:35], a[112:119], v4
    s_waitcnt lgkmcnt(2)
    v_smfmac_f32_16x16x64_bf16 v[56:59], v[40:43], a[48:55], v4
    v_smfmac_f32_16x16x64_bf16 v[60:63], v[40:43], a[128:135], v4
    s_waitcnt lgkmcnt(1)
    v_smfmac_f32_16x16x64_bf16 v[56:59], v[44:47], a[56:63], v4
    v_smfmac_f32_16x16x64_bf16 v[60:63], v[44:47], a[136:143], v4
    s_waitcnt lgkmcnt(0)
    v_smfmac_f32_16x16x64_bf16 v[56:59], v[48:51], a[64:71], v4
    v_smfmac_f32_16x16x64_bf16 v[60:63], v[48:51], a[144:151], v4
    s_branch mj_28
mw_31:
    s_cmp_eq_u32 s3, 3
    s_cbranch_scc1 mw_32

    s_waitcnt lgkmcnt(0)
    s_barrier
    ds_read_b128 v[16:19], v175 offset:0
    ds_read_b128 v[20:23], v175 offset:1024
    ds_read_b128 v[28:31], v175 offset:3072
    ds_read_b128 v[32:35], v175 offset:4096
    ds_read_b128 v[36:39], v175 offset:5120
    ds_read_b128 v[44:47], v175 offset:7168
    ds_read_b128 v[48:51], v175 offset:8192
    ds_read_b128 v[52:55], v175 offset:9216
    v_smfmac_f32_16x16x64_bf16 v[56:59], v[160:163], a[16:23], v4
    v_smfmac_f32_16x16x64_bf16 v[60:63], v[160:163], a[96:103], v4
    v_smfmac_f32_16x16x64_bf16 v[56:59], v[164:167], a[48:55], v4
    v_smfmac_f32_16x16x64_bf16 v[60:63], v[164:167], a[128:135], v4
    s_waitcnt lgkmcnt(7)
    v_smfmac_f32_16x16x64_bf16 v[56:59], v[16:19], a[0:7], v4
    v_smfmac_f32_16x16x64_bf16 v[60:63], v[16:19], a[80:87], v4
    s_waitcnt lgkmcnt(6)
    v_smfmac_f32_16x16x64_bf16 v[56:59], v[20:23], a[8:15], v4
    v_smfmac_f32_16x16x64_bf16 v[60:63], v[20:23], a[88:95], v4
    s_waitcnt lgkmcnt(5)
    v_smfmac_f32_16x16x64_bf16 v[56:59], v[28:31], a[24:31], v4
    v_smfmac_f32_16x16x64_bf16 v[60:63], v[28:31], a[104:111], v4
    s_waitcnt lgkmcnt(4)
    v_smfmac_f32_16x16x64_bf16 v[56:59], v[32:35], a[32:39], v4
    v_smfmac_f32_16x16x64_bf16 v[60:63], v[32:35], a[112:119], v4
    s_waitcnt lgkmcnt(3)
    v_smfmac_f32_16x16x64_bf16 v[56:59], v[36:39], a[40:47], v4
    v_smfmac_f32_16x16x64_bf16 v[60:63], v[36:39], a[120:127], v4
    s_waitcnt lgkmcnt(2)
    v_smfmac_f32_16x16x64_bf16 v[56:59], v[44:47], a[56:63], v4
    v_smfmac_f32_16x16x64_bf16 v[60:63], v[44:47], a[136:143], v4
    s_waitcnt lgkmcnt(1)
    v_smfmac_f32_16x16x64_bf16 v[56:59], v[48:51], a[64:71], v4
    v_smfmac_f32_16x16x64_bf16 v[60:63], v[48:51], a[144:151], v4
    s_waitcnt lgkmcnt(0)
    v_smfmac_f32_16x16x64_bf16 v[56:59], v[52:55], a[72:79], v4
    v_smfmac_f32_16x16x64_bf16 v[60:63], v[52:55], a[152:159], v4
    s_branch mj_28
mw_32:
    s_waitcnt lgkmcnt(0)
    s_barrier
    ds_read_b128 v[16:19], v175 offset:0
    ds_read_b128 v[20:23], v175 offset:1024
    ds_read_b128 v[24:27], v175 offset:2048
    ds_read_b128 v[32:35], v175 offset:4096
    ds_read_b128 v[36:39], v175 offset:5120
    ds_read_b128 v[40:43], v175 offset:6144
    ds_read_b128 v[48:51], v175 offset:8192
    ds_read_b128 v[52:55], v175 offset:9216
    v_smfmac_f32_16x16x64_bf16 v[56:59], v[160:163], a[24:31], v4
    v_smfmac_f32_16x16x64_bf16 v[60:63], v[160:163], a[104:111], v4
    v_smfmac_f32_16x16x64_bf16 v[56:59], v[164:167], a[56:63], v4
    v_smfmac_f32_16x16x64_bf16 v[60:63], v[164:167], a[136:143], v4
    s_waitcnt lgkmcnt(7)
    v_smfmac_f32_16x16x64_bf16 v[56:59], v[16:19], a[0:7], v4
    v_smfmac_f32_16x16x64_bf16 v[60:63], v[16:19], a[80:87], v4
    s_waitcnt lgkmcnt(6)
    v_smfmac_f32_16x16x64_bf16 v[56:59], v[20:23], a[8:15], v4
    v_smfmac_f32_16x16x64_bf16 v[60:63], v[20:23], a[88:95], v4
    s_waitcnt lgkmcnt(5)
    v_smfmac_f32_16x16x64_bf16 v[56:59], v[24:27], a[16:23], v4
    v_smfmac_f32_16x16x64_bf16 v[60:63], v[24:27], a[96:103], v4
    s_waitcnt lgkmcnt(4)
    v_smfmac_f32_16x16x64_bf16 v[56:59], v[32:35], a[32:39], v4
    v_smfmac_f32_16x16x64_bf16 v[60:63], v[32:35], a[112:119], v4
    s_waitcnt lgkmcnt(3)
    v_smfmac_f32_16x16x64_bf16 v[56:59], v[36:39], a[40:47], v4
    v_smfmac_f32_16x16x64_bf16 v[60:63], v[36:39], a[120:127], v4
    s_waitcnt lgkmcnt(2)
    v_smfmac_f32_16x16x64_bf16 v[56:59], v[40:43], a[48:55], v4
    v_smfmac_f32_16x16x64_bf16 v[60:63], v[40:43], a[128:135], v4
    s_waitcnt lgkmcnt(1)
    v_smfmac_f32_16x16x64_bf16 v[56:59], v[48:51], a[64:71], v4
    v_smfmac_f32_16x16x64_bf16 v[60:63], v[48:51], a[144:151], v4
    s_waitcnt lgkmcnt(0)
    v_smfmac_f32_16x16x64_bf16 v[56:59], v[52:55], a[72:79], v4
    v_smfmac_f32_16x16x64_bf16 v[60:63], v[52:55], a[152:159], v4
mj_28:
    s_nop 7
    v_permlane32_swap_b32 v56, v60
    v_permlane32_swap_b32 v57, v61
    v_permlane32_swap_b32 v58, v62
    v_permlane32_swap_b32 v59, v63
    v_pk_add_f32 v[56:57], v[56:57], v[60:61]
    v_pk_add_f32 v[58:59], v[58:59], v[62:63]
    v_cvt_pk_bf16_f32 v136, v56, v57
    v_cvt_pk_bf16_f32 v137, v58, v59
    ds_write_b64 v8, v[136:137]
    s_waitcnt lgkmcnt(0)
    s_barrier

    ds_read_b64_tr_b16 v[72:73], v9 offset:0
    ds_read_b64_tr_b16 v[74:75], v9 offset:64
    ds_read_b64_tr_b16 v[76:77], v9 offset:1024
    ds_read_b64_tr_b16 v[78:79], v9 offset:1088
    s_add_u32 s68, s58, 0
    s_add_u32 s69, s58, 32768
    s_add_u32 s70, s58, 65536
    s_add_u32 s71, s58, 98304
    s_add_u32 s72, s58, 131072
    s_waitcnt lgkmcnt(0)
    v_smfmac_f32_16x16x64_bf16 v[80:83], v[72:75], a[160:167], v4
    v_smfmac_f32_16x16x64_bf16 v[84:87], v[72:75], a[176:183], v4
    v_smfmac_f32_16x16x64_bf16 v[80:83], v[76:79], a[168:175], v4
    v_smfmac_f32_16x16x64_bf16 v[84:87], v[76:79], a[184:191], v4
    v_smfmac_f32_16x16x64_bf16 v[88:91], v[72:75], a[192:199], v4
    s_nop 1
    v_smfmac_f32_16x16x64_bf16 v[92:95], v[72:75], a[208:215], v4
    s_nop 1
    v_smfmac_f32_16x16x64_bf16 v[88:91], v[76:79], a[200:207], v4
    s_nop 0
    v_permlane32_swap_b32 v80, v84
    v_smfmac_f32_16x16x64_bf16 v[92:95], v[76:79], a[216:223], v4
    v_permlane32_swap_b32 v81, v85
    v_permlane32_swap_b32 v82, v86
    v_permlane32_swap_b32 v83, v87
    v_smfmac_f32_16x16x64_bf16 v[96:99], v[72:75], a[224:231], v4
    v_pk_add_f32 v[80:81], v[80:81], v[84:85]
    v_pk_add_f32 v[82:83], v[82:83], v[86:87]
    v_cvt_pk_bf16_f32 v120, v80, v81
    v_smfmac_f32_16x16x64_bf16 v[100:103], v[72:75], a[240:247], v4
    v_cvt_pk_bf16_f32 v121, v82, v83
    buffer_store_dwordx2 v[120:121], v13, s[8:11], s68 offen sc1
    v_permlane32_swap_b32 v88, v92
    v_smfmac_f32_16x16x64_bf16 v[96:99], v[76:79], a[232:239], v4
    v_permlane32_swap_b32 v89, v93
    v_permlane32_swap_b32 v90, v94
    v_permlane32_swap_b32 v91, v95
    v_smfmac_f32_16x16x64_bf16 v[100:103], v[76:79], a[248:255], v4
    v_pk_add_f32 v[88:89], v[88:89], v[92:93]
    v_pk_add_f32 v[90:91], v[90:91], v[94:95]
    v_cvt_pk_bf16_f32 v122, v88, v89
    v_smfmac_f32_16x16x64_bf16 v[104:107], v[72:75], v[192:199], v4
    v_cvt_pk_bf16_f32 v123, v90, v91
    buffer_store_dwordx2 v[122:123], v13, s[8:11], s69 offen sc1
    v_smfmac_f32_16x16x64_bf16 v[108:111], v[72:75], v[208:215], v4
    s_nop 0
    v_permlane32_swap_b32 v96, v100
    v_smfmac_f32_16x16x64_bf16 v[104:107], v[76:79], v[200:207], v4
    v_permlane32_swap_b32 v97, v101
    v_permlane32_swap_b32 v98, v102
    v_permlane32_swap_b32 v99, v103
    v_smfmac_f32_16x16x64_bf16 v[108:111], v[76:79], v[216:223], v4
    v_pk_add_f32 v[96:97], v[96:97], v[100:101]
    v_pk_add_f32 v[98:99], v[98:99], v[102:103]
    v_cvt_pk_bf16_f32 v124, v96, v97
    v_smfmac_f32_16x16x64_bf16 v[112:115], v[72:75], v[224:231], v4
    v_cvt_pk_bf16_f32 v125, v98, v99
    buffer_store_dwordx2 v[124:125], v13, s[8:11], s70 offen sc1
    v_smfmac_f32_16x16x64_bf16 v[116:119], v[72:75], v[240:247], v4
    s_nop 0
    v_permlane32_swap_b32 v104, v108
    v_smfmac_f32_16x16x64_bf16 v[112:115], v[76:79], v[232:239], v4
    v_permlane32_swap_b32 v105, v109
    v_permlane32_swap_b32 v106, v110
    v_permlane32_swap_b32 v107, v111
    v_smfmac_f32_16x16x64_bf16 v[116:119], v[76:79], v[248:255], v4
    v_pk_add_f32 v[104:105], v[104:105], v[108:109]
    v_pk_add_f32 v[106:107], v[106:107], v[110:111]
    v_cvt_pk_bf16_f32 v126, v104, v105
    v_cvt_pk_bf16_f32 v127, v106, v107
    buffer_store_dwordx2 v[126:127], v13, s[8:11], s71 offen sc1
    s_nop 2
    v_permlane32_swap_b32 v112, v116
    v_permlane32_swap_b32 v113, v117
    v_permlane32_swap_b32 v114, v118
    v_permlane32_swap_b32 v115, v119
    v_pk_add_f32 v[112:113], v[112:113], v[116:117]
    v_pk_add_f32 v[114:115], v[114:115], v[118:119]
    v_cvt_pk_bf16_f32 v128, v112, v113
    v_cvt_pk_bf16_f32 v129, v114, v115
    buffer_store_dwordx2 v[128:129], v13, s[8:11], s72 offen sc1
    s_cmp_eq_u32 s29, 63
    s_cbranch_scc1 vm_nohold
    s_sleep 12
vm_nohold:

    buffer_store_dwordx2 v[120:121], v12, s[8:11], s57 offen offset:0 sc1
    buffer_store_dwordx2 v[122:123], v12, s[8:11], s57 offen offset:512 sc1
    buffer_store_dwordx2 v[124:125], v12, s[8:11], s57 offen offset:1024 sc1
    buffer_store_dwordx2 v[126:127], v12, s[8:11], s57 offen offset:1536 sc1
    buffer_store_dwordx2 v[128:129], v12, s[8:11], s57 offen offset:2048 sc1
    s_add_u32 s40, s65, s67
    buffer_store_dwordx2 v[132:133], v13, s[8:11], s40 offen sc1
    s_add_u32 s40, s40, 32768
    buffer_store_dwordx2 v[132:133], v13, s[8:11], s40 offen sc1
    s_add_u32 s40, s40, 32768
    buffer_store_dwordx2 v[132:133], v13, s[8:11], s40 offen sc1
    s_add_u32 s40, s40, 32768
    buffer_store_dwordx2 v[132:133], v13, s[8:11], s40 offen sc1
    s_add_u32 s40, s40, 32768
    buffer_store_dwordx2 v[132:133], v13, s[8:11], s40 offen sc1
    s_add_u32 s40, s40, 32768
    s_add_u32 s57, s57, 327680
    s_mov_b32 s67, s66
    s_add_u32 s66, s66, 655360
    s_cmp_ge_u32 s66, 1966080
    s_cselect_b32 s66, 0, s66
    s_add_u32 s40, s29, 1
    v_mov_b32 v134, s40

    s_waitcnt vmcnt(5)
    s_mov_b64 exec, 1
    buffer_store_dword v134, off, s[8:11], s61 sc1
    s_mov_b64 exec, -1

    s_add_u32 s29, s29, 1
    s_cmp_lt_u32 s29, 64
    s_cbranch_scc1 vm_loop
    s_waitcnt vmcnt(0)
    s_mov_b64 exec, 1
    buffer_store_dword v134, off, s[8:11], s61 sc1
    s_endpgm

role_u:
    s_sub_u32 s28, s28, 64
    v_bfe_u32 v10, v2, 3, 1
    v_and_b32 v11, 7, v2
    v_lshrrev_b32 v12, 4, v2
    v_lshrrev_b32 v13, 1, v12
    v_and_b32 v14, 1, v12
    s_mul_i32 s40, s3, 16384
    v_mul_u32_u24 v15, 640, v10
    v_add_u32 v15, s40, v15
    v_lshl_add_u32 v15, v13, 8, v15
    v_lshl_add_u32 v15, v11, 5, v15
    v_lshl_add_u32 v8, v14, 4, v15
    v_lshl_add_u32 v15, v13, 2, v14
    v_mul_u32_u24 v15, 640, v15
    v_add_u32 v15, s40, v15
    v_lshl_add_u32 v15, v10, 6, v15
    v_lshl_add_u32 v15, v11, 3, v15
    v_add_u32 v9, 512, v15
    s_mul_i32 s40, s3, 2048
    v_mul_u32_u24 v15, 256, v13
    v_add_u32 v15, s40, v15
    v_lshl_add_u32 v15, v14, 7, v15
    v_and_b32 v11, 15, v2
    v_lshl_add_u32 v140, v11, 3, v15

    s_lshl_b32 s40, s3, 9
    v_lshlrev_b32 v12, 3, v2
    v_add_u32 v12, s40, v12
    v_bfe_u32 v10, v2, 2, 1
    v_lshlrev_b32 v10, 5, v10
    v_bfe_u32 v11, v2, 4, 1
    v_lshl_add_u32 v10, v11, 4, v10
    v_lshrrev_b32 v11, 5, v2
    v_lshl_add_u32 v10, v11, 3, v10
    v_and_b32 v11, 3, v2
    v_lshl_add_u32 v10, v11, 1, v10
    v_lshlrev_b32 v10, 3, v10
    v_bfe_u32 v11, v2, 3, 1
    v_lshl_add_u32 v13, v11, 2, v10
    v_add_u32 v14, 1024, v13
    v_lshlrev_b32 v15, 2, v2
    v_lshlrev_b32 v133, 7, v2
    v_mov_b32 v123, 0
    s_mul_i32 s33, s3, 327680
    s_lshl_b32 s40, s28, 10
    s_add_u32 s33, s33, s40
    s_add_u32 s33, s33, 0x8000000
    s_lshl_b32 s34, s3, 10
    s_add_u32 s34, s34, 0x12000
    v_mov_b32 v134, -1

    s_cmp_lg_u32 s3, 0
    s_cbranch_scc1 dwg_33

dw_34:
    buffer_load_dword v135, off, s[12:15], 0 offset:160 sc1
    s_waitcnt vmcnt(0)
    v_readfirstlane_b32 s44, v135
    s_sub_u32 s30, s30, 1
    s_cmp_lt_i32 s30, 0
    s_cbranch_scc1 dwd_35
    s_cmp_ge_u32 s44, 1
    s_cbranch_scc1 dwd_35
    s_sleep 6
    s_branch dw_34

dwd_35:
dw_36:
    buffer_load_dword v135, off, s[12:15], 0 offset:176 sc1
    s_waitcnt vmcnt(0)
    v_readfirstlane_b32 s44, v135
    s_sub_u32 s30, s30, 1
    s_cmp_lt_i32 s30, 0
    s_cbranch_scc1 dwd_37
    s_cmp_ge_u32 s44, 1
    s_cbranch_scc1 dwd_37
    s_sleep 6
    s_branch dw_36

dwd_37:
dw_38:
    buffer_load_dword v135, off, s[12:15], 0 offset:180 sc1
    s_waitcnt vmcnt(0)
    v_readfirstlane_b32 s44, v135
    s_sub_u32 s30, s30, 1
    s_cmp_lt_i32 s30, 0
    s_cbranch_scc1 dwd_39
    s_cmp_ge_u32 s44, 1
    s_cbranch_scc1 dwd_39
    s_sleep 6
    s_branch dw_38

dwd_39:
dwg_33:
    s_barrier
    buffer_load_dwordx2 v[184:185], off, s[12:15], 0 offset:176 sc1
    s_waitcnt vmcnt(0)
    v_readfirstlane_b32 s98, v184
    v_readfirstlane_b32 s99, v185
    s_nop 3
    s_and_b32 s98, s98, 2
    s_lshl_b32 s98, s98, 12
    s_and_b32 s99, s99, 2
    s_lshl_b32 s99, s99, 12
    v_add_u32 v187, 16384, v5

    s_add_u32 s60, s99, 0x6280000
    s_add_u32 s64, s99, 0x6210000
    s_lshl_b32 s65, s28, 8
    s_cmp_ge_u32 s28, 32
    s_cselect_b32 s40, 8192, 0
    s_add_u32 s65, s65, s40
    s_add_u32 s65, s65, s99
    s_add_u32 s65, s65, 0x6200000
    s_lshl_b32 s57, s28, 14
    s_add_u32 s57, s57, s98
    s_add_u32 s57, s57, 0x6000000
    s_mov_b32 s66, 0

u_loop:
    s_and_b32 s40, s29, 3
    s_lshl_b32 s40, s40, 17
    s_add_u32 s32, s40, s64
    s_xor_b32 s41, s40, 0x40000
    s_add_u32 s41, s41, s65
    s_add_u32 s40, s29, 1
    s_and_b32 s40, s40, 3
    s_lshl_b32 s40, s40, 17
    s_add_u32 s31, s40, s65
    s_cmp_lg_u32 s3, 1
    s_cbranch_scc1 u_noarm
    buffer_store_dword v134, v15, s[8:11], s41 offen sc1
    s_add_u32 s41, s41, 32768
    buffer_store_dword v134, v15, s[8:11], s41 offen sc1
u_noarm:

    s_add_u32 s36, s29, 1
    s_mov_b64 exec, 255
    v_cmp_gt_u32 vcc, s36, v123
    s_mov_b64 exec, -1
    s_cbranch_vccz u_vok

wa_40:
    s_mov_b32 exec_lo, 0xff
    s_mov_b32 exec_hi, 0
    buffer_load_dword v123, v133, s[8:11], s34 offen sc1
    s_waitcnt vmcnt(0)

    v_cmp_gt_u32 vcc, s36, v123
    s_mov_b64 exec, -1
    s_cbranch_vccz wad_41
    s_sub_u32 s30, s30, 1
    s_cmp_lt_i32 s30, 0
    s_cbranch_scc1 wad_41
    s_sleep 4
    s_branch wa_40

wad_41:
u_vok:
    s_mov_b32 s40, s33
    buffer_load_dwordx4 v[16:19], v5, s[8:11], s40 offen sc1
    s_add_u32 s40, s40, 40960
    buffer_load_dwordx4 v[20:23], v5, s[8:11], s40 offen sc1
    s_add_u32 s40, s40, 40960
    buffer_load_dwordx4 v[24:27], v5, s[8:11], s40 offen sc1
    s_add_u32 s40, s40, 40960
    buffer_load_dwordx4 v[28:31], v5, s[8:11], s40 offen sc1
    s_add_u32 s40, s40, 40960
    buffer_load_dwordx4 v[32:35], v5, s[8:11], s40 offen sc1
    s_add_u32 s40, s40, 40960
    buffer_load_dwordx4 v[36:39], v5, s[8:11], s40 offen sc1
    s_add_u32 s40, s40, 40960
    buffer_load_dwordx4 v[40:43], v5, s[8:11], s40 offen sc1
    s_add_u32 s40, s40, 40960
    buffer_load_dwordx4 v[44:47], v5, s[8:11], s40 offen sc1
    s_add_u32 s40, s40, 40960
    s_mov_b64 exec, 255
    buffer_load_dword v123, v133, s[8:11], s34 offen sc1
    s_mov_b64 exec, -1
    s_add_u32 s58, s57, s66
    s_add_u32 s66, s66, 655360
    s_cmp_ge_u32 s66, 1966080
    s_cselect_b32 s66, 0, s66
    s_waitcnt vmcnt(0)

    v_mov_b32 v48, v16
    v_mov_b32 v50, v17
    v_mov_b32 v52, v18
    v_mov_b32 v54, v19
    v_mov_b32 v49, v20
    v_mov_b32 v51, v21
    v_mov_b32 v53, v22
    v_mov_b32 v55, v23
    v_mov_b32 v56, v24
    v_mov_b32 v58, v25
    v_mov_b32 v60, v26
    v_mov_b32 v62, v27
    v_mov_b32 v57, v28
    v_mov_b32 v59, v29
    v_mov_b32 v61, v30
    v_mov_b32 v63, v31
    v_mov_b32 v64, v32
    v_mov_b32 v66, v33
    v_mov_b32 v68, v34
    v_mov_b32 v70, v35
    v_mov_b32 v65, v36
    v_mov_b32 v67, v37
    v_mov_b32 v69, v38
    v_mov_b32 v71, v39
    v_mov_b32 v72, v40
    v_mov_b32 v74, v41
    v_mov_b32 v76, v42
    v_mov_b32 v78, v43
    v_mov_b32 v73, v44
    v_mov_b32 v75, v45
    v_mov_b32 v77, v46
    v_mov_b32 v79, v47
    s_cmp_lg_u32 s3, 0
    s_cbranch_scc1 u_dsync

    buffer_load_dword v124, off, s[8:11], s60 sc1
    s_sleep 1
    buffer_load_dword v125, off, s[8:11], s60 sc1
    s_sleep 1
    buffer_load_dword v126, off, s[8:11], s60 sc1
    s_sleep 1
u_dspin:
    buffer_load_dword v127, off, s[8:11], s60 sc1
    s_waitcnt vmcnt(3)
    v_cmp_le_u32 vcc, s36, v124
    s_cbranch_vccnz u_ddone
    s_nop 7

    buffer_load_dword v124, off, s[8:11], s60 sc1
    s_waitcnt vmcnt(3)
    v_cmp_le_u32 vcc, s36, v125
    s_cbranch_vccnz u_ddone
    s_nop 7

    buffer_load_dword v125, off, s[8:11], s60 sc1
    s_waitcnt vmcnt(3)
    v_cmp_le_u32 vcc, s36, v126
    s_cbranch_vccnz u_ddone
    s_nop 7

    buffer_load_dword v126, off, s[8:11], s60 sc1
    s_waitcnt vmcnt(3)
    v_cmp_le_u32 vcc, s36, v127
    s_cbranch_vccnz u_ddone
    s_nop 7

    s_sub_u32 s30, s30, 1
    s_cmp_ge_i32 s30, 0
    s_cbranch_scc1 u_dspin

u_ddone:
    s_sleep 11
u_dsync:
    s_barrier
u_ppoll:
    buffer_load_dwordx4 v[80:83], v8, s[8:11], s32 offen offset:0 sc1
    buffer_load_dwordx4 v[84:87], v8, s[8:11], s32 offen offset:1280 sc1
    buffer_load_dwordx4 v[88:91], v8, s[8:11], s32 offen offset:2560 sc1
    buffer_load_dwordx4 v[92:95], v8, s[8:11], s32 offen offset:3840 sc1
    buffer_load_dwordx2 v[96:97], v9, s[8:11], s32 offen offset:0 sc1
    buffer_load_dwordx2 v[98:99], v9, s[8:11], s32 offen offset:1280 sc1
    buffer_load_dwordx2 v[104:105], v140, s[8:11], s58 offen offset:0 sc1
    buffer_load_dwordx2 v[106:107], v140, s[8:11], s58 offen offset:512 sc1
    buffer_load_dwordx2 v[108:109], v140, s[8:11], s58 offen offset:1024 sc1
    buffer_load_dwordx2 v[110:111], v140, s[8:11], s58 offen offset:1536 sc1
    v_mov_b32 v112, 0
    v_mov_b32 v113, 0
    v_mov_b32 v114, 0
    v_mov_b32 v115, 0
    v_mov_b32 v122, 0
    s_waitcnt vmcnt(9)
    v_smfmac_f32_16x16x64_bf16 v[112:115], v[80:83], v[48:55], v4
    v_max3_u32 v122, v122, v80, v81
    v_max3_u32 v122, v122, v82, v83
    s_waitcnt vmcnt(8)
    v_smfmac_f32_16x16x64_bf16 v[112:115], v[84:87], v[56:63], v4
    v_max3_u32 v122, v122, v84, v85
    v_max3_u32 v122, v122, v86, v87
    s_waitcnt vmcnt(7)
    v_smfmac_f32_16x16x64_bf16 v[112:115], v[88:91], v[64:71], v4
    v_max3_u32 v122, v122, v88, v89
    v_max3_u32 v122, v122, v90, v91
    s_waitcnt vmcnt(6)
    v_smfmac_f32_16x16x64_bf16 v[112:115], v[92:95], v[72:79], v4
    v_max3_u32 v122, v122, v92, v93
    v_max3_u32 v122, v122, v94, v95
    v_cmp_eq_u32 vcc, -1, v122
    s_cbranch_vccz pok_42
    s_sub_u32 s30, s30, 1
    s_cmp_lt_i32 s30, 0
    s_cbranch_scc1 pok_42
    s_sleep 1
    s_branch u_ppoll

pok_42:
u_mchk:
    s_waitcnt vmcnt(4)
    v_swap_b32 v97, v98
    v_max3_u32 v122, v96, v97, v98
    v_max_u32 v122, v122, v99
    s_waitcnt vmcnt(2)
    v_max3_u32 v122, v122, v104, v105
    v_max3_u32 v122, v122, v106, v107
    s_waitcnt vmcnt(0)
    v_max3_u32 v122, v122, v108, v109
    v_max3_u32 v122, v122, v110, v111
    v_cmp_eq_u32 vcc, -1, v122
    s_cbranch_vccnz u_mretry
u_mok:
    v_smfmac_f32_16x16x64_bf16 v[112:115], v[96:99], v[104:111], v4

    s_nop 1
    s_nop 5
    v_permlane32_swap_b32 v112, v113
    v_permlane32_swap_b32 v114, v115
    v_add_f32 v112, v112, v113
    v_add_f32 v113, v114, v115
    ds_write_b64 v12, v[112:113]
    s_waitcnt lgkmcnt(0)
    s_barrier
    s_cmp_lg_u32 s3, 0
    s_cbranch_scc1 u_next
    ds_read2_b32 v[124:125], v13 offset0:0 offset1:2
    ds_read2_b32 v[126:127], v13 offset0:128 offset1:130
    ds_read2_b32 v[128:129], v14 offset0:0 offset1:2
    ds_read2_b32 v[130:131], v14 offset0:128 offset1:130
    s_add_u32 s40, s31, 32768
    s_waitcnt lgkmcnt(2)
    v_add_f32 v124, v124, v126
    v_add_f32 v125, v125, v127
    s_waitcnt lgkmcnt(0)
    v_add_f32 v128, v128, v130
    v_add_f32 v129, v129, v131
    v_add_f32 v124, v124, v128
    v_add_f32 v125, v125, v129
    v_cvt_pk_bf16_f32 v124, v124, v125
    v_min_u32 v124, -2, v124
    buffer_store_dword v124, v15, s[8:11], s31 offen sc1
    buffer_store_dword v124, v15, s[8:11], s40 offen sc1

u_next:
    s_add_u32 s33, s33, 1310720
    s_add_u32 s29, s29, 1
    s_cmp_lt_u32 s29, 63
    s_cbranch_scc1 u_loop
    s_endpgm

u_mretry:
    s_sub_u32 s30, s30, 1
    s_cmp_lt_i32 s30, 0
    s_cbranch_scc1 u_mok

    buffer_load_dwordx2 v[96:97], v9, s[8:11], s32 offen offset:0 sc1
    buffer_load_dwordx2 v[98:99], v9, s[8:11], s32 offen offset:1280 sc1
    buffer_load_dwordx2 v[104:105], v140, s[8:11], s58 offen offset:0 sc1
    buffer_load_dwordx2 v[106:107], v140, s[8:11], s58 offen offset:512 sc1
    buffer_load_dwordx2 v[108:109], v140, s[8:11], s58 offen offset:1024 sc1
    buffer_load_dwordx2 v[110:111], v140, s[8:11], s58 offen offset:1536 sc1
    s_branch u_mchk
role_t:
    s_sub_u32 s28, s28, 112
    s_mov_b32 s37, 0x2400000
    s_mov_b32 s38, 0

    v_lshrrev_b32 v10, 4, v2
    v_and_b32 v11, 15, v2
    v_and_b32 v12, 1, v10
    s_lshl_b32 s40, s3, 1
    v_or_b32 v12, s40, v12
    v_lshlrev_b32 v12, 1, v12
    v_xor_b32 v11, v11, v12
    v_lshlrev_b32 v11, 4, v11
    s_lshl_b32 s40, s3, 2
    v_add_u32 v12, s40, v10
    v_lshl_add_u32 v11, v12, 13, v11
    s_lshl_b32 s41, s28, 8
    s_lshl_b32 s42, s3, 10
    v_bfe_u32 v12, v2, 2, 2
    v_and_b32 v13, 3, v2
    v_lshrrev_b32 v14, 1, v10
    v_lshlrev_b32 v14, 4, v14
    v_and_b32 v15, 1, v10
    v_lshl_add_u32 v14, v15, 2, v14
    v_and_b32 v16, 1, v12
    v_add_u32 v14, v14, v16
    v_lshrrev_b32 v17, 1, v12
    v_lshl_add_u32 v14, v17, 3, v14
    v_lshlrev_b32 v14, 8, v14
    v_lshl_add_u32 v14, v13, 3, v14
    v_lshl_or_b32 v16, v15, 1, v16
    v_lshl_or_b32 v16, v17, 2, v16
    v_lshl_or_b32 v14, v16, 5, v14
    s_lshl_b32 s40, s3, 6
    v_xor_b32 v18, s40, v14
    v_xor_b32 v19, 32, v18
    v_add_u32 v20, 0x10000, v18
    v_add_u32 v21, 0x10000, v19

    s_add_u32 s43, s42, 0
    s_mov_b32 m0, s43
    s_add_u32 s44, s41, 0
    buffer_load_dwordx4 v11, s[16:19], s44 offen lds

    s_add_u32 s43, s42, 4096
    s_mov_b32 m0, s43
    s_add_u32 s44, s41, 131072
    buffer_load_dwordx4 v11, s[16:19], s44 offen lds

    s_add_u32 s43, s42, 8192
    s_mov_b32 m0, s43
    s_add_u32 s44, s41, 262144
    buffer_load_dwordx4 v11, s[16:19], s44 offen lds

    s_add_u32 s43, s42, 12288
    s_mov_b32 m0, s43
    s_add_u32 s44, s41, 393216
    buffer_load_dwordx4 v11, s[16:19], s44 offen lds

    s_add_u32 s43, s42, 16384
    s_mov_b32 m0, s43
    s_add_u32 s44, s41, 0
    buffer_load_dwordx4 v11, s[20:23], s44 offen lds

    s_add_u32 s43, s42, 20480
    s_mov_b32 m0, s43
    s_add_u32 s44, s41, 131072
    buffer_load_dwordx4 v11, s[20:23], s44 offen lds

    s_add_u32 s43, s42, 24576
    s_mov_b32 m0, s43
    s_add_u32 s44, s41, 262144
    buffer_load_dwordx4 v11, s[20:23], s44 offen lds

    s_add_u32 s43, s42, 28672
    s_mov_b32 m0, s43
    s_add_u32 s44, s41, 393216
    buffer_load_dwordx4 v11, s[20:23], s44 offen lds

    s_add_u32 s43, s42, 32768
    s_mov_b32 m0, s43
    s_add_u32 s44, s41, 524288
    buffer_load_dwordx4 v11, s[16:19], s44 offen lds

    s_add_u32 s43, s42, 36864
    s_mov_b32 m0, s43
    s_add_u32 s44, s41, 655360
    buffer_load_dwordx4 v11, s[16:19], s44 offen lds

    s_add_u32 s43, s42, 40960
    s_mov_b32 m0, s43
    s_add_u32 s44, s41, 786432
    buffer_load_dwordx4 v11, s[16:19], s44 offen lds

    s_add_u32 s43, s42, 45056
    s_mov_b32 m0, s43
    s_add_u32 s44, s41, 917504
    buffer_load_dwordx4 v11, s[16:19], s44 offen lds

    s_add_u32 s43, s42, 49152
    s_mov_b32 m0, s43
    s_add_u32 s44, s41, 524288
    buffer_load_dwordx4 v11, s[20:23], s44 offen lds

    s_add_u32 s43, s42, 53248
    s_mov_b32 m0, s43
    s_add_u32 s44, s41, 655360
    buffer_load_dwordx4 v11, s[20:23], s44 offen lds

    s_add_u32 s43, s42, 57344
    s_mov_b32 m0, s43
    s_add_u32 s44, s41, 786432
    buffer_load_dwordx4 v11, s[20:23], s44 offen lds

    s_add_u32 s43, s42, 61440
    s_mov_b32 m0, s43
    s_add_u32 s44, s41, 917504
    buffer_load_dwordx4 v11, s[20:23], s44 offen lds

    s_waitcnt vmcnt(8)
    s_barrier
    s_add_u32 s43, s42, 65536
    s_mov_b32 m0, s43
    s_add_u32 s44, s41, 1048576
    buffer_load_dwordx4 v11, s[16:19], s44 offen lds

    s_add_u32 s43, s42, 69632
    s_mov_b32 m0, s43
    s_add_u32 s44, s41, 1179648
    buffer_load_dwordx4 v11, s[16:19], s44 offen lds

    s_add_u32 s43, s42, 73728
    s_mov_b32 m0, s43
    s_add_u32 s44, s41, 1310720
    buffer_load_dwordx4 v11, s[16:19], s44 offen lds

    s_add_u32 s43, s42, 77824
    s_mov_b32 m0, s43
    s_add_u32 s44, s41, 1441792
    buffer_load_dwordx4 v11, s[16:19], s44 offen lds

    s_add_u32 s43, s42, 81920
    s_mov_b32 m0, s43
    s_add_u32 s44, s41, 1048576
    buffer_load_dwordx4 v11, s[20:23], s44 offen lds

    s_add_u32 s43, s42, 86016
    s_mov_b32 m0, s43
    s_add_u32 s44, s41, 1179648
    buffer_load_dwordx4 v11, s[20:23], s44 offen lds

    s_add_u32 s43, s42, 90112
    s_mov_b32 m0, s43
    s_add_u32 s44, s41, 1310720
    buffer_load_dwordx4 v11, s[20:23], s44 offen lds

    s_add_u32 s43, s42, 94208
    s_mov_b32 m0, s43
    s_add_u32 s44, s41, 1441792
    buffer_load_dwordx4 v11, s[20:23], s44 offen lds

    ds_read_b64_tr_b16 a[0:1], v18 offset:0
    ds_read_b64_tr_b16 a[2:3], v18 offset:512
    ds_read_b64_tr_b16 a[4:5], v18 offset:8192
    ds_read_b64_tr_b16 a[6:7], v18 offset:8704
    ds_read_b64_tr_b16 a[80:81], v19 offset:0
    ds_read_b64_tr_b16 a[82:83], v19 offset:512
    ds_read_b64_tr_b16 a[84:85], v19 offset:8192
    ds_read_b64_tr_b16 a[86:87], v19 offset:8704
    s_waitcnt lgkmcnt(0)
    ds_read_b64_tr_b16 a[160:161], v18 offset:16384
    ds_read_b64_tr_b16 a[162:163], v18 offset:16896
    ds_read_b64_tr_b16 a[164:165], v18 offset:24576
    ds_read_b64_tr_b16 a[166:167], v18 offset:25088
    ds_read_b64_tr_b16 a[240:241], v19 offset:16384
    ds_read_b64_tr_b16 a[242:243], v19 offset:16896
    ds_read_b64_tr_b16 a[244:245], v19 offset:24576
    ds_read_b64_tr_b16 a[246:247], v19 offset:25088
    s_waitcnt lgkmcnt(0)
    s_waitcnt vmcnt(8)
    s_barrier
    s_add_u32 s43, s42, 98304
    s_mov_b32 m0, s43
    s_add_u32 s44, s41, 1572864
    buffer_load_dwordx4 v11, s[16:19], s44 offen lds

    s_add_u32 s43, s42, 102400
    s_mov_b32 m0, s43
    s_add_u32 s44, s41, 1703936
    buffer_load_dwordx4 v11, s[16:19], s44 offen lds

    s_add_u32 s43, s42, 106496
    s_mov_b32 m0, s43
    s_add_u32 s44, s41, 1835008
    buffer_load_dwordx4 v11, s[16:19], s44 offen lds

    s_add_u32 s43, s42, 110592
    s_mov_b32 m0, s43
    s_add_u32 s44, s41, 1966080
    buffer_load_dwordx4 v11, s[16:19], s44 offen lds

    s_add_u32 s43, s42, 114688
    s_mov_b32 m0, s43
    s_add_u32 s44, s41, 1572864
    buffer_load_dwordx4 v11, s[20:23], s44 offen lds

    s_add_u32 s43, s42, 118784
    s_mov_b32 m0, s43
    s_add_u32 s44, s41, 1703936
    buffer_load_dwordx4 v11, s[20:23], s44 offen lds

    s_add_u32 s43, s42, 122880
    s_mov_b32 m0, s43
    s_add_u32 s44, s41, 1835008
    buffer_load_dwordx4 v11, s[20:23], s44 offen lds

    s_add_u32 s43, s42, 126976
    s_mov_b32 m0, s43
    s_add_u32 s44, s41, 1966080
    buffer_load_dwordx4 v11, s[20:23], s44 offen lds

    ds_read_b64_tr_b16 a[8:9], v18 offset:32768
    ds_read_b64_tr_b16 a[10:11], v18 offset:33280
    ds_read_b64_tr_b16 a[12:13], v18 offset:40960
    ds_read_b64_tr_b16 a[14:15], v18 offset:41472
    ds_read_b64_tr_b16 a[88:89], v19 offset:32768
    ds_read_b64_tr_b16 a[90:91], v19 offset:33280
    ds_read_b64_tr_b16 a[92:93], v19 offset:40960
    ds_read_b64_tr_b16 a[94:95], v19 offset:41472
    s_waitcnt lgkmcnt(0)
    ds_read_b64_tr_b16 a[168:169], v18 offset:49152
    ds_read_b64_tr_b16 a[170:171], v18 offset:49664
    ds_read_b64_tr_b16 a[172:173], v18 offset:57344
    ds_read_b64_tr_b16 a[174:175], v18 offset:57856
    ds_read_b64_tr_b16 a[248:249], v19 offset:49152
    ds_read_b64_tr_b16 a[250:251], v19 offset:49664
    ds_read_b64_tr_b16 a[252:253], v19 offset:57344
    ds_read_b64_tr_b16 a[254:255], v19 offset:57856
    s_waitcnt lgkmcnt(0)
    s_waitcnt vmcnt(8)
    s_barrier
    s_add_u32 s43, s42, 0
    s_mov_b32 m0, s43
    s_add_u32 s44, s41, 2097152
    buffer_load_dwordx4 v11, s[16:19], s44 offen lds

    s_add_u32 s43, s42, 4096
    s_mov_b32 m0, s43
    s_add_u32 s44, s41, 2228224
    buffer_load_dwordx4 v11, s[16:19], s44 offen lds

    s_add_u32 s43, s42, 8192
    s_mov_b32 m0, s43
    s_add_u32 s44, s41, 2359296
    buffer_load_dwordx4 v11, s[16:19], s44 offen lds

    s_add_u32 s43, s42, 12288
    s_mov_b32 m0, s43
    s_add_u32 s44, s41, 2490368
    buffer_load_dwordx4 v11, s[16:19], s44 offen lds

    s_add_u32 s43, s42, 16384
    s_mov_b32 m0, s43
    s_add_u32 s44, s41, 2097152
    buffer_load_dwordx4 v11, s[20:23], s44 offen lds

    s_add_u32 s43, s42, 20480
    s_mov_b32 m0, s43
    s_add_u32 s44, s41, 2228224
    buffer_load_dwordx4 v11, s[20:23], s44 offen lds

    s_add_u32 s43, s42, 24576
    s_mov_b32 m0, s43
    s_add_u32 s44, s41, 2359296
    buffer_load_dwordx4 v11, s[20:23], s44 offen lds

    s_add_u32 s43, s42, 28672
    s_mov_b32 m0, s43
    s_add_u32 s44, s41, 2490368
    buffer_load_dwordx4 v11, s[20:23], s44 offen lds

    ds_read_b64_tr_b16 a[16:17], v20 offset:0
    ds_read_b64_tr_b16 a[18:19], v20 offset:512
    ds_read_b64_tr_b16 a[20:21], v20 offset:8192
    ds_read_b64_tr_b16 a[22:23], v20 offset:8704
    ds_read_b64_tr_b16 a[96:97], v21 offset:0
    ds_read_b64_tr_b16 a[98:99], v21 offset:512
    ds_read_b64_tr_b16 a[100:101], v21 offset:8192
    ds_read_b64_tr_b16 a[102:103], v21 offset:8704
    s_waitcnt lgkmcnt(0)
    ds_read_b64_tr_b16 a[176:177], v20 offset:16384
    ds_read_b64_tr_b16 a[178:179], v20 offset:16896
    ds_read_b64_tr_b16 a[180:181], v20 offset:24576
    ds_read_b64_tr_b16 a[182:183], v20 offset:25088
    ds_read_b64_tr_b16 v[192:193], v21 offset:16384
    ds_read_b64_tr_b16 v[194:195], v21 offset:16896
    ds_read_b64_tr_b16 v[196:197], v21 offset:24576
    ds_read_b64_tr_b16 v[198:199], v21 offset:25088
    s_waitcnt lgkmcnt(0)
    s_waitcnt vmcnt(8)
    s_barrier
    s_add_u32 s43, s42, 32768
    s_mov_b32 m0, s43
    s_add_u32 s44, s41, 2621440
    buffer_load_dwordx4 v11, s[16:19], s44 offen lds

    s_add_u32 s43, s42, 36864
    s_mov_b32 m0, s43
    s_add_u32 s44, s41, 2752512
    buffer_load_dwordx4 v11, s[16:19], s44 offen lds

    s_add_u32 s43, s42, 40960
    s_mov_b32 m0, s43
    s_add_u32 s44, s41, 2883584
    buffer_load_dwordx4 v11, s[16:19], s44 offen lds

    s_add_u32 s43, s42, 45056
    s_mov_b32 m0, s43
    s_add_u32 s44, s41, 3014656
    buffer_load_dwordx4 v11, s[16:19], s44 offen lds

    s_add_u32 s43, s42, 49152
    s_mov_b32 m0, s43
    s_add_u32 s44, s41, 2621440
    buffer_load_dwordx4 v11, s[20:23], s44 offen lds

    s_add_u32 s43, s42, 53248
    s_mov_b32 m0, s43
    s_add_u32 s44, s41, 2752512
    buffer_load_dwordx4 v11, s[20:23], s44 offen lds

    s_add_u32 s43, s42, 57344
    s_mov_b32 m0, s43
    s_add_u32 s44, s41, 2883584
    buffer_load_dwordx4 v11, s[20:23], s44 offen lds

    s_add_u32 s43, s42, 61440
    s_mov_b32 m0, s43
    s_add_u32 s44, s41, 3014656
    buffer_load_dwordx4 v11, s[20:23], s44 offen lds

    ds_read_b64_tr_b16 a[24:25], v20 offset:32768
    ds_read_b64_tr_b16 a[26:27], v20 offset:33280
    ds_read_b64_tr_b16 a[28:29], v20 offset:40960
    ds_read_b64_tr_b16 a[30:31], v20 offset:41472
    ds_read_b64_tr_b16 a[104:105], v21 offset:32768
    ds_read_b64_tr_b16 a[106:107], v21 offset:33280
    ds_read_b64_tr_b16 a[108:109], v21 offset:40960
    ds_read_b64_tr_b16 a[110:111], v21 offset:41472
    s_waitcnt lgkmcnt(0)
    ds_read_b64_tr_b16 a[184:185], v20 offset:49152
    ds_read_b64_tr_b16 a[186:187], v20 offset:49664
    ds_read_b64_tr_b16 a[188:189], v20 offset:57344
    ds_read_b64_tr_b16 a[190:191], v20 offset:57856
    ds_read_b64_tr_b16 v[200:201], v21 offset:49152
    ds_read_b64_tr_b16 v[202:203], v21 offset:49664
    ds_read_b64_tr_b16 v[204:205], v21 offset:57344
    ds_read_b64_tr_b16 v[206:207], v21 offset:57856
    s_waitcnt lgkmcnt(0)
    s_waitcnt vmcnt(8)
    s_barrier
    s_add_u32 s43, s42, 65536
    s_mov_b32 m0, s43
    s_add_u32 s44, s41, 3145728
    buffer_load_dwordx4 v11, s[16:19], s44 offen lds

    s_add_u32 s43, s42, 69632
    s_mov_b32 m0, s43
    s_add_u32 s44, s41, 3276800
    buffer_load_dwordx4 v11, s[16:19], s44 offen lds

    s_add_u32 s43, s42, 73728
    s_mov_b32 m0, s43
    s_add_u32 s44, s41, 3407872
    buffer_load_dwordx4 v11, s[16:19], s44 offen lds

    s_add_u32 s43, s42, 77824
    s_mov_b32 m0, s43
    s_add_u32 s44, s41, 3538944
    buffer_load_dwordx4 v11, s[16:19], s44 offen lds

    s_add_u32 s43, s42, 81920
    s_mov_b32 m0, s43
    s_add_u32 s44, s41, 3145728
    buffer_load_dwordx4 v11, s[20:23], s44 offen lds

    s_add_u32 s43, s42, 86016
    s_mov_b32 m0, s43
    s_add_u32 s44, s41, 3276800
    buffer_load_dwordx4 v11, s[20:23], s44 offen lds

    s_add_u32 s43, s42, 90112
    s_mov_b32 m0, s43
    s_add_u32 s44, s41, 3407872
    buffer_load_dwordx4 v11, s[20:23], s44 offen lds

    s_add_u32 s43, s42, 94208
    s_mov_b32 m0, s43
    s_add_u32 s44, s41, 3538944
    buffer_load_dwordx4 v11, s[20:23], s44 offen lds

    ds_read_b64_tr_b16 a[32:33], v18 offset:0
    ds_read_b64_tr_b16 a[34:35], v18 offset:512
    ds_read_b64_tr_b16 a[36:37], v18 offset:8192
    ds_read_b64_tr_b16 a[38:39], v18 offset:8704
    ds_read_b64_tr_b16 a[112:113], v19 offset:0
    ds_read_b64_tr_b16 a[114:115], v19 offset:512
    ds_read_b64_tr_b16 a[116:117], v19 offset:8192
    ds_read_b64_tr_b16 a[118:119], v19 offset:8704
    s_waitcnt lgkmcnt(0)
    ds_read_b64_tr_b16 a[192:193], v18 offset:16384
    ds_read_b64_tr_b16 a[194:195], v18 offset:16896
    ds_read_b64_tr_b16 a[196:197], v18 offset:24576
    ds_read_b64_tr_b16 a[198:199], v18 offset:25088
    ds_read_b64_tr_b16 v[208:209], v19 offset:16384
    ds_read_b64_tr_b16 v[210:211], v19 offset:16896
    ds_read_b64_tr_b16 v[212:213], v19 offset:24576
    ds_read_b64_tr_b16 v[214:215], v19 offset:25088
    s_waitcnt lgkmcnt(0)
    s_waitcnt vmcnt(8)
    s_barrier
    s_add_u32 s43, s42, 98304
    s_mov_b32 m0, s43
    s_add_u32 s44, s41, 3670016
    buffer_load_dwordx4 v11, s[16:19], s44 offen lds

    s_add_u32 s43, s42, 102400
    s_mov_b32 m0, s43
    s_add_u32 s44, s41, 3801088
    buffer_load_dwordx4 v11, s[16:19], s44 offen lds

    s_add_u32 s43, s42, 106496
    s_mov_b32 m0, s43
    s_add_u32 s44, s41, 3932160
    buffer_load_dwordx4 v11, s[16:19], s44 offen lds

    s_add_u32 s43, s42, 110592
    s_mov_b32 m0, s43
    s_add_u32 s44, s41, 4063232
    buffer_load_dwordx4 v11, s[16:19], s44 offen lds

    s_add_u32 s43, s42, 114688
    s_mov_b32 m0, s43
    s_add_u32 s44, s41, 3670016
    buffer_load_dwordx4 v11, s[20:23], s44 offen lds

    s_add_u32 s43, s42, 118784
    s_mov_b32 m0, s43
    s_add_u32 s44, s41, 3801088
    buffer_load_dwordx4 v11, s[20:23], s44 offen lds

    s_add_u32 s43, s42, 122880
    s_mov_b32 m0, s43
    s_add_u32 s44, s41, 3932160
    buffer_load_dwordx4 v11, s[20:23], s44 offen lds

    s_add_u32 s43, s42, 126976
    s_mov_b32 m0, s43
    s_add_u32 s44, s41, 4063232
    buffer_load_dwordx4 v11, s[20:23], s44 offen lds

    ds_read_b64_tr_b16 a[40:41], v18 offset:32768
    ds_read_b64_tr_b16 a[42:43], v18 offset:33280
    ds_read_b64_tr_b16 a[44:45], v18 offset:40960
    ds_read_b64_tr_b16 a[46:47], v18 offset:41472
    ds_read_b64_tr_b16 a[120:121], v19 offset:32768
    ds_read_b64_tr_b16 a[122:123], v19 offset:33280
    ds_read_b64_tr_b16 a[124:125], v19 offset:40960
    ds_read_b64_tr_b16 a[126:127], v19 offset:41472
    s_waitcnt lgkmcnt(0)
    ds_read_b64_tr_b16 a[200:201], v18 offset:49152
    ds_read_b64_tr_b16 a[202:203], v18 offset:49664
    ds_read_b64_tr_b16 a[204:205], v18 offset:57344
    ds_read_b64_tr_b16 a[206:207], v18 offset:57856
    ds_read_b64_tr_b16 v[216:217], v19 offset:49152
    ds_read_b64_tr_b16 v[218:219], v19 offset:49664
    ds_read_b64_tr_b16 v[220:221], v19 offset:57344
    ds_read_b64_tr_b16 v[222:223], v19 offset:57856
    s_waitcnt lgkmcnt(0)
    s_waitcnt vmcnt(8)
    s_barrier
    s_add_u32 s43, s42, 0
    s_mov_b32 m0, s43
    s_add_u32 s44, s41, 4194304
    buffer_load_dwordx4 v11, s[16:19], s44 offen lds

    s_add_u32 s43, s42, 4096
    s_mov_b32 m0, s43
    s_add_u32 s44, s41, 4325376
    buffer_load_dwordx4 v11, s[16:19], s44 offen lds

    s_add_u32 s43, s42, 8192
    s_mov_b32 m0, s43
    s_add_u32 s44, s41, 4456448
    buffer_load_dwordx4 v11, s[16:19], s44 offen lds

    s_add_u32 s43, s42, 12288
    s_mov_b32 m0, s43
    s_add_u32 s44, s41, 4587520
    buffer_load_dwordx4 v11, s[16:19], s44 offen lds

    s_add_u32 s43, s42, 16384
    s_mov_b32 m0, s43
    s_add_u32 s44, s41, 4194304
    buffer_load_dwordx4 v11, s[20:23], s44 offen lds

    s_add_u32 s43, s42, 20480
    s_mov_b32 m0, s43
    s_add_u32 s44, s41, 4325376
    buffer_load_dwordx4 v11, s[20:23], s44 offen lds

    s_add_u32 s43, s42, 24576
    s_mov_b32 m0, s43
    s_add_u32 s44, s41, 4456448
    buffer_load_dwordx4 v11, s[20:23], s44 offen lds

    s_add_u32 s43, s42, 28672
    s_mov_b32 m0, s43
    s_add_u32 s44, s41, 4587520
    buffer_load_dwordx4 v11, s[20:23], s44 offen lds

    ds_read_b64_tr_b16 a[48:49], v20 offset:0
    ds_read_b64_tr_b16 a[50:51], v20 offset:512
    ds_read_b64_tr_b16 a[52:53], v20 offset:8192
    ds_read_b64_tr_b16 a[54:55], v20 offset:8704
    ds_read_b64_tr_b16 a[128:129], v21 offset:0
    ds_read_b64_tr_b16 a[130:131], v21 offset:512
    ds_read_b64_tr_b16 a[132:133], v21 offset:8192
    ds_read_b64_tr_b16 a[134:135], v21 offset:8704
    s_waitcnt lgkmcnt(0)
    ds_read_b64_tr_b16 a[208:209], v20 offset:16384
    ds_read_b64_tr_b16 a[210:211], v20 offset:16896
    ds_read_b64_tr_b16 a[212:213], v20 offset:24576
    ds_read_b64_tr_b16 a[214:215], v20 offset:25088
    ds_read_b64_tr_b16 v[224:225], v21 offset:16384
    ds_read_b64_tr_b16 v[226:227], v21 offset:16896
    ds_read_b64_tr_b16 v[228:229], v21 offset:24576
    ds_read_b64_tr_b16 v[230:231], v21 offset:25088
    s_waitcnt lgkmcnt(0)
    s_waitcnt vmcnt(8)
    s_barrier
    s_add_u32 s43, s42, 32768
    s_mov_b32 m0, s43
    s_add_u32 s44, s41, 4718592
    buffer_load_dwordx4 v11, s[16:19], s44 offen lds

    s_add_u32 s43, s42, 36864
    s_mov_b32 m0, s43
    s_add_u32 s44, s41, 4849664
    buffer_load_dwordx4 v11, s[16:19], s44 offen lds

    s_add_u32 s43, s42, 40960
    s_mov_b32 m0, s43
    s_add_u32 s44, s41, 4980736
    buffer_load_dwordx4 v11, s[16:19], s44 offen lds

    s_add_u32 s43, s42, 45056
    s_mov_b32 m0, s43
    s_add_u32 s44, s41, 5111808
    buffer_load_dwordx4 v11, s[16:19], s44 offen lds

    s_add_u32 s43, s42, 49152
    s_mov_b32 m0, s43
    s_add_u32 s44, s41, 4718592
    buffer_load_dwordx4 v11, s[20:23], s44 offen lds

    s_add_u32 s43, s42, 53248
    s_mov_b32 m0, s43
    s_add_u32 s44, s41, 4849664
    buffer_load_dwordx4 v11, s[20:23], s44 offen lds

    s_add_u32 s43, s42, 57344
    s_mov_b32 m0, s43
    s_add_u32 s44, s41, 4980736
    buffer_load_dwordx4 v11, s[20:23], s44 offen lds

    s_add_u32 s43, s42, 61440
    s_mov_b32 m0, s43
    s_add_u32 s44, s41, 5111808
    buffer_load_dwordx4 v11, s[20:23], s44 offen lds

    ds_read_b64_tr_b16 a[56:57], v20 offset:32768
    ds_read_b64_tr_b16 a[58:59], v20 offset:33280
    ds_read_b64_tr_b16 a[60:61], v20 offset:40960
    ds_read_b64_tr_b16 a[62:63], v20 offset:41472
    ds_read_b64_tr_b16 a[136:137], v21 offset:32768
    ds_read_b64_tr_b16 a[138:139], v21 offset:33280
    ds_read_b64_tr_b16 a[140:141], v21 offset:40960
    ds_read_b64_tr_b16 a[142:143], v21 offset:41472
    s_waitcnt lgkmcnt(0)
    ds_read_b64_tr_b16 a[216:217], v20 offset:49152
    ds_read_b64_tr_b16 a[218:219], v20 offset:49664
    ds_read_b64_tr_b16 a[220:221], v20 offset:57344
    ds_read_b64_tr_b16 a[222:223], v20 offset:57856
    ds_read_b64_tr_b16 v[232:233], v21 offset:49152
    ds_read_b64_tr_b16 v[234:235], v21 offset:49664
    ds_read_b64_tr_b16 v[236:237], v21 offset:57344
    ds_read_b64_tr_b16 v[238:239], v21 offset:57856
    s_waitcnt lgkmcnt(0)
    s_waitcnt vmcnt(8)
    s_barrier
    ds_read_b64_tr_b16 a[64:65], v18 offset:0
    ds_read_b64_tr_b16 a[66:67], v18 offset:512
    ds_read_b64_tr_b16 a[68:69], v18 offset:8192
    ds_read_b64_tr_b16 a[70:71], v18 offset:8704
    ds_read_b64_tr_b16 a[144:145], v19 offset:0
    ds_read_b64_tr_b16 a[146:147], v19 offset:512
    ds_read_b64_tr_b16 a[148:149], v19 offset:8192
    ds_read_b64_tr_b16 a[150:151], v19 offset:8704
    s_waitcnt lgkmcnt(0)
    ds_read_b64_tr_b16 a[224:225], v18 offset:16384
    ds_read_b64_tr_b16 a[226:227], v18 offset:16896
    ds_read_b64_tr_b16 a[228:229], v18 offset:24576
    ds_read_b64_tr_b16 a[230:231], v18 offset:25088
    ds_read_b64_tr_b16 v[240:241], v19 offset:16384
    ds_read_b64_tr_b16 v[242:243], v19 offset:16896
    ds_read_b64_tr_b16 v[244:245], v19 offset:24576
    ds_read_b64_tr_b16 v[246:247], v19 offset:25088
    s_waitcnt lgkmcnt(0)
    s_waitcnt vmcnt(0)
    s_barrier
    ds_read_b64_tr_b16 a[72:73], v18 offset:32768
    ds_read_b64_tr_b16 a[74:75], v18 offset:33280
    ds_read_b64_tr_b16 a[76:77], v18 offset:40960
    ds_read_b64_tr_b16 a[78:79], v18 offset:41472
    ds_read_b64_tr_b16 a[152:153], v19 offset:32768
    ds_read_b64_tr_b16 a[154:155], v19 offset:33280
    ds_read_b64_tr_b16 a[156:157], v19 offset:40960
    ds_read_b64_tr_b16 a[158:159], v19 offset:41472
    s_waitcnt lgkmcnt(0)
    ds_read_b64_tr_b16 a[232:233], v18 offset:49152
    ds_read_b64_tr_b16 a[234:235], v18 offset:49664
    ds_read_b64_tr_b16 a[236:237], v18 offset:57344
    ds_read_b64_tr_b16 a[238:239], v18 offset:57856
    ds_read_b64_tr_b16 v[248:249], v19 offset:49152
    ds_read_b64_tr_b16 v[250:251], v19 offset:49664
    ds_read_b64_tr_b16 v[252:253], v19 offset:57344
    ds_read_b64_tr_b16 v[254:255], v19 offset:57856
    s_waitcnt lgkmcnt(0)
    s_barrier
    s_cmp_lg_u32 s3, 0
    s_cbranch_scc1 dwg_43

dw_44:
    buffer_load_dword v3, off, s[12:15], 0 offset:160 sc1
    s_waitcnt vmcnt(0)
    v_readfirstlane_b32 s44, v3
    s_sub_u32 s30, s30, 1
    s_cmp_lt_i32 s30, 0
    s_cbranch_scc1 dwd_45
    s_cmp_ge_u32 s44, 1
    s_cbranch_scc1 dwd_45
    s_sleep 2
    s_branch dw_44

dwd_45:
dw_46:
    buffer_load_dword v3, off, s[12:15], 0 offset:192 sc1
    s_waitcnt vmcnt(0)
    v_readfirstlane_b32 s44, v3
    s_sub_u32 s30, s30, 1
    s_cmp_lt_i32 s30, 0
    s_cbranch_scc1 dwd_47
    s_cmp_ge_u32 s44, 1
    s_cbranch_scc1 dwd_47
    s_sleep 2
    s_branch dw_46

dwd_47:
dwg_43:
    s_barrier
    s_mul_i32 s43, s3, 10240
    s_add_u32 s44, s43, s37
    s_add_u32 s43, s43, s38

    s_mov_b32 m0, s43
    s_add_u32 s43, s43, 1024
    buffer_load_dwordx4 v5, s[8:11], s44 offen sc1 lds
    s_add_u32 s44, s44, 1024

    s_mov_b32 m0, s43
    s_add_u32 s43, s43, 1024
    buffer_load_dwordx4 v5, s[8:11], s44 offen sc1 lds
    s_add_u32 s44, s44, 1024

    s_mov_b32 m0, s43
    s_add_u32 s43, s43, 1024
    buffer_load_dwordx4 v5, s[8:11], s44 offen sc1 lds
    s_add_u32 s44, s44, 1024

    s_mov_b32 m0, s43
    s_add_u32 s43, s43, 1024
    buffer_load_dwordx4 v5, s[8:11], s44 offen sc1 lds
    s_add_u32 s44, s44, 1024

    s_mov_b32 m0, s43
    s_add_u32 s43, s43, 1024
    buffer_load_dwordx4 v5, s[8:11], s44 offen sc1 lds
    s_add_u32 s44, s44, 1024

    s_mov_b32 m0, s43
    s_add_u32 s43, s43, 1024
    buffer_load_dwordx4 v5, s[8:11], s44 offen sc1 lds
    s_add_u32 s44, s44, 1024

    s_mov_b32 m0, s43
    s_add_u32 s43, s43, 1024
    buffer_load_dwordx4 v5, s[8:11], s44 offen sc1 lds
    s_add_u32 s44, s44, 1024

    s_mov_b32 m0, s43
    s_add_u32 s43, s43, 1024
    buffer_load_dwordx4 v5, s[8:11], s44 offen sc1 lds
    s_add_u32 s44, s44, 1024

    s_mov_b32 m0, s43
    s_add_u32 s43, s43, 1024
    buffer_load_dwordx4 v5, s[8:11], s44 offen sc1 lds
    s_add_u32 s44, s44, 1024

    s_mov_b32 m0, s43
    s_add_u32 s43, s43, 1024
    buffer_load_dwordx4 v5, s[8:11], s44 offen sc1 lds
    s_add_u32 s44, s44, 1024

    s_lshl_b32 s39, s28, 13
    s_lshl_b32 s40, s3, 10
    s_add_u32 s39, s39, s40
    s_add_u32 s39, s39, 0x3800000
    s_lshl_b32 s34, s28, 7
    s_add_u32 s34, s34, 0x10080
    s_waitcnt vmcnt(0)
    s_barrier

t_loop:
    v_add_u32 v14, s38, v5
    s_sub_u32 s38, 40960, s38
    s_add_u32 s37, s37, 40960

    s_add_u32 s45, s29, 1
    s_and_b32 s46, s45, 7
    s_cmp_lg_u32 s46, 0
    s_cbranch_scc1 lrd_49
    s_cmp_ge_u32 s45, 64
    s_cbranch_scc1 lrd_49
    s_lshr_b32 s45, s45, 1
lr_48:
    buffer_load_dword v3, off, s[12:15], s45 offset:192 sc1
    s_waitcnt vmcnt(0)
    v_readfirstlane_b32 s44, v3
    s_sub_u32 s30, s30, 1
    s_cmp_lt_i32 s30, 0
    s_cbranch_scc1 lrd_49
    s_cmp_ge_u32 s44, 1
    s_cbranch_scc1 lrd_49
    s_sleep 4
    s_branch lr_48
lrd_49:

    s_mul_i32 s43, s3, 10240
    s_add_u32 s44, s43, s37
    s_add_u32 s43, s43, s38

    ds_read_b128 v[104:107], v14 offset:0
    ds_read_b128 v[108:111], v14 offset:20480
    ds_read_b128 v[112:115], v14 offset:1024
    ds_read_b128 v[116:119], v14 offset:21504
    ds_read_b128 v[120:123], v14 offset:2048
    ds_read_b128 v[124:127], v14 offset:22528
    s_waitcnt lgkmcnt(4)
    v_mfma_f32_16x16x32_bf16 v[72:75], a[0:3], v[104:107], 0
    v_mfma_f32_16x16x32_bf16 v[76:79], a[0:3], v[108:111], 0
    v_mfma_f32_16x16x32_bf16 v[80:83], a[80:83], v[104:107], 0
    v_mfma_f32_16x16x32_bf16 v[84:87], a[80:83], v[108:111], 0
    s_mov_b32 m0, s43
    s_add_u32 s43, s43, 1024
    buffer_load_dwordx4 v5, s[8:11], s44 offen sc1 lds
    s_add_u32 s44, s44, 1024

    v_mfma_f32_16x16x32_bf16 v[88:91], a[160:163], v[104:107], 0
    v_mfma_f32_16x16x32_bf16 v[92:95], a[160:163], v[108:111], 0
    v_mfma_f32_16x16x32_bf16 v[96:99], a[240:243], v[104:107], 0
    v_mfma_f32_16x16x32_bf16 v[100:103], a[240:243], v[108:111], 0
    ds_read_b128 v[104:107], v14 offset:3072
    ds_read_b128 v[108:111], v14 offset:23552
    s_waitcnt lgkmcnt(4)
    v_mfma_f32_16x16x32_bf16 v[72:75], a[4:7], v[112:115], v[72:75]
    v_mfma_f32_16x16x32_bf16 v[76:79], a[4:7], v[116:119], v[76:79]
    v_mfma_f32_16x16x32_bf16 v[80:83], a[84:87], v[112:115], v[80:83]
    v_mfma_f32_16x16x32_bf16 v[84:87], a[84:87], v[116:119], v[84:87]
    s_mov_b32 m0, s43
    s_add_u32 s43, s43, 1024
    buffer_load_dwordx4 v5, s[8:11], s44 offen sc1 lds
    s_add_u32 s44, s44, 1024

    v_mfma_f32_16x16x32_bf16 v[88:91], a[164:167], v[112:115], v[88:91]
    v_mfma_f32_16x16x32_bf16 v[92:95], a[164:167], v[116:119], v[92:95]
    v_mfma_f32_16x16x32_bf16 v[96:99], a[244:247], v[112:115], v[96:99]
    v_mfma_f32_16x16x32_bf16 v[100:103], a[244:247], v[116:119], v[100:103]
    ds_read_b128 v[112:115], v14 offset:4096
    ds_read_b128 v[116:119], v14 offset:24576
    s_waitcnt lgkmcnt(4)
    v_mfma_f32_16x16x32_bf16 v[72:75], a[8:11], v[120:123], v[72:75]
    v_mfma_f32_16x16x32_bf16 v[76:79], a[8:11], v[124:127], v[76:79]
    v_mfma_f32_16x16x32_bf16 v[80:83], a[88:91], v[120:123], v[80:83]
    v_mfma_f32_16x16x32_bf16 v[84:87], a[88:91], v[124:127], v[84:87]
    v_mfma_f32_16x16x32_bf16 v[88:91], a[168:171], v[120:123], v[88:91]
    v_mfma_f32_16x16x32_bf16 v[92:95], a[168:171], v[124:127], v[92:95]
    v_mfma_f32_16x16x32_bf16 v[96:99], a[248:251], v[120:123], v[96:99]
    v_mfma_f32_16x16x32_bf16 v[100:103], a[248:251], v[124:127], v[100:103]
    ds_read_b128 v[120:123], v14 offset:5120
    ds_read_b128 v[124:127], v14 offset:25600
    s_waitcnt lgkmcnt(4)
    v_mfma_f32_16x16x32_bf16 v[72:75], a[12:15], v[104:107], v[72:75]
    v_mfma_f32_16x16x32_bf16 v[76:79], a[12:15], v[108:111], v[76:79]
    v_mfma_f32_16x16x32_bf16 v[80:83], a[92:95], v[104:107], v[80:83]
    v_mfma_f32_16x16x32_bf16 v[84:87], a[92:95], v[108:111], v[84:87]
    s_mov_b32 m0, s43
    s_add_u32 s43, s43, 1024
    buffer_load_dwordx4 v5, s[8:11], s44 offen sc1 lds
    s_add_u32 s44, s44, 1024

    v_mfma_f32_16x16x32_bf16 v[88:91], a[172:175], v[104:107], v[88:91]
    v_mfma_f32_16x16x32_bf16 v[92:95], a[172:175], v[108:111], v[92:95]
    v_mfma_f32_16x16x32_bf16 v[96:99], a[252:255], v[104:107], v[96:99]
    v_mfma_f32_16x16x32_bf16 v[100:103], a[252:255], v[108:111], v[100:103]
    ds_read_b128 v[104:107], v14 offset:6144
    ds_read_b128 v[108:111], v14 offset:26624
    s_waitcnt lgkmcnt(4)
    v_mfma_f32_16x16x32_bf16 v[72:75], a[16:19], v[112:115], v[72:75]
    v_mfma_f32_16x16x32_bf16 v[76:79], a[16:19], v[116:119], v[76:79]
    v_mfma_f32_16x16x32_bf16 v[80:83], a[96:99], v[112:115], v[80:83]
    v_mfma_f32_16x16x32_bf16 v[84:87], a[96:99], v[116:119], v[84:87]
    s_mov_b32 m0, s43
    s_add_u32 s43, s43, 1024
    buffer_load_dwordx4 v5, s[8:11], s44 offen sc1 lds
    s_add_u32 s44, s44, 1024

    v_mfma_f32_16x16x32_bf16 v[88:91], a[176:179], v[112:115], v[88:91]
    v_mfma_f32_16x16x32_bf16 v[92:95], a[176:179], v[116:119], v[92:95]
    v_mfma_f32_16x16x32_bf16 v[96:99], v[192:195], v[112:115], v[96:99]
    v_mfma_f32_16x16x32_bf16 v[100:103], v[192:195], v[116:119], v[100:103]
    ds_read_b128 v[112:115], v14 offset:7168
    ds_read_b128 v[116:119], v14 offset:27648
    s_waitcnt lgkmcnt(4)
    v_mfma_f32_16x16x32_bf16 v[72:75], a[20:23], v[120:123], v[72:75]
    v_mfma_f32_16x16x32_bf16 v[76:79], a[20:23], v[124:127], v[76:79]
    v_mfma_f32_16x16x32_bf16 v[80:83], a[100:103], v[120:123], v[80:83]
    v_mfma_f32_16x16x32_bf16 v[84:87], a[100:103], v[124:127], v[84:87]
    s_waitcnt vmcnt(4)
    s_barrier
    s_cmp_lg_u32 s3, 3
    s_cbranch_scc1 pub_50
    v_mov_b32 v3, s29
    s_mov_b64 exec, 1
    buffer_store_dword v3, off, s[8:11], s34 sc1
    s_mov_b64 exec, -1
pub_50:

    v_mfma_f32_16x16x32_bf16 v[88:91], a[180:183], v[120:123], v[88:91]
    v_mfma_f32_16x16x32_bf16 v[92:95], a[180:183], v[124:127], v[92:95]
    v_mfma_f32_16x16x32_bf16 v[96:99], v[196:199], v[120:123], v[96:99]
    v_mfma_f32_16x16x32_bf16 v[100:103], v[196:199], v[124:127], v[100:103]
    ds_read_b128 v[120:123], v14 offset:8192
    ds_read_b128 v[124:127], v14 offset:28672
    s_waitcnt lgkmcnt(4)
    v_mfma_f32_16x16x32_bf16 v[72:75], a[24:27], v[104:107], v[72:75]
    v_mfma_f32_16x16x32_bf16 v[76:79], a[24:27], v[108:111], v[76:79]
    v_mfma_f32_16x16x32_bf16 v[80:83], a[104:107], v[104:107], v[80:83]
    v_mfma_f32_16x16x32_bf16 v[84:87], a[104:107], v[108:111], v[84:87]
    s_mov_b32 m0, s43
    s_add_u32 s43, s43, 1024
    buffer_load_dwordx4 v5, s[8:11], s44 offen sc1 lds
    s_add_u32 s44, s44, 1024

    v_mfma_f32_16x16x32_bf16 v[88:91], a[184:187], v[104:107], v[88:91]
    v_mfma_f32_16x16x32_bf16 v[92:95], a[184:187], v[108:111], v[92:95]
    v_mfma_f32_16x16x32_bf16 v[96:99], v[200:203], v[104:107], v[96:99]
    v_mfma_f32_16x16x32_bf16 v[100:103], v[200:203], v[108:111], v[100:103]
    ds_read_b128 v[104:107], v14 offset:9216
    ds_read_b128 v[108:111], v14 offset:29696
    s_waitcnt lgkmcnt(4)
    v_mfma_f32_16x16x32_bf16 v[72:75], a[28:31], v[112:115], v[72:75]
    v_mfma_f32_16x16x32_bf16 v[76:79], a[28:31], v[116:119], v[76:79]
    v_mfma_f32_16x16x32_bf16 v[80:83], a[108:111], v[112:115], v[80:83]
    v_mfma_f32_16x16x32_bf16 v[84:87], a[108:111], v[116:119], v[84:87]
    s_mov_b32 m0, s43
    s_add_u32 s43, s43, 1024
    buffer_load_dwordx4 v5, s[8:11], s44 offen sc1 lds
    s_add_u32 s44, s44, 1024

    v_mfma_f32_16x16x32_bf16 v[88:91], a[188:191], v[112:115], v[88:91]
    v_mfma_f32_16x16x32_bf16 v[92:95], a[188:191], v[116:119], v[92:95]
    v_mfma_f32_16x16x32_bf16 v[96:99], v[204:207], v[112:115], v[96:99]
    v_mfma_f32_16x16x32_bf16 v[100:103], v[204:207], v[116:119], v[100:103]
    ds_read_b128 v[112:115], v14 offset:10240
    ds_read_b128 v[116:119], v14 offset:30720
    s_waitcnt lgkmcnt(4)
    v_mfma_f32_16x16x32_bf16 v[72:75], a[32:35], v[120:123], v[72:75]
    v_mfma_f32_16x16x32_bf16 v[76:79], a[32:35], v[124:127], v[76:79]
    v_mfma_f32_16x16x32_bf16 v[80:83], a[112:115], v[120:123], v[80:83]
    v_mfma_f32_16x16x32_bf16 v[84:87], a[112:115], v[124:127], v[84:87]
    v_mfma_f32_16x16x32_bf16 v[88:91], a[192:195], v[120:123], v[88:91]
    v_mfma_f32_16x16x32_bf16 v[92:95], a[192:195], v[124:127], v[92:95]
    v_mfma_f32_16x16x32_bf16 v[96:99], v[208:211], v[120:123], v[96:99]
    v_mfma_f32_16x16x32_bf16 v[100:103], v[208:211], v[124:127], v[100:103]
    ds_read_b128 v[120:123], v14 offset:11264
    ds_read_b128 v[124:127], v14 offset:31744
    s_waitcnt lgkmcnt(4)
    v_mfma_f32_16x16x32_bf16 v[72:75], a[36:39], v[104:107], v[72:75]
    v_mfma_f32_16x16x32_bf16 v[76:79], a[36:39], v[108:111], v[76:79]
    v_mfma_f32_16x16x32_bf16 v[80:83], a[116:119], v[104:107], v[80:83]
    v_mfma_f32_16x16x32_bf16 v[84:87], a[116:119], v[108:111], v[84:87]
    s_mov_b32 m0, s43
    s_add_u32 s43, s43, 1024
    buffer_load_dwordx4 v5, s[8:11], s44 offen sc1 lds
    s_add_u32 s44, s44, 1024

    v_mfma_f32_16x16x32_bf16 v[88:91], a[196:199], v[104:107], v[88:91]
    v_mfma_f32_16x16x32_bf16 v[92:95], a[196:199], v[108:111], v[92:95]
    v_mfma_f32_16x16x32_bf16 v[96:99], v[212:215], v[104:107], v[96:99]
    v_mfma_f32_16x16x32_bf16 v[100:103], v[212:215], v[108:111], v[100:103]
    ds_read_b128 v[104:107], v14 offset:12288
    ds_read_b128 v[108:111], v14 offset:32768
    s_waitcnt lgkmcnt(4)
    v_mfma_f32_16x16x32_bf16 v[72:75], a[40:43], v[112:115], v[72:75]
    v_mfma_f32_16x16x32_bf16 v[76:79], a[40:43], v[116:119], v[76:79]
    v_mfma_f32_16x16x32_bf16 v[80:83], a[120:123], v[112:115], v[80:83]
    v_mfma_f32_16x16x32_bf16 v[84:87], a[120:123], v[116:119], v[84:87]
    s_mov_b32 m0, s43
    s_add_u32 s43, s43, 1024
    buffer_load_dwordx4 v5, s[8:11], s44 offen sc1 lds
    s_add_u32 s44, s44, 1024

    v_mfma_f32_16x16x32_bf16 v[88:91], a[200:203], v[112:115], v[88:91]
    v_mfma_f32_16x16x32_bf16 v[92:95], a[200:203], v[116:119], v[92:95]
    v_mfma_f32_16x16x32_bf16 v[96:99], v[216:219], v[112:115], v[96:99]
    v_mfma_f32_16x16x32_bf16 v[100:103], v[216:219], v[116:119], v[100:103]
    ds_read_b128 v[112:115], v14 offset:13312
    ds_read_b128 v[116:119], v14 offset:33792
    s_waitcnt lgkmcnt(4)
    v_mfma_f32_16x16x32_bf16 v[72:75], a[44:47], v[120:123], v[72:75]
    v_mfma_f32_16x16x32_bf16 v[76:79], a[44:47], v[124:127], v[76:79]
    v_mfma_f32_16x16x32_bf16 v[80:83], a[124:127], v[120:123], v[80:83]
    v_mfma_f32_16x16x32_bf16 v[84:87], a[124:127], v[124:127], v[84:87]
    v_mfma_f32_16x16x32_bf16 v[88:91], a[204:207], v[120:123], v[88:91]
    v_mfma_f32_16x16x32_bf16 v[92:95], a[204:207], v[124:127], v[92:95]
    v_mfma_f32_16x16x32_bf16 v[96:99], v[220:223], v[120:123], v[96:99]
    v_mfma_f32_16x16x32_bf16 v[100:103], v[220:223], v[124:127], v[100:103]
    ds_read_b128 v[120:123], v14 offset:14336
    ds_read_b128 v[124:127], v14 offset:34816
    s_waitcnt lgkmcnt(4)
    v_mfma_f32_16x16x32_bf16 v[72:75], a[48:51], v[104:107], v[72:75]
    v_mfma_f32_16x16x32_bf16 v[76:79], a[48:51], v[108:111], v[76:79]
    v_mfma_f32_16x16x32_bf16 v[80:83], a[128:131], v[104:107], v[80:83]
    v_mfma_f32_16x16x32_bf16 v[84:87], a[128:131], v[108:111], v[84:87]
    s_mov_b32 m0, s43
    s_add_u32 s43, s43, 1024
    buffer_load_dwordx4 v5, s[8:11], s44 offen sc1 lds
    s_add_u32 s44, s44, 1024

    v_mfma_f32_16x16x32_bf16 v[88:91], a[208:211], v[104:107], v[88:91]
    v_mfma_f32_16x16x32_bf16 v[92:95], a[208:211], v[108:111], v[92:95]
    v_mfma_f32_16x16x32_bf16 v[96:99], v[224:227], v[104:107], v[96:99]
    v_mfma_f32_16x16x32_bf16 v[100:103], v[224:227], v[108:111], v[100:103]
    ds_read_b128 v[104:107], v14 offset:15360
    ds_read_b128 v[108:111], v14 offset:35840
    s_waitcnt lgkmcnt(4)
    v_mfma_f32_16x16x32_bf16 v[72:75], a[52:55], v[112:115], v[72:75]
    v_mfma_f32_16x16x32_bf16 v[76:79], a[52:55], v[116:119], v[76:79]
    v_mfma_f32_16x16x32_bf16 v[80:83], a[132:135], v[112:115], v[80:83]
    v_mfma_f32_16x16x32_bf16 v[84:87], a[132:135], v[116:119], v[84:87]
    s_mov_b32 m0, s43
    s_add_u32 s43, s43, 1024
    buffer_load_dwordx4 v5, s[8:11], s44 offen sc1 lds
    s_add_u32 s44, s44, 1024

    v_mfma_f32_16x16x32_bf16 v[88:91], a[212:215], v[112:115], v[88:91]
    v_mfma_f32_16x16x32_bf16 v[92:95], a[212:215], v[116:119], v[92:95]
    v_mfma_f32_16x16x32_bf16 v[96:99], v[228:231], v[112:115], v[96:99]
    v_mfma_f32_16x16x32_bf16 v[100:103], v[228:231], v[116:119], v[100:103]
    ds_read_b128 v[112:115], v14 offset:16384
    ds_read_b128 v[116:119], v14 offset:36864
    s_waitcnt lgkmcnt(4)
    v_mfma_f32_16x16x32_bf16 v[72:75], a[56:59], v[120:123], v[72:75]
    v_mfma_f32_16x16x32_bf16 v[76:79], a[56:59], v[124:127], v[76:79]
    v_mfma_f32_16x16x32_bf16 v[80:83], a[136:139], v[120:123], v[80:83]
    v_mfma_f32_16x16x32_bf16 v[84:87], a[136:139], v[124:127], v[84:87]
    v_mfma_f32_16x16x32_bf16 v[88:91], a[216:219], v[120:123], v[88:91]
    v_mfma_f32_16x16x32_bf16 v[92:95], a[216:219], v[124:127], v[92:95]
    v_mfma_f32_16x16x32_bf16 v[96:99], v[232:235], v[120:123], v[96:99]
    v_mfma_f32_16x16x32_bf16 v[100:103], v[232:235], v[124:127], v[100:103]
    ds_read_b128 v[120:123], v14 offset:17408
    ds_read_b128 v[124:127], v14 offset:37888
    s_waitcnt lgkmcnt(4)
    v_mfma_f32_16x16x32_bf16 v[72:75], a[60:63], v[104:107], v[72:75]
    v_mfma_f32_16x16x32_bf16 v[76:79], a[60:63], v[108:111], v[76:79]
    v_mfma_f32_16x16x32_bf16 v[80:83], a[140:143], v[104:107], v[80:83]
    v_mfma_f32_16x16x32_bf16 v[84:87], a[140:143], v[108:111], v[84:87]
    v_mfma_f32_16x16x32_bf16 v[88:91], a[220:223], v[104:107], v[88:91]
    v_mfma_f32_16x16x32_bf16 v[92:95], a[220:223], v[108:111], v[92:95]
    v_mfma_f32_16x16x32_bf16 v[96:99], v[236:239], v[104:107], v[96:99]
    v_mfma_f32_16x16x32_bf16 v[100:103], v[236:239], v[108:111], v[100:103]
    ds_read_b128 v[104:107], v14 offset:18432
    ds_read_b128 v[108:111], v14 offset:38912
    s_waitcnt lgkmcnt(4)
    v_mfma_f32_16x16x32_bf16 v[72:75], a[64:67], v[112:115], v[72:75]
    v_mfma_f32_16x16x32_bf16 v[76:79], a[64:67], v[116:119], v[76:79]
    v_mfma_f32_16x16x32_bf16 v[80:83], a[144:147], v[112:115], v[80:83]
    v_mfma_f32_16x16x32_bf16 v[84:87], a[144:147], v[116:119], v[84:87]
    v_mfma_f32_16x16x32_bf16 v[88:91], a[224:227], v[112:115], v[88:91]
    v_mfma_f32_16x16x32_bf16 v[92:95], a[224:227], v[116:119], v[92:95]
    v_mfma_f32_16x16x32_bf16 v[96:99], v[240:243], v[112:115], v[96:99]
    v_mfma_f32_16x16x32_bf16 v[100:103], v[240:243], v[116:119], v[100:103]
    ds_read_b128 v[112:115], v14 offset:19456
    ds_read_b128 v[116:119], v14 offset:39936
    s_waitcnt lgkmcnt(4)
    v_mfma_f32_16x16x32_bf16 v[72:75], a[68:71], v[120:123], v[72:75]
    v_mfma_f32_16x16x32_bf16 v[76:79], a[68:71], v[124:127], v[76:79]
    v_mfma_f32_16x16x32_bf16 v[80:83], a[148:151], v[120:123], v[80:83]
    v_mfma_f32_16x16x32_bf16 v[84:87], a[148:151], v[124:127], v[84:87]
    v_mfma_f32_16x16x32_bf16 v[88:91], a[228:231], v[120:123], v[88:91]
    v_mfma_f32_16x16x32_bf16 v[92:95], a[228:231], v[124:127], v[92:95]
    v_mfma_f32_16x16x32_bf16 v[96:99], v[244:247], v[120:123], v[96:99]
    v_mfma_f32_16x16x32_bf16 v[100:103], v[244:247], v[124:127], v[100:103]
    s_waitcnt lgkmcnt(2)
    v_mfma_f32_16x16x32_bf16 v[72:75], a[72:75], v[104:107], v[72:75]
    v_mfma_f32_16x16x32_bf16 v[76:79], a[72:75], v[108:111], v[76:79]
    v_mfma_f32_16x16x32_bf16 v[80:83], a[152:155], v[104:107], v[80:83]
    v_mfma_f32_16x16x32_bf16 v[84:87], a[152:155], v[108:111], v[84:87]
    v_mfma_f32_16x16x32_bf16 v[88:91], a[232:235], v[104:107], v[88:91]
    v_mfma_f32_16x16x32_bf16 v[92:95], a[232:235], v[108:111], v[92:95]
    v_mfma_f32_16x16x32_bf16 v[96:99], v[248:251], v[104:107], v[96:99]
    v_mfma_f32_16x16x32_bf16 v[100:103], v[248:251], v[108:111], v[100:103]
    s_waitcnt lgkmcnt(0)
    v_mfma_f32_16x16x32_bf16 v[72:75], a[76:79], v[112:115], v[72:75]
    v_mfma_f32_16x16x32_bf16 v[76:79], a[76:79], v[116:119], v[76:79]
    v_mfma_f32_16x16x32_bf16 v[80:83], a[156:159], v[112:115], v[80:83]
    v_mfma_f32_16x16x32_bf16 v[84:87], a[156:159], v[116:119], v[84:87]
    v_mfma_f32_16x16x32_bf16 v[88:91], a[236:239], v[112:115], v[88:91]
    v_mfma_f32_16x16x32_bf16 v[92:95], a[236:239], v[116:119], v[92:95]
    v_mfma_f32_16x16x32_bf16 v[96:99], v[252:255], v[112:115], v[96:99]
    v_mfma_f32_16x16x32_bf16 v[100:103], v[252:255], v[116:119], v[100:103]
    s_nop 3
    s_add_u32 s40, s39, 0x1000000
    v_cvt_pk_bf16_f32 v128, v72, v73
    v_cvt_pk_bf16_f32 v129, v74, v75
    v_cvt_pk_bf16_f32 v130, v80, v81
    v_cvt_pk_bf16_f32 v131, v82, v83
    v_cvt_pk_bf16_f32 v132, v76, v77
    v_cvt_pk_bf16_f32 v133, v78, v79
    v_cvt_pk_bf16_f32 v134, v84, v85
    v_cvt_pk_bf16_f32 v135, v86, v87
    v_cvt_pk_bf16_f32 v136, v88, v89
    v_cvt_pk_bf16_f32 v137, v90, v91
    v_cvt_pk_bf16_f32 v138, v96, v97
    v_cvt_pk_bf16_f32 v139, v98, v99
    v_cvt_pk_bf16_f32 v140, v92, v93
    v_cvt_pk_bf16_f32 v141, v94, v95
    v_cvt_pk_bf16_f32 v142, v100, v101
    v_cvt_pk_bf16_f32 v143, v102, v103
    s_waitcnt vmcnt(0)
    buffer_store_dwordx4 v[136:139], v5, s[8:11], s39 offen sc1
    buffer_store_dwordx4 v[140:143], v6, s[8:11], s39 offen sc1
    buffer_store_dwordx4 v[128:131], v5, s[8:11], s40 offen sc1
    buffer_store_dwordx4 v[132:135], v6, s[8:11], s40 offen sc1
    s_add_u32 s39, s39, 262144
    s_cmp_ge_u32 s29, 2
    s_cbranch_scc1 t_ne
    s_add_u32 s46, s29, 1
    s_waitcnt vmcnt(0)
    s_barrier

    s_cmp_lg_u32 s3, 3
    s_cbranch_scc1 pub_51
    v_mov_b32 v3, s46
    s_mov_b64 exec, 1
    buffer_store_dword v3, off, s[8:11], s34 sc1
    s_mov_b64 exec, -1
pub_51:

t_ne:
    s_barrier
    s_add_u32 s29, s29, 1
    s_cmp_lt_u32 s29, 64
    s_cbranch_scc1 t_loop
    s_waitcnt vmcnt(0)
    s_barrier

    s_cmp_lg_u32 s3, 3
    s_cbranch_scc1 pub_52
    v_mov_b32 v3, s29
    s_mov_b64 exec, 1
    buffer_store_dword v3, off, s[8:11], s34 sc1
    s_mov_b64 exec, -1
pub_52:

    s_mov_b32 s29, 0
    s_add_u32 s97, s97, 691200
    s_branch help_c
help_f:
    s_cmp_ge_u32 s28, 27
    s_cbranch_scc1 t_a
    s_add_u32 s28, s28, 212
    s_mov_b32 s100, 55
    s_branch role_f
t_a:
    s_add_u32 s28, s28, 149
    s_mov_b32 s100, 57
    s_branch role_a

role_vo:
    s_sub_u32 s28, s28, 144
    s_load_dwordx4 s[64:67], s[0:1], 32
    s_mov_b32 s37, 0x2400000
    s_mov_b32 s38, 0
    s_waitcnt lgkmcnt(0)

    s_mov_b32 s16, s64
    s_and_b32 s17, s65, 0xffff
    s_mov_b32 s18, 0x500000
    s_mov_b32 s19, 0x00020000
    s_mov_b32 s20, s66
    s_and_b32 s21, s67, 0xffff
    s_mov_b32 s22, 0x500000
    s_mov_b32 s23, 0x00020000
    v_add_u32 v10, 0, v2
    v_mul_u32_u24 v11, 3277, v10
    v_lshrrev_b32 v11, 16, v11
    v_mul_u32_u24 v12, 20, v11
    v_sub_u32 v10, v10, v12
    v_mul_u32_u24 v11, 1280, v11
    v_lshl_add_u32 v24, v10, 4, v11

    v_add_u32 v10, 64, v2
    v_mul_u32_u24 v11, 3277, v10
    v_lshrrev_b32 v11, 16, v11
    v_mul_u32_u24 v12, 20, v11
    v_sub_u32 v10, v10, v12
    v_mul_u32_u24 v11, 1280, v11
    v_lshl_add_u32 v25, v10, 4, v11

    v_add_u32 v10, 128, v2
    v_mul_u32_u24 v11, 3277, v10
    v_lshrrev_b32 v11, 16, v11
    v_mul_u32_u24 v12, 20, v11
    v_sub_u32 v10, v10, v12
    v_mul_u32_u24 v11, 1280, v11
    v_lshl_add_u32 v26, v10, 4, v11

    v_add_u32 v10, 192, v2
    v_mul_u32_u24 v11, 3277, v10
    v_lshrrev_b32 v11, 16, v11
    v_mul_u32_u24 v12, 20, v11
    v_sub_u32 v10, v10, v12
    v_mul_u32_u24 v11, 1280, v11
    v_lshl_add_u32 v27, v10, 4, v11

    v_add_u32 v10, 256, v2
    v_mul_u32_u24 v11, 3277, v10
    v_lshrrev_b32 v11, 16, v11
    v_mul_u32_u24 v12, 20, v11
    v_sub_u32 v10, v10, v12
    v_mul_u32_u24 v11, 1280, v11
    v_lshl_add_u32 v28, v10, 4, v11

    s_mul_i32 s46, s28, 163840
    s_mul_i32 s40, s3, 320
    s_add_u32 s46, s46, s40
    s_mul_i32 s47, s3, 20480
    s_add_u32 s47, s47, 49152
    v_lshrrev_b32 v10, 4, v2
    v_bfe_u32 v11, v2, 2, 2
    v_lshl_add_u32 v10, v10, 2, v11
    v_mul_u32_u24 v10, 320, v10
    v_and_b32 v11, 3, v2
    v_lshl_add_u32 v10, v11, 3, v10
    v_add_u32 v29, s47, v10

    v_lshrrev_b32 v10, 4, v2
    v_and_b32 v11, 15, v2
    v_and_b32 v12, 1, v10
    s_lshl_b32 s40, s3, 1
    v_or_b32 v12, s40, v12
    v_lshlrev_b32 v12, 1, v12
    v_xor_b32 v11, v11, v12
    v_lshlrev_b32 v11, 4, v11
    s_lshl_b32 s40, s3, 2
    v_add_u32 v12, s40, v10
    v_lshl_add_u32 v11, v12, 13, v11
    s_lshl_b32 s41, s28, 8
    s_lshl_b32 s42, s3, 10
    v_bfe_u32 v12, v2, 2, 2
    v_and_b32 v13, 3, v2
    v_lshrrev_b32 v14, 1, v10
    v_lshlrev_b32 v14, 4, v14
    v_and_b32 v15, 1, v10
    v_lshl_add_u32 v14, v15, 2, v14
    v_and_b32 v16, 1, v12
    v_add_u32 v14, v14, v16
    v_lshrrev_b32 v17, 1, v12
    v_lshl_add_u32 v14, v17, 3, v14
    v_lshlrev_b32 v14, 8, v14
    v_lshl_add_u32 v14, v13, 3, v14
    v_lshl_or_b32 v16, v15, 1, v16
    v_lshl_or_b32 v16, v17, 2, v16
    v_lshl_or_b32 v14, v16, 5, v14
    s_lshl_b32 s40, s3, 6
    v_xor_b32 v18, s40, v14
    v_xor_b32 v19, 32, v18
    v_add_u32 v20, 0x10000, v18
    v_add_u32 v21, 0x10000, v19

    s_add_u32 s43, s42, 0
    s_mov_b32 m0, s43
    s_add_u32 s44, s41, 0
    buffer_load_dwordx4 v11, s[16:19], s44 offen lds

    s_add_u32 s43, s42, 4096
    s_mov_b32 m0, s43
    s_add_u32 s44, s41, 131072
    buffer_load_dwordx4 v11, s[16:19], s44 offen lds

    s_add_u32 s43, s42, 8192
    s_mov_b32 m0, s43
    s_add_u32 s44, s41, 262144
    buffer_load_dwordx4 v11, s[16:19], s44 offen lds

    s_add_u32 s43, s42, 12288
    s_mov_b32 m0, s43
    s_add_u32 s44, s41, 393216
    buffer_load_dwordx4 v11, s[16:19], s44 offen lds

    s_add_u32 s43, s42, 16384
    s_mov_b32 m0, s43
    s_add_u32 s44, s41, 524288
    buffer_load_dwordx4 v11, s[16:19], s44 offen lds

    s_add_u32 s43, s42, 20480
    s_mov_b32 m0, s43
    s_add_u32 s44, s41, 655360
    buffer_load_dwordx4 v11, s[16:19], s44 offen lds

    s_add_u32 s43, s42, 24576
    s_mov_b32 m0, s43
    s_add_u32 s44, s41, 786432
    buffer_load_dwordx4 v11, s[16:19], s44 offen lds

    s_add_u32 s43, s42, 28672
    s_mov_b32 m0, s43
    s_add_u32 s44, s41, 917504
    buffer_load_dwordx4 v11, s[16:19], s44 offen lds

    s_mov_b32 s45, s47
    s_mov_b32 m0, s45
    s_add_u32 s45, s45, 1024
    buffer_load_dwordx4 v24, s[20:23], s46 offen lds

    s_mov_b32 m0, s45
    s_add_u32 s45, s45, 1024
    buffer_load_dwordx4 v25, s[20:23], s46 offen lds

    s_mov_b32 m0, s45
    s_add_u32 s45, s45, 1024
    buffer_load_dwordx4 v26, s[20:23], s46 offen lds

    s_mov_b32 m0, s45
    s_add_u32 s45, s45, 1024
    buffer_load_dwordx4 v27, s[20:23], s46 offen lds

    s_mov_b32 m0, s45
    s_add_u32 s45, s45, 1024
    buffer_load_dwordx4 v28, s[20:23], s46 offen lds

    s_add_u32 s46, s46, 20480
    s_mov_b32 m0, s45
    s_add_u32 s45, s45, 1024
    buffer_load_dwordx4 v24, s[20:23], s46 offen lds

    s_mov_b32 m0, s45
    s_add_u32 s45, s45, 1024
    buffer_load_dwordx4 v25, s[20:23], s46 offen lds

    s_mov_b32 m0, s45
    s_add_u32 s45, s45, 1024
    buffer_load_dwordx4 v26, s[20:23], s46 offen lds

    s_mov_b32 m0, s45
    s_add_u32 s45, s45, 1024
    buffer_load_dwordx4 v27, s[20:23], s46 offen lds

    s_mov_b32 m0, s45
    s_add_u32 s45, s45, 1024
    buffer_load_dwordx4 v28, s[20:23], s46 offen lds

    s_add_u32 s46, s46, 20480
    s_mov_b32 m0, s45
    s_add_u32 s45, s45, 1024
    buffer_load_dwordx4 v24, s[20:23], s46 offen lds

    s_mov_b32 m0, s45
    s_add_u32 s45, s45, 1024
    buffer_load_dwordx4 v25, s[20:23], s46 offen lds

    s_mov_b32 m0, s45
    s_add_u32 s45, s45, 1024
    buffer_load_dwordx4 v26, s[20:23], s46 offen lds

    s_mov_b32 m0, s45
    s_add_u32 s45, s45, 1024
    buffer_load_dwordx4 v27, s[20:23], s46 offen lds

    s_mov_b32 m0, s45
    s_add_u32 s45, s45, 1024
    buffer_load_dwordx4 v28, s[20:23], s46 offen lds

    s_add_u32 s46, s46, 20480
    s_mov_b32 m0, s45
    s_add_u32 s45, s45, 1024
    buffer_load_dwordx4 v24, s[20:23], s46 offen lds

    s_mov_b32 m0, s45
    s_add_u32 s45, s45, 1024
    buffer_load_dwordx4 v25, s[20:23], s46 offen lds

    s_mov_b32 m0, s45
    s_add_u32 s45, s45, 1024
    buffer_load_dwordx4 v26, s[20:23], s46 offen lds

    s_mov_b32 m0, s45
    s_add_u32 s45, s45, 1024
    buffer_load_dwordx4 v27, s[20:23], s46 offen lds

    s_mov_b32 m0, s45
    s_add_u32 s45, s45, 1024
    buffer_load_dwordx4 v28, s[20:23], s46 offen lds

    s_add_u32 s46, s46, 20480
    s_waitcnt vmcnt(24)
    s_barrier
    s_add_u32 s43, s42, 32768
    s_mov_b32 m0, s43
    s_add_u32 s44, s41, 1048576
    buffer_load_dwordx4 v11, s[16:19], s44 offen lds

    s_add_u32 s43, s42, 36864
    s_mov_b32 m0, s43
    s_add_u32 s44, s41, 1179648
    buffer_load_dwordx4 v11, s[16:19], s44 offen lds

    s_add_u32 s43, s42, 40960
    s_mov_b32 m0, s43
    s_add_u32 s44, s41, 1310720
    buffer_load_dwordx4 v11, s[16:19], s44 offen lds

    s_add_u32 s43, s42, 45056
    s_mov_b32 m0, s43
    s_add_u32 s44, s41, 1441792
    buffer_load_dwordx4 v11, s[16:19], s44 offen lds

    ds_read_b64_tr_b16 a[0:1], v18 offset:0
    ds_read_b64_tr_b16 a[2:3], v18 offset:512
    ds_read_b64_tr_b16 a[4:5], v18 offset:8192
    ds_read_b64_tr_b16 a[6:7], v18 offset:8704
    ds_read_b64_tr_b16 a[80:81], v19 offset:0
    ds_read_b64_tr_b16 a[82:83], v19 offset:512
    ds_read_b64_tr_b16 a[84:85], v19 offset:8192
    ds_read_b64_tr_b16 a[86:87], v19 offset:8704
    s_waitcnt lgkmcnt(0)
    s_waitcnt vmcnt(24)
    s_barrier
    s_add_u32 s43, s42, 0
    s_mov_b32 m0, s43
    s_add_u32 s44, s41, 1572864
    buffer_load_dwordx4 v11, s[16:19], s44 offen lds

    s_add_u32 s43, s42, 4096
    s_mov_b32 m0, s43
    s_add_u32 s44, s41, 1703936
    buffer_load_dwordx4 v11, s[16:19], s44 offen lds

    s_add_u32 s43, s42, 8192
    s_mov_b32 m0, s43
    s_add_u32 s44, s41, 1835008
    buffer_load_dwordx4 v11, s[16:19], s44 offen lds

    s_add_u32 s43, s42, 12288
    s_mov_b32 m0, s43
    s_add_u32 s44, s41, 1966080
    buffer_load_dwordx4 v11, s[16:19], s44 offen lds

    ds_read_b64_tr_b16 a[8:9], v18 offset:16384
    ds_read_b64_tr_b16 a[10:11], v18 offset:16896
    ds_read_b64_tr_b16 a[12:13], v18 offset:24576
    ds_read_b64_tr_b16 a[14:15], v18 offset:25088
    ds_read_b64_tr_b16 a[88:89], v19 offset:16384
    ds_read_b64_tr_b16 a[90:91], v19 offset:16896
    ds_read_b64_tr_b16 a[92:93], v19 offset:24576
    ds_read_b64_tr_b16 a[94:95], v19 offset:25088
    s_waitcnt lgkmcnt(0)
    s_waitcnt vmcnt(4)
    s_barrier
    s_add_u32 s43, s42, 16384
    s_mov_b32 m0, s43
    s_add_u32 s44, s41, 2097152
    buffer_load_dwordx4 v11, s[16:19], s44 offen lds

    s_add_u32 s43, s42, 20480
    s_mov_b32 m0, s43
    s_add_u32 s44, s41, 2228224
    buffer_load_dwordx4 v11, s[16:19], s44 offen lds

    s_add_u32 s43, s42, 24576
    s_mov_b32 m0, s43
    s_add_u32 s44, s41, 2359296
    buffer_load_dwordx4 v11, s[16:19], s44 offen lds

    s_add_u32 s43, s42, 28672
    s_mov_b32 m0, s43
    s_add_u32 s44, s41, 2490368
    buffer_load_dwordx4 v11, s[16:19], s44 offen lds

    ds_read_b64_tr_b16 a[16:17], v18 offset:32768
    ds_read_b64_tr_b16 a[18:19], v18 offset:33280
    ds_read_b64_tr_b16 a[20:21], v18 offset:40960
    ds_read_b64_tr_b16 a[22:23], v18 offset:41472
    ds_read_b64_tr_b16 a[96:97], v19 offset:32768
    ds_read_b64_tr_b16 a[98:99], v19 offset:33280
    ds_read_b64_tr_b16 a[100:101], v19 offset:40960
    ds_read_b64_tr_b16 a[102:103], v19 offset:41472
    s_waitcnt lgkmcnt(0)
    ds_read_b64_tr_b16 a[160:161], v29 offset:0
    ds_read_b64_tr_b16 a[162:163], v29 offset:5120
    ds_read_b64_tr_b16 a[164:165], v29 offset:10240
    ds_read_b64_tr_b16 a[166:167], v29 offset:15360
    ds_read_b64_tr_b16 a[176:177], v29 offset:32
    ds_read_b64_tr_b16 a[178:179], v29 offset:5152
    ds_read_b64_tr_b16 a[180:181], v29 offset:10272
    ds_read_b64_tr_b16 a[182:183], v29 offset:15392
    s_waitcnt lgkmcnt(0)
    ds_read_b64_tr_b16 a[192:193], v29 offset:64
    ds_read_b64_tr_b16 a[194:195], v29 offset:5184
    ds_read_b64_tr_b16 a[196:197], v29 offset:10304
    ds_read_b64_tr_b16 a[198:199], v29 offset:15424
    ds_read_b64_tr_b16 a[208:209], v29 offset:96
    ds_read_b64_tr_b16 a[210:211], v29 offset:5216
    ds_read_b64_tr_b16 a[212:213], v29 offset:10336
    ds_read_b64_tr_b16 a[214:215], v29 offset:15456
    s_waitcnt lgkmcnt(0)
    ds_read_b64_tr_b16 a[224:225], v29 offset:128
    ds_read_b64_tr_b16 a[226:227], v29 offset:5248
    ds_read_b64_tr_b16 a[228:229], v29 offset:10368
    ds_read_b64_tr_b16 a[230:231], v29 offset:15488
    ds_read_b64_tr_b16 a[240:241], v29 offset:160
    ds_read_b64_tr_b16 a[242:243], v29 offset:5280
    ds_read_b64_tr_b16 a[244:245], v29 offset:10400
    ds_read_b64_tr_b16 a[246:247], v29 offset:15520
    s_waitcnt lgkmcnt(0)
    ds_read_b64_tr_b16 v[192:193], v29 offset:192
    ds_read_b64_tr_b16 v[194:195], v29 offset:5312
    ds_read_b64_tr_b16 v[196:197], v29 offset:10432
    ds_read_b64_tr_b16 v[198:199], v29 offset:15552
    ds_read_b64_tr_b16 v[208:209], v29 offset:224
    ds_read_b64_tr_b16 v[210:211], v29 offset:5344
    ds_read_b64_tr_b16 v[212:213], v29 offset:10464
    ds_read_b64_tr_b16 v[214:215], v29 offset:15584
    s_waitcnt lgkmcnt(0)
    ds_read_b64_tr_b16 v[224:225], v29 offset:256
    ds_read_b64_tr_b16 v[226:227], v29 offset:5376
    ds_read_b64_tr_b16 v[228:229], v29 offset:10496
    ds_read_b64_tr_b16 v[230:231], v29 offset:15616
    ds_read_b64_tr_b16 v[240:241], v29 offset:288
    ds_read_b64_tr_b16 v[242:243], v29 offset:5408
    ds_read_b64_tr_b16 v[244:245], v29 offset:10528
    ds_read_b64_tr_b16 v[246:247], v29 offset:15648
    s_waitcnt lgkmcnt(0)
    s_mov_b32 s45, s47
    s_mov_b32 m0, s45
    s_add_u32 s45, s45, 1024
    buffer_load_dwordx4 v24, s[20:23], s46 offen lds

    s_mov_b32 m0, s45
    s_add_u32 s45, s45, 1024
    buffer_load_dwordx4 v25, s[20:23], s46 offen lds

    s_mov_b32 m0, s45
    s_add_u32 s45, s45, 1024
    buffer_load_dwordx4 v26, s[20:23], s46 offen lds

    s_mov_b32 m0, s45
    s_add_u32 s45, s45, 1024
    buffer_load_dwordx4 v27, s[20:23], s46 offen lds

    s_mov_b32 m0, s45
    s_add_u32 s45, s45, 1024
    buffer_load_dwordx4 v28, s[20:23], s46 offen lds

    s_add_u32 s46, s46, 20480
    s_mov_b32 m0, s45
    s_add_u32 s45, s45, 1024
    buffer_load_dwordx4 v24, s[20:23], s46 offen lds

    s_mov_b32 m0, s45
    s_add_u32 s45, s45, 1024
    buffer_load_dwordx4 v25, s[20:23], s46 offen lds

    s_mov_b32 m0, s45
    s_add_u32 s45, s45, 1024
    buffer_load_dwordx4 v26, s[20:23], s46 offen lds

    s_mov_b32 m0, s45
    s_add_u32 s45, s45, 1024
    buffer_load_dwordx4 v27, s[20:23], s46 offen lds

    s_mov_b32 m0, s45
    s_add_u32 s45, s45, 1024
    buffer_load_dwordx4 v28, s[20:23], s46 offen lds

    s_add_u32 s46, s46, 20480
    s_mov_b32 m0, s45
    s_add_u32 s45, s45, 1024
    buffer_load_dwordx4 v24, s[20:23], s46 offen lds

    s_mov_b32 m0, s45
    s_add_u32 s45, s45, 1024
    buffer_load_dwordx4 v25, s[20:23], s46 offen lds

    s_mov_b32 m0, s45
    s_add_u32 s45, s45, 1024
    buffer_load_dwordx4 v26, s[20:23], s46 offen lds

    s_mov_b32 m0, s45
    s_add_u32 s45, s45, 1024
    buffer_load_dwordx4 v27, s[20:23], s46 offen lds

    s_mov_b32 m0, s45
    s_add_u32 s45, s45, 1024
    buffer_load_dwordx4 v28, s[20:23], s46 offen lds

    s_add_u32 s46, s46, 20480
    s_mov_b32 m0, s45
    s_add_u32 s45, s45, 1024
    buffer_load_dwordx4 v24, s[20:23], s46 offen lds

    s_mov_b32 m0, s45
    s_add_u32 s45, s45, 1024
    buffer_load_dwordx4 v25, s[20:23], s46 offen lds

    s_mov_b32 m0, s45
    s_add_u32 s45, s45, 1024
    buffer_load_dwordx4 v26, s[20:23], s46 offen lds

    s_mov_b32 m0, s45
    s_add_u32 s45, s45, 1024
    buffer_load_dwordx4 v27, s[20:23], s46 offen lds

    s_mov_b32 m0, s45
    s_add_u32 s45, s45, 1024
    buffer_load_dwordx4 v28, s[20:23], s46 offen lds

    s_add_u32 s46, s46, 20480
    s_waitcnt vmcnt(4)
    s_barrier
    s_add_u32 s43, s42, 32768
    s_mov_b32 m0, s43
    s_add_u32 s44, s41, 2621440
    buffer_load_dwordx4 v11, s[16:19], s44 offen lds

    s_add_u32 s43, s42, 36864
    s_mov_b32 m0, s43
    s_add_u32 s44, s41, 2752512
    buffer_load_dwordx4 v11, s[16:19], s44 offen lds

    s_add_u32 s43, s42, 40960
    s_mov_b32 m0, s43
    s_add_u32 s44, s41, 2883584
    buffer_load_dwordx4 v11, s[16:19], s44 offen lds

    s_add_u32 s43, s42, 45056
    s_mov_b32 m0, s43
    s_add_u32 s44, s41, 3014656
    buffer_load_dwordx4 v11, s[16:19], s44 offen lds

    ds_read_b64_tr_b16 a[24:25], v18 offset:0
    ds_read_b64_tr_b16 a[26:27], v18 offset:512
    ds_read_b64_tr_b16 a[28:29], v18 offset:8192
    ds_read_b64_tr_b16 a[30:31], v18 offset:8704
    ds_read_b64_tr_b16 a[104:105], v19 offset:0
    ds_read_b64_tr_b16 a[106:107], v19 offset:512
    ds_read_b64_tr_b16 a[108:109], v19 offset:8192
    ds_read_b64_tr_b16 a[110:111], v19 offset:8704
    s_waitcnt lgkmcnt(0)
    s_waitcnt vmcnt(4)
    s_barrier
    s_add_u32 s43, s42, 0
    s_mov_b32 m0, s43
    s_add_u32 s44, s41, 3145728
    buffer_load_dwordx4 v11, s[16:19], s44 offen lds

    s_add_u32 s43, s42, 4096
    s_mov_b32 m0, s43
    s_add_u32 s44, s41, 3276800
    buffer_load_dwordx4 v11, s[16:19], s44 offen lds

    s_add_u32 s43, s42, 8192
    s_mov_b32 m0, s43
    s_add_u32 s44, s41, 3407872
    buffer_load_dwordx4 v11, s[16:19], s44 offen lds

    s_add_u32 s43, s42, 12288
    s_mov_b32 m0, s43
    s_add_u32 s44, s41, 3538944
    buffer_load_dwordx4 v11, s[16:19], s44 offen lds

    ds_read_b64_tr_b16 a[32:33], v18 offset:16384
    ds_read_b64_tr_b16 a[34:35], v18 offset:16896
    ds_read_b64_tr_b16 a[36:37], v18 offset:24576
    ds_read_b64_tr_b16 a[38:39], v18 offset:25088
    ds_read_b64_tr_b16 a[112:113], v19 offset:16384
    ds_read_b64_tr_b16 a[114:115], v19 offset:16896
    ds_read_b64_tr_b16 a[116:117], v19 offset:24576
    ds_read_b64_tr_b16 a[118:119], v19 offset:25088
    s_waitcnt lgkmcnt(0)
    s_waitcnt vmcnt(4)
    s_barrier
    s_add_u32 s43, s42, 16384
    s_mov_b32 m0, s43
    s_add_u32 s44, s41, 3670016
    buffer_load_dwordx4 v11, s[16:19], s44 offen lds

    s_add_u32 s43, s42, 20480
    s_mov_b32 m0, s43
    s_add_u32 s44, s41, 3801088
    buffer_load_dwordx4 v11, s[16:19], s44 offen lds

    s_add_u32 s43, s42, 24576
    s_mov_b32 m0, s43
    s_add_u32 s44, s41, 3932160
    buffer_load_dwordx4 v11, s[16:19], s44 offen lds

    s_add_u32 s43, s42, 28672
    s_mov_b32 m0, s43
    s_add_u32 s44, s41, 4063232
    buffer_load_dwordx4 v11, s[16:19], s44 offen lds

    ds_read_b64_tr_b16 a[40:41], v18 offset:32768
    ds_read_b64_tr_b16 a[42:43], v18 offset:33280
    ds_read_b64_tr_b16 a[44:45], v18 offset:40960
    ds_read_b64_tr_b16 a[46:47], v18 offset:41472
    ds_read_b64_tr_b16 a[120:121], v19 offset:32768
    ds_read_b64_tr_b16 a[122:123], v19 offset:33280
    ds_read_b64_tr_b16 a[124:125], v19 offset:40960
    ds_read_b64_tr_b16 a[126:127], v19 offset:41472
    s_waitcnt lgkmcnt(0)
    s_waitcnt vmcnt(4)
    s_barrier
    s_add_u32 s43, s42, 32768
    s_mov_b32 m0, s43
    s_add_u32 s44, s41, 4194304
    buffer_load_dwordx4 v11, s[16:19], s44 offen lds

    s_add_u32 s43, s42, 36864
    s_mov_b32 m0, s43
    s_add_u32 s44, s41, 4325376
    buffer_load_dwordx4 v11, s[16:19], s44 offen lds

    s_add_u32 s43, s42, 40960
    s_mov_b32 m0, s43
    s_add_u32 s44, s41, 4456448
    buffer_load_dwordx4 v11, s[16:19], s44 offen lds

    s_add_u32 s43, s42, 45056
    s_mov_b32 m0, s43
    s_add_u32 s44, s41, 4587520
    buffer_load_dwordx4 v11, s[16:19], s44 offen lds

    ds_read_b64_tr_b16 a[48:49], v18 offset:0
    ds_read_b64_tr_b16 a[50:51], v18 offset:512
    ds_read_b64_tr_b16 a[52:53], v18 offset:8192
    ds_read_b64_tr_b16 a[54:55], v18 offset:8704
    ds_read_b64_tr_b16 a[128:129], v19 offset:0
    ds_read_b64_tr_b16 a[130:131], v19 offset:512
    ds_read_b64_tr_b16 a[132:133], v19 offset:8192
    ds_read_b64_tr_b16 a[134:135], v19 offset:8704
    s_waitcnt lgkmcnt(0)
    s_waitcnt vmcnt(4)
    s_barrier
    s_add_u32 s43, s42, 0
    s_mov_b32 m0, s43
    s_add_u32 s44, s41, 4718592
    buffer_load_dwordx4 v11, s[16:19], s44 offen lds

    s_add_u32 s43, s42, 4096
    s_mov_b32 m0, s43
    s_add_u32 s44, s41, 4849664
    buffer_load_dwordx4 v11, s[16:19], s44 offen lds

    s_add_u32 s43, s42, 8192
    s_mov_b32 m0, s43
    s_add_u32 s44, s41, 4980736
    buffer_load_dwordx4 v11, s[16:19], s44 offen lds

    s_add_u32 s43, s42, 12288
    s_mov_b32 m0, s43
    s_add_u32 s44, s41, 5111808
    buffer_load_dwordx4 v11, s[16:19], s44 offen lds

    ds_read_b64_tr_b16 a[56:57], v18 offset:16384
    ds_read_b64_tr_b16 a[58:59], v18 offset:16896
    ds_read_b64_tr_b16 a[60:61], v18 offset:24576
    ds_read_b64_tr_b16 a[62:63], v18 offset:25088
    ds_read_b64_tr_b16 a[136:137], v19 offset:16384
    ds_read_b64_tr_b16 a[138:139], v19 offset:16896
    ds_read_b64_tr_b16 a[140:141], v19 offset:24576
    ds_read_b64_tr_b16 a[142:143], v19 offset:25088
    s_waitcnt lgkmcnt(0)
    s_waitcnt vmcnt(4)
    s_barrier
    ds_read_b64_tr_b16 a[64:65], v18 offset:32768
    ds_read_b64_tr_b16 a[66:67], v18 offset:33280
    ds_read_b64_tr_b16 a[68:69], v18 offset:40960
    ds_read_b64_tr_b16 a[70:71], v18 offset:41472
    ds_read_b64_tr_b16 a[144:145], v19 offset:32768
    ds_read_b64_tr_b16 a[146:147], v19 offset:33280
    ds_read_b64_tr_b16 a[148:149], v19 offset:40960
    ds_read_b64_tr_b16 a[150:151], v19 offset:41472
    s_waitcnt lgkmcnt(0)
    s_waitcnt vmcnt(0)
    s_barrier
    ds_read_b64_tr_b16 a[72:73], v18 offset:0
    ds_read_b64_tr_b16 a[74:75], v18 offset:512
    ds_read_b64_tr_b16 a[76:77], v18 offset:8192
    ds_read_b64_tr_b16 a[78:79], v18 offset:8704
    ds_read_b64_tr_b16 a[152:153], v19 offset:0
    ds_read_b64_tr_b16 a[154:155], v19 offset:512
    ds_read_b64_tr_b16 a[156:157], v19 offset:8192
    ds_read_b64_tr_b16 a[158:159], v19 offset:8704
    s_waitcnt lgkmcnt(0)
    s_barrier
    ds_read_b64_tr_b16 a[168:169], v29 offset:0
    ds_read_b64_tr_b16 a[170:171], v29 offset:5120
    ds_read_b64_tr_b16 a[172:173], v29 offset:10240
    ds_read_b64_tr_b16 a[174:175], v29 offset:15360
    ds_read_b64_tr_b16 a[184:185], v29 offset:32
    ds_read_b64_tr_b16 a[186:187], v29 offset:5152
    ds_read_b64_tr_b16 a[188:189], v29 offset:10272
    ds_read_b64_tr_b16 a[190:191], v29 offset:15392
    s_waitcnt lgkmcnt(0)
    ds_read_b64_tr_b16 a[200:201], v29 offset:64
    ds_read_b64_tr_b16 a[202:203], v29 offset:5184
    ds_read_b64_tr_b16 a[204:205], v29 offset:10304
    ds_read_b64_tr_b16 a[206:207], v29 offset:15424
    ds_read_b64_tr_b16 a[216:217], v29 offset:96
    ds_read_b64_tr_b16 a[218:219], v29 offset:5216
    ds_read_b64_tr_b16 a[220:221], v29 offset:10336
    ds_read_b64_tr_b16 a[222:223], v29 offset:15456
    s_waitcnt lgkmcnt(0)
    ds_read_b64_tr_b16 a[232:233], v29 offset:128
    ds_read_b64_tr_b16 a[234:235], v29 offset:5248
    ds_read_b64_tr_b16 a[236:237], v29 offset:10368
    ds_read_b64_tr_b16 a[238:239], v29 offset:15488
    ds_read_b64_tr_b16 a[248:249], v29 offset:160
    ds_read_b64_tr_b16 a[250:251], v29 offset:5280
    ds_read_b64_tr_b16 a[252:253], v29 offset:10400
    ds_read_b64_tr_b16 a[254:255], v29 offset:15520
    s_waitcnt lgkmcnt(0)
    ds_read_b64_tr_b16 v[200:201], v29 offset:192
    ds_read_b64_tr_b16 v[202:203], v29 offset:5312
    ds_read_b64_tr_b16 v[204:205], v29 offset:10432
    ds_read_b64_tr_b16 v[206:207], v29 offset:15552
    ds_read_b64_tr_b16 v[216:217], v29 offset:224
    ds_read_b64_tr_b16 v[218:219], v29 offset:5344
    ds_read_b64_tr_b16 v[220:221], v29 offset:10464
    ds_read_b64_tr_b16 v[222:223], v29 offset:15584
    s_waitcnt lgkmcnt(0)
    ds_read_b64_tr_b16 v[232:233], v29 offset:256
    ds_read_b64_tr_b16 v[234:235], v29 offset:5376
    ds_read_b64_tr_b16 v[236:237], v29 offset:10496
    ds_read_b64_tr_b16 v[238:239], v29 offset:15616
    ds_read_b64_tr_b16 v[248:249], v29 offset:288
    ds_read_b64_tr_b16 v[250:251], v29 offset:5408
    ds_read_b64_tr_b16 v[252:253], v29 offset:10528
    ds_read_b64_tr_b16 v[254:255], v29 offset:15648
    s_waitcnt lgkmcnt(0)
    s_barrier
    s_cmp_lg_u32 s3, 0
    s_cbranch_scc1 dwg_53

dw_54:
    buffer_load_dword v3, off, s[12:15], 0 offset:160 sc1
    s_waitcnt vmcnt(0)
    v_readfirstlane_b32 s44, v3
    s_sub_u32 s30, s30, 1
    s_cmp_lt_i32 s30, 0
    s_cbranch_scc1 dwd_55
    s_cmp_ge_u32 s44, 1
    s_cbranch_scc1 dwd_55
    s_sleep 2
    s_branch dw_54

dwd_55:
dw_56:
    buffer_load_dword v3, off, s[12:15], 0 offset:192 sc1
    s_waitcnt vmcnt(0)
    v_readfirstlane_b32 s44, v3
    s_sub_u32 s30, s30, 1
    s_cmp_lt_i32 s30, 0
    s_cbranch_scc1 dwd_57
    s_cmp_ge_u32 s44, 1
    s_cbranch_scc1 dwd_57
    s_sleep 2
    s_branch dw_56

dwd_57:
dwg_53:
    s_barrier
    s_mul_i32 s43, s3, 10240
    s_add_u32 s44, s43, s37
    s_add_u32 s43, s43, s38

    s_mov_b32 m0, s43
    s_add_u32 s43, s43, 1024
    buffer_load_dwordx4 v5, s[8:11], s44 offen sc1 lds
    s_add_u32 s44, s44, 1024

    s_mov_b32 m0, s43
    s_add_u32 s43, s43, 1024
    buffer_load_dwordx4 v5, s[8:11], s44 offen sc1 lds
    s_add_u32 s44, s44, 1024

    s_mov_b32 m0, s43
    s_add_u32 s43, s43, 1024
    buffer_load_dwordx4 v5, s[8:11], s44 offen sc1 lds
    s_add_u32 s44, s44, 1024

    s_mov_b32 m0, s43
    s_add_u32 s43, s43, 1024
    buffer_load_dwordx4 v5, s[8:11], s44 offen sc1 lds
    s_add_u32 s44, s44, 1024

    s_mov_b32 m0, s43
    s_add_u32 s43, s43, 1024
    buffer_load_dwordx4 v5, s[8:11], s44 offen sc1 lds
    s_add_u32 s44, s44, 1024

    s_mov_b32 m0, s43
    s_add_u32 s43, s43, 1024
    buffer_load_dwordx4 v5, s[8:11], s44 offen sc1 lds
    s_add_u32 s44, s44, 1024

    s_mov_b32 m0, s43
    s_add_u32 s43, s43, 1024
    buffer_load_dwordx4 v5, s[8:11], s44 offen sc1 lds
    s_add_u32 s44, s44, 1024

    s_mov_b32 m0, s43
    s_add_u32 s43, s43, 1024
    buffer_load_dwordx4 v5, s[8:11], s44 offen sc1 lds
    s_add_u32 s44, s44, 1024

    s_mov_b32 m0, s43
    s_add_u32 s43, s43, 1024
    buffer_load_dwordx4 v5, s[8:11], s44 offen sc1 lds
    s_add_u32 s44, s44, 1024

    s_mov_b32 m0, s43
    s_add_u32 s43, s43, 1024
    buffer_load_dwordx4 v5, s[8:11], s44 offen sc1 lds
    s_add_u32 s44, s44, 1024

    s_mul_i32 s39, s28, 40960
    s_mul_i32 s40, s3, 10240
    s_add_u32 s39, s39, s40
    s_add_u32 s39, s39, 0x8000000
    s_lshl_b32 s34, s28, 7
    s_add_u32 s34, s34, 0x12000
    s_lshl_b32 s40, s3, 10
    s_add_u32 s40, s40, 0x14000
    v_add_u32 v12, s40, v5
    v_add_u32 v13, 0x14000, v5
    s_waitcnt vmcnt(0)
    s_barrier

vo_loop:
    v_add_u32 v14, s38, v5
    s_sub_u32 s38, 40960, s38
    s_add_u32 s37, s37, 40960

    s_add_u32 s45, s29, 1
    s_and_b32 s46, s45, 7
    s_cmp_lg_u32 s46, 0
    s_cbranch_scc1 lrd_59
    s_cmp_ge_u32 s45, 64
    s_cbranch_scc1 lrd_59
    s_lshr_b32 s45, s45, 1
lr_58:
    buffer_load_dword v3, off, s[12:15], s45 offset:192 sc1
    s_waitcnt vmcnt(0)
    v_readfirstlane_b32 s44, v3
    s_sub_u32 s30, s30, 1
    s_cmp_lt_i32 s30, 0
    s_cbranch_scc1 lrd_59
    s_cmp_ge_u32 s44, 1
    s_cbranch_scc1 lrd_59
    s_sleep 4
    s_branch lr_58
lrd_59:

    s_mul_i32 s43, s3, 10240
    s_add_u32 s44, s43, s37
    s_add_u32 s43, s43, s38

    ds_read_b128 v[104:107], v14 offset:0
    ds_read_b128 v[108:111], v14 offset:20480
    ds_read_b128 v[112:115], v14 offset:1024
    ds_read_b128 v[116:119], v14 offset:21504
    ds_read_b128 v[120:123], v14 offset:2048
    ds_read_b128 v[124:127], v14 offset:22528
    s_waitcnt lgkmcnt(4)
    v_mfma_f32_16x16x32_bf16 v[72:75], a[0:3], v[104:107], 0
    v_mfma_f32_16x16x32_bf16 v[76:79], a[0:3], v[108:111], 0
    s_mov_b32 m0, s43
    s_add_u32 s43, s43, 1024
    buffer_load_dwordx4 v5, s[8:11], s44 offen sc1 lds
    s_add_u32 s44, s44, 1024

    v_mfma_f32_16x16x32_bf16 v[80:83], a[80:83], v[104:107], 0
    v_mfma_f32_16x16x32_bf16 v[84:87], a[80:83], v[108:111], 0
    ds_read_b128 v[104:107], v14 offset:3072
    ds_read_b128 v[108:111], v14 offset:23552
    s_waitcnt lgkmcnt(4)
    v_mfma_f32_16x16x32_bf16 v[72:75], a[4:7], v[112:115], v[72:75]
    v_mfma_f32_16x16x32_bf16 v[76:79], a[4:7], v[116:119], v[76:79]
    v_mfma_f32_16x16x32_bf16 v[80:83], a[84:87], v[112:115], v[80:83]
    v_mfma_f32_16x16x32_bf16 v[84:87], a[84:87], v[116:119], v[84:87]
    ds_read_b128 v[112:115], v14 offset:4096
    ds_read_b128 v[116:119], v14 offset:24576
    s_waitcnt lgkmcnt(4)
    v_mfma_f32_16x16x32_bf16 v[72:75], a[8:11], v[120:123], v[72:75]
    v_mfma_f32_16x16x32_bf16 v[76:79], a[8:11], v[124:127], v[76:79]
    s_mov_b32 m0, s43
    s_add_u32 s43, s43, 1024
    buffer_load_dwordx4 v5, s[8:11], s44 offen sc1 lds
    s_add_u32 s44, s44, 1024

    v_mfma_f32_16x16x32_bf16 v[80:83], a[88:91], v[120:123], v[80:83]
    v_mfma_f32_16x16x32_bf16 v[84:87], a[88:91], v[124:127], v[84:87]
    ds_read_b128 v[120:123], v14 offset:5120
    ds_read_b128 v[124:127], v14 offset:25600
    s_waitcnt lgkmcnt(4)
    v_mfma_f32_16x16x32_bf16 v[72:75], a[12:15], v[104:107], v[72:75]
    v_mfma_f32_16x16x32_bf16 v[76:79], a[12:15], v[108:111], v[76:79]
    v_mfma_f32_16x16x32_bf16 v[80:83], a[92:95], v[104:107], v[80:83]
    v_mfma_f32_16x16x32_bf16 v[84:87], a[92:95], v[108:111], v[84:87]
    ds_read_b128 v[104:107], v14 offset:6144
    ds_read_b128 v[108:111], v14 offset:26624
    s_waitcnt lgkmcnt(4)
    v_mfma_f32_16x16x32_bf16 v[72:75], a[16:19], v[112:115], v[72:75]
    v_mfma_f32_16x16x32_bf16 v[76:79], a[16:19], v[116:119], v[76:79]
    s_mov_b32 m0, s43
    s_add_u32 s43, s43, 1024
    buffer_load_dwordx4 v5, s[8:11], s44 offen sc1 lds
    s_add_u32 s44, s44, 1024

    v_mfma_f32_16x16x32_bf16 v[80:83], a[96:99], v[112:115], v[80:83]
    v_mfma_f32_16x16x32_bf16 v[84:87], a[96:99], v[116:119], v[84:87]
    ds_read_b128 v[112:115], v14 offset:7168
    ds_read_b128 v[116:119], v14 offset:27648
    s_waitcnt lgkmcnt(4)
    v_mfma_f32_16x16x32_bf16 v[72:75], a[20:23], v[120:123], v[72:75]
    v_mfma_f32_16x16x32_bf16 v[76:79], a[20:23], v[124:127], v[76:79]
    v_mfma_f32_16x16x32_bf16 v[80:83], a[100:103], v[120:123], v[80:83]
    v_mfma_f32_16x16x32_bf16 v[84:87], a[100:103], v[124:127], v[84:87]
    ds_read_b128 v[120:123], v14 offset:8192
    ds_read_b128 v[124:127], v14 offset:28672
    s_waitcnt lgkmcnt(4)
    v_mfma_f32_16x16x32_bf16 v[72:75], a[24:27], v[104:107], v[72:75]
    v_mfma_f32_16x16x32_bf16 v[76:79], a[24:27], v[108:111], v[76:79]
    s_mov_b32 m0, s43
    s_add_u32 s43, s43, 1024
    buffer_load_dwordx4 v5, s[8:11], s44 offen sc1 lds
    s_add_u32 s44, s44, 1024

    v_mfma_f32_16x16x32_bf16 v[80:83], a[104:107], v[104:107], v[80:83]
    v_mfma_f32_16x16x32_bf16 v[84:87], a[104:107], v[108:111], v[84:87]
    ds_read_b128 v[104:107], v14 offset:9216
    ds_read_b128 v[108:111], v14 offset:29696
    s_waitcnt lgkmcnt(4)
    v_mfma_f32_16x16x32_bf16 v[72:75], a[28:31], v[112:115], v[72:75]
    v_mfma_f32_16x16x32_bf16 v[76:79], a[28:31], v[116:119], v[76:79]
    v_mfma_f32_16x16x32_bf16 v[80:83], a[108:111], v[112:115], v[80:83]
    v_mfma_f32_16x16x32_bf16 v[84:87], a[108:111], v[116:119], v[84:87]
    ds_read_b128 v[112:115], v14 offset:10240
    ds_read_b128 v[116:119], v14 offset:30720
    s_waitcnt lgkmcnt(4)
    v_mfma_f32_16x16x32_bf16 v[72:75], a[32:35], v[120:123], v[72:75]
    v_mfma_f32_16x16x32_bf16 v[76:79], a[32:35], v[124:127], v[76:79]
    s_mov_b32 m0, s43
    s_add_u32 s43, s43, 1024
    buffer_load_dwordx4 v5, s[8:11], s44 offen sc1 lds
    s_add_u32 s44, s44, 1024

    v_mfma_f32_16x16x32_bf16 v[80:83], a[112:115], v[120:123], v[80:83]
    v_mfma_f32_16x16x32_bf16 v[84:87], a[112:115], v[124:127], v[84:87]
    ds_read_b128 v[120:123], v14 offset:11264
    ds_read_b128 v[124:127], v14 offset:31744
    s_waitcnt lgkmcnt(4)
    v_mfma_f32_16x16x32_bf16 v[72:75], a[36:39], v[104:107], v[72:75]
    v_mfma_f32_16x16x32_bf16 v[76:79], a[36:39], v[108:111], v[76:79]
    v_mfma_f32_16x16x32_bf16 v[80:83], a[116:119], v[104:107], v[80:83]
    v_mfma_f32_16x16x32_bf16 v[84:87], a[116:119], v[108:111], v[84:87]
    ds_read_b128 v[104:107], v14 offset:12288
    ds_read_b128 v[108:111], v14 offset:32768
    s_waitcnt lgkmcnt(4)
    v_mfma_f32_16x16x32_bf16 v[72:75], a[40:43], v[112:115], v[72:75]
    v_mfma_f32_16x16x32_bf16 v[76:79], a[40:43], v[116:119], v[76:79]
    s_mov_b32 m0, s43
    s_add_u32 s43, s43, 1024
    buffer_load_dwordx4 v5, s[8:11], s44 offen sc1 lds
    s_add_u32 s44, s44, 1024

    v_mfma_f32_16x16x32_bf16 v[80:83], a[120:123], v[112:115], v[80:83]
    v_mfma_f32_16x16x32_bf16 v[84:87], a[120:123], v[116:119], v[84:87]
    ds_read_b128 v[112:115], v14 offset:13312
    ds_read_b128 v[116:119], v14 offset:33792
    s_waitcnt lgkmcnt(4)
    v_mfma_f32_16x16x32_bf16 v[72:75], a[44:47], v[120:123], v[72:75]
    v_mfma_f32_16x16x32_bf16 v[76:79], a[44:47], v[124:127], v[76:79]
    v_mfma_f32_16x16x32_bf16 v[80:83], a[124:127], v[120:123], v[80:83]
    v_mfma_f32_16x16x32_bf16 v[84:87], a[124:127], v[124:127], v[84:87]
    ds_read_b128 v[120:123], v14 offset:14336
    ds_read_b128 v[124:127], v14 offset:34816
    s_waitcnt lgkmcnt(4)
    v_mfma_f32_16x16x32_bf16 v[72:75], a[48:51], v[104:107], v[72:75]
    v_mfma_f32_16x16x32_bf16 v[76:79], a[48:51], v[108:111], v[76:79]
    s_mov_b32 m0, s43
    s_add_u32 s43, s43, 1024
    buffer_load_dwordx4 v5, s[8:11], s44 offen sc1 lds
    s_add_u32 s44, s44, 1024

    v_mfma_f32_16x16x32_bf16 v[80:83], a[128:131], v[104:107], v[80:83]
    v_mfma_f32_16x16x32_bf16 v[84:87], a[128:131], v[108:111], v[84:87]
    ds_read_b128 v[104:107], v14 offset:15360
    ds_read_b128 v[108:111], v14 offset:35840
    s_waitcnt lgkmcnt(4)
    v_mfma_f32_16x16x32_bf16 v[72:75], a[52:55], v[112:115], v[72:75]
    v_mfma_f32_16x16x32_bf16 v[76:79], a[52:55], v[116:119], v[76:79]
    v_mfma_f32_16x16x32_bf16 v[80:83], a[132:135], v[112:115], v[80:83]
    v_mfma_f32_16x16x32_bf16 v[84:87], a[132:135], v[116:119], v[84:87]
    ds_read_b128 v[112:115], v14 offset:16384
    ds_read_b128 v[116:119], v14 offset:36864
    s_waitcnt lgkmcnt(4)
    v_mfma_f32_16x16x32_bf16 v[72:75], a[56:59], v[120:123], v[72:75]
    v_mfma_f32_16x16x32_bf16 v[76:79], a[56:59], v[124:127], v[76:79]
    s_mov_b32 m0, s43
    s_add_u32 s43, s43, 1024
    buffer_load_dwordx4 v5, s[8:11], s44 offen sc1 lds
    s_add_u32 s44, s44, 1024

    v_mfma_f32_16x16x32_bf16 v[80:83], a[136:139], v[120:123], v[80:83]
    v_mfma_f32_16x16x32_bf16 v[84:87], a[136:139], v[124:127], v[84:87]
    ds_read_b128 v[120:123], v14 offset:17408
    ds_read_b128 v[124:127], v14 offset:37888
    s_waitcnt lgkmcnt(4)
    v_mfma_f32_16x16x32_bf16 v[72:75], a[60:63], v[104:107], v[72:75]
    v_mfma_f32_16x16x32_bf16 v[76:79], a[60:63], v[108:111], v[76:79]
    v_mfma_f32_16x16x32_bf16 v[80:83], a[140:143], v[104:107], v[80:83]
    v_mfma_f32_16x16x32_bf16 v[84:87], a[140:143], v[108:111], v[84:87]
    ds_read_b128 v[104:107], v14 offset:18432
    ds_read_b128 v[108:111], v14 offset:38912
    s_waitcnt lgkmcnt(4)
    v_mfma_f32_16x16x32_bf16 v[72:75], a[64:67], v[112:115], v[72:75]
    v_mfma_f32_16x16x32_bf16 v[76:79], a[64:67], v[116:119], v[76:79]
    s_mov_b32 m0, s43
    s_add_u32 s43, s43, 1024
    buffer_load_dwordx4 v5, s[8:11], s44 offen sc1 lds
    s_add_u32 s44, s44, 1024

    v_mfma_f32_16x16x32_bf16 v[80:83], a[144:147], v[112:115], v[80:83]
    v_mfma_f32_16x16x32_bf16 v[84:87], a[144:147], v[116:119], v[84:87]
    ds_read_b128 v[112:115], v14 offset:19456
    ds_read_b128 v[116:119], v14 offset:39936
    s_waitcnt lgkmcnt(4)
    v_mfma_f32_16x16x32_bf16 v[72:75], a[68:71], v[120:123], v[72:75]
    v_mfma_f32_16x16x32_bf16 v[76:79], a[68:71], v[124:127], v[76:79]
    v_mfma_f32_16x16x32_bf16 v[80:83], a[148:151], v[120:123], v[80:83]
    v_mfma_f32_16x16x32_bf16 v[84:87], a[148:151], v[124:127], v[84:87]
    s_waitcnt lgkmcnt(2)
    v_mfma_f32_16x16x32_bf16 v[72:75], a[72:75], v[104:107], v[72:75]
    v_mfma_f32_16x16x32_bf16 v[76:79], a[72:75], v[108:111], v[76:79]
    s_mov_b32 m0, s43
    s_add_u32 s43, s43, 1024
    buffer_load_dwordx4 v5, s[8:11], s44 offen sc1 lds
    s_add_u32 s44, s44, 1024

    v_mfma_f32_16x16x32_bf16 v[80:83], a[152:155], v[104:107], v[80:83]
    v_mfma_f32_16x16x32_bf16 v[84:87], a[152:155], v[108:111], v[84:87]
    s_waitcnt lgkmcnt(0)
    v_mfma_f32_16x16x32_bf16 v[72:75], a[76:79], v[112:115], v[72:75]
    v_mfma_f32_16x16x32_bf16 v[76:79], a[76:79], v[116:119], v[76:79]
    v_mfma_f32_16x16x32_bf16 v[80:83], a[156:159], v[112:115], v[80:83]
    v_mfma_f32_16x16x32_bf16 v[84:87], a[156:159], v[116:119], v[84:87]
    s_nop 5
    v_cvt_pk_bf16_f32 v168, v72, v73
    v_cvt_pk_bf16_f32 v169, v74, v75
    v_cvt_pk_bf16_f32 v170, v80, v81
    v_cvt_pk_bf16_f32 v171, v82, v83
    ds_write_b128 v12, v[168:171] offset:0
    v_cvt_pk_bf16_f32 v172, v76, v77
    v_cvt_pk_bf16_f32 v173, v78, v79
    v_cvt_pk_bf16_f32 v174, v84, v85
    v_cvt_pk_bf16_f32 v175, v86, v87
    ds_write_b128 v12, v[172:175] offset:4096
    s_waitcnt vmcnt(10) lgkmcnt(0)
    s_barrier

    ds_read_b128 v[16:19], v13 offset:0
    ds_read_b128 v[32:35], v13 offset:4096
    ds_read_b128 v[20:23], v13 offset:1024
    ds_read_b128 v[36:39], v13 offset:5120
    ds_read_b128 v[24:27], v13 offset:2048
    ds_read_b128 v[40:43], v13 offset:6144
    ds_read_b128 v[28:31], v13 offset:3072
    ds_read_b128 v[44:47], v13 offset:7168
    s_cmp_lg_u32 s3, 3
    s_cbranch_scc1 pub_60
    v_mov_b32 v3, s29
    s_mov_b64 exec, 1
    buffer_store_dword v3, off, s[8:11], s34 sc1
    s_mov_b64 exec, -1
pub_60:

    s_waitcnt lgkmcnt(6)
    v_mfma_f32_16x16x32_bf16 v[128:131], v[16:19], a[160:163], 0
    v_mfma_f32_16x16x32_bf16 v[132:135], v[32:35], a[160:163], 0
    v_mfma_f32_16x16x32_bf16 v[136:139], v[16:19], a[176:179], 0
    v_mfma_f32_16x16x32_bf16 v[140:143], v[32:35], a[176:179], 0
    v_mfma_f32_16x16x32_bf16 v[144:147], v[16:19], a[192:195], 0
    v_mfma_f32_16x16x32_bf16 v[148:151], v[32:35], a[192:195], 0
    v_mfma_f32_16x16x32_bf16 v[152:155], v[16:19], a[208:211], 0
    v_mfma_f32_16x16x32_bf16 v[156:159], v[32:35], a[208:211], 0
    v_mfma_f32_16x16x32_bf16 v[160:163], v[16:19], a[224:227], 0
    v_mfma_f32_16x16x32_bf16 v[164:167], v[32:35], a[224:227], 0
    s_waitcnt lgkmcnt(4)
    v_mfma_f32_16x16x32_bf16 v[128:131], v[20:23], a[164:167], v[128:131]
    v_mfma_f32_16x16x32_bf16 v[132:135], v[36:39], a[164:167], v[132:135]
    v_mfma_f32_16x16x32_bf16 v[136:139], v[20:23], a[180:183], v[136:139]
    v_mfma_f32_16x16x32_bf16 v[140:143], v[36:39], a[180:183], v[140:143]
    v_mfma_f32_16x16x32_bf16 v[144:147], v[20:23], a[196:199], v[144:147]
    v_mfma_f32_16x16x32_bf16 v[148:151], v[36:39], a[196:199], v[148:151]
    v_mfma_f32_16x16x32_bf16 v[152:155], v[20:23], a[212:215], v[152:155]
    v_mfma_f32_16x16x32_bf16 v[156:159], v[36:39], a[212:215], v[156:159]
    v_mfma_f32_16x16x32_bf16 v[160:163], v[20:23], a[228:231], v[160:163]
    v_mfma_f32_16x16x32_bf16 v[164:167], v[36:39], a[228:231], v[164:167]
    s_waitcnt lgkmcnt(2)
    v_mfma_f32_16x16x32_bf16 v[128:131], v[24:27], a[168:171], v[128:131]
    v_mfma_f32_16x16x32_bf16 v[132:135], v[40:43], a[168:171], v[132:135]
    v_mfma_f32_16x16x32_bf16 v[136:139], v[24:27], a[184:187], v[136:139]
    v_mfma_f32_16x16x32_bf16 v[140:143], v[40:43], a[184:187], v[140:143]
    v_mfma_f32_16x16x32_bf16 v[144:147], v[24:27], a[200:203], v[144:147]
    v_mfma_f32_16x16x32_bf16 v[148:151], v[40:43], a[200:203], v[148:151]
    v_mfma_f32_16x16x32_bf16 v[152:155], v[24:27], a[216:219], v[152:155]
    v_mfma_f32_16x16x32_bf16 v[156:159], v[40:43], a[216:219], v[156:159]
    v_mfma_f32_16x16x32_bf16 v[160:163], v[24:27], a[232:235], v[160:163]
    v_mfma_f32_16x16x32_bf16 v[164:167], v[40:43], a[232:235], v[164:167]
    s_waitcnt lgkmcnt(0)
    v_mfma_f32_16x16x32_bf16 v[128:131], v[28:31], a[172:175], v[128:131]
    v_mfma_f32_16x16x32_bf16 v[132:135], v[44:47], a[172:175], v[132:135]
    v_mfma_f32_16x16x32_bf16 v[136:139], v[28:31], a[188:191], v[136:139]
    v_mfma_f32_16x16x32_bf16 v[140:143], v[44:47], a[188:191], v[140:143]
    v_mfma_f32_16x16x32_bf16 v[144:147], v[28:31], a[204:207], v[144:147]
    v_mfma_f32_16x16x32_bf16 v[148:151], v[44:47], a[204:207], v[148:151]
    v_mfma_f32_16x16x32_bf16 v[152:155], v[28:31], a[220:223], v[152:155]
    v_mfma_f32_16x16x32_bf16 v[156:159], v[44:47], a[220:223], v[156:159]
    v_mfma_f32_16x16x32_bf16 v[160:163], v[28:31], a[236:239], v[160:163]
    v_mfma_f32_16x16x32_bf16 v[164:167], v[44:47], a[236:239], v[164:167]
    v_mfma_f32_16x16x32_bf16 v[72:75], v[16:19], a[240:243], 0
    v_mfma_f32_16x16x32_bf16 v[76:79], v[32:35], a[240:243], 0
    v_cvt_pk_bf16_f32 v168, v128, v129
    v_cvt_pk_bf16_f32 v169, v130, v131
    v_cvt_pk_bf16_f32 v170, v132, v133
    v_cvt_pk_bf16_f32 v171, v134, v135
    buffer_store_dwordx4 v[168:171], v5, s[8:11], s39 offen offset:0 sc1
    v_mfma_f32_16x16x32_bf16 v[80:83], v[16:19], v[192:195], 0
    v_mfma_f32_16x16x32_bf16 v[84:87], v[32:35], v[192:195], 0
    v_cvt_pk_bf16_f32 v172, v136, v137
    v_cvt_pk_bf16_f32 v173, v138, v139
    v_cvt_pk_bf16_f32 v174, v140, v141
    v_cvt_pk_bf16_f32 v175, v142, v143
    buffer_store_dwordx4 v[172:175], v5, s[8:11], s39 offen offset:1024 sc1
    v_mfma_f32_16x16x32_bf16 v[88:91], v[16:19], v[208:211], 0
    v_mfma_f32_16x16x32_bf16 v[92:95], v[32:35], v[208:211], 0
    v_mfma_f32_16x16x32_bf16 v[96:99], v[16:19], v[224:227], 0
    v_mfma_f32_16x16x32_bf16 v[100:103], v[32:35], v[224:227], 0
    v_mfma_f32_16x16x32_bf16 v[104:107], v[16:19], v[240:243], 0
    v_mfma_f32_16x16x32_bf16 v[108:111], v[32:35], v[240:243], 0
    v_mfma_f32_16x16x32_bf16 v[72:75], v[20:23], a[244:247], v[72:75]
    v_mfma_f32_16x16x32_bf16 v[76:79], v[36:39], a[244:247], v[76:79]
    v_cvt_pk_bf16_f32 v168, v144, v145
    v_cvt_pk_bf16_f32 v169, v146, v147
    v_cvt_pk_bf16_f32 v170, v148, v149
    v_cvt_pk_bf16_f32 v171, v150, v151
    buffer_store_dwordx4 v[168:171], v5, s[8:11], s39 offen offset:2048 sc1
    v_mfma_f32_16x16x32_bf16 v[80:83], v[20:23], v[196:199], v[80:83]
    v_mfma_f32_16x16x32_bf16 v[84:87], v[36:39], v[196:199], v[84:87]
    v_cvt_pk_bf16_f32 v172, v152, v153
    v_cvt_pk_bf16_f32 v173, v154, v155
    v_cvt_pk_bf16_f32 v174, v156, v157
    v_cvt_pk_bf16_f32 v175, v158, v159
    buffer_store_dwordx4 v[172:175], v5, s[8:11], s39 offen offset:3072 sc1
    v_mfma_f32_16x16x32_bf16 v[88:91], v[20:23], v[212:215], v[88:91]
    v_mfma_f32_16x16x32_bf16 v[92:95], v[36:39], v[212:215], v[92:95]
    v_mfma_f32_16x16x32_bf16 v[96:99], v[20:23], v[228:231], v[96:99]
    v_mfma_f32_16x16x32_bf16 v[100:103], v[36:39], v[228:231], v[100:103]
    v_mfma_f32_16x16x32_bf16 v[104:107], v[20:23], v[244:247], v[104:107]
    v_mfma_f32_16x16x32_bf16 v[108:111], v[36:39], v[244:247], v[108:111]
    v_mfma_f32_16x16x32_bf16 v[72:75], v[24:27], a[248:251], v[72:75]
    v_mfma_f32_16x16x32_bf16 v[76:79], v[40:43], a[248:251], v[76:79]
    v_cvt_pk_bf16_f32 v168, v160, v161
    v_cvt_pk_bf16_f32 v169, v162, v163
    v_cvt_pk_bf16_f32 v170, v164, v165
    v_cvt_pk_bf16_f32 v171, v166, v167
    buffer_store_dwordx4 v[168:171], v6, s[8:11], s39 offen offset:0 sc1
    v_mfma_f32_16x16x32_bf16 v[80:83], v[24:27], v[200:203], v[80:83]
    v_mfma_f32_16x16x32_bf16 v[84:87], v[40:43], v[200:203], v[84:87]
    v_mfma_f32_16x16x32_bf16 v[88:91], v[24:27], v[216:219], v[88:91]
    v_mfma_f32_16x16x32_bf16 v[92:95], v[40:43], v[216:219], v[92:95]
    v_mfma_f32_16x16x32_bf16 v[96:99], v[24:27], v[232:235], v[96:99]
    v_mfma_f32_16x16x32_bf16 v[100:103], v[40:43], v[232:235], v[100:103]
    v_mfma_f32_16x16x32_bf16 v[104:107], v[24:27], v[248:251], v[104:107]
    v_mfma_f32_16x16x32_bf16 v[108:111], v[40:43], v[248:251], v[108:111]
    v_mfma_f32_16x16x32_bf16 v[72:75], v[28:31], a[252:255], v[72:75]
    v_mfma_f32_16x16x32_bf16 v[76:79], v[44:47], a[252:255], v[76:79]
    v_mfma_f32_16x16x32_bf16 v[80:83], v[28:31], v[204:207], v[80:83]
    v_mfma_f32_16x16x32_bf16 v[84:87], v[44:47], v[204:207], v[84:87]
    v_mfma_f32_16x16x32_bf16 v[88:91], v[28:31], v[220:223], v[88:91]
    v_mfma_f32_16x16x32_bf16 v[92:95], v[44:47], v[220:223], v[92:95]
    v_mfma_f32_16x16x32_bf16 v[96:99], v[28:31], v[236:239], v[96:99]
    v_mfma_f32_16x16x32_bf16 v[100:103], v[44:47], v[236:239], v[100:103]
    v_mfma_f32_16x16x32_bf16 v[104:107], v[28:31], v[252:255], v[104:107]
    v_mfma_f32_16x16x32_bf16 v[108:111], v[44:47], v[252:255], v[108:111]
    v_cvt_pk_bf16_f32 v176, v72, v73
    v_cvt_pk_bf16_f32 v177, v74, v75
    v_cvt_pk_bf16_f32 v178, v76, v77
    v_cvt_pk_bf16_f32 v179, v78, v79
    buffer_store_dwordx4 v[176:179], v6, s[8:11], s39 offen offset:1024 sc1
    v_cvt_pk_bf16_f32 v180, v80, v81
    v_cvt_pk_bf16_f32 v181, v82, v83
    v_cvt_pk_bf16_f32 v182, v84, v85
    v_cvt_pk_bf16_f32 v183, v86, v87
    buffer_store_dwordx4 v[180:183], v6, s[8:11], s39 offen offset:2048 sc1
    v_cvt_pk_bf16_f32 v176, v88, v89
    v_cvt_pk_bf16_f32 v177, v90, v91
    v_cvt_pk_bf16_f32 v178, v92, v93
    v_cvt_pk_bf16_f32 v179, v94, v95
    buffer_store_dwordx4 v[176:179], v6, s[8:11], s39 offen offset:3072 sc1
    v_cvt_pk_bf16_f32 v180, v96, v97
    v_cvt_pk_bf16_f32 v181, v98, v99
    v_cvt_pk_bf16_f32 v182, v100, v101
    v_cvt_pk_bf16_f32 v183, v102, v103
    buffer_store_dwordx4 v[180:183], v7, s[8:11], s39 offen offset:0 sc1
    v_cvt_pk_bf16_f32 v176, v104, v105
    v_cvt_pk_bf16_f32 v177, v106, v107
    v_cvt_pk_bf16_f32 v178, v108, v109
    v_cvt_pk_bf16_f32 v179, v110, v111
    buffer_store_dwordx4 v[176:179], v7, s[8:11], s39 offen offset:1024 sc1
    s_add_u32 s39, s39, 1310720
    s_cmp_ge_u32 s29, 2
    s_cbranch_scc1 vo_ne
    s_add_u32 s46, s29, 1
    s_waitcnt vmcnt(0)
    s_barrier

    s_cmp_lg_u32 s3, 3
    s_cbranch_scc1 pub_61
    v_mov_b32 v3, s46
    s_mov_b64 exec, 1
    buffer_store_dword v3, off, s[8:11], s34 sc1
    s_mov_b64 exec, -1
pub_61:

vo_ne:
    s_waitcnt vmcnt(10)
    s_barrier

    s_add_u32 s29, s29, 1
    s_cmp_lt_u32 s29, 64
    s_cbranch_scc1 vo_loop
    s_waitcnt vmcnt(0)
    s_barrier

    s_cmp_lg_u32 s3, 3
    s_cbranch_scc1 pub_62
    v_mov_b32 v3, s29
    s_mov_b64 exec, 1
    buffer_store_dword v3, off, s[8:11], s34 sc1
    s_mov_b64 exec, -1
pub_62:

    s_mov_b32 s29, 0
    s_add_u32 s97, s97, 691200
    s_branch help_f
help_c:
    s_cmp_ge_u32 s28, 25
    s_cbranch_scc1 vo_a
    s_add_u32 s28, s28, 209
    s_branch role_c
vo_a:
    s_cmp_ge_u32 s28, 28
    s_cbranch_scc1 r_end
    s_add_u32 s28, s28, 156
    s_mov_b32 s100, 57
    s_branch role_a

role_al:
    s_sub_u32 s40, s28, 176
    s_sub_u32 s41, s28, 196
    s_cmp_lt_u32 s28, 184
    s_cselect_b32 s40, s40, s41
    s_lshl_b32 s40, s40, 1
    s_and_b32 s41, s3, 1
    s_add_u32 s28, s40, s41
    s_cmp_ge_u32 s3, 2
    s_cbranch_scc1 role_l
    s_branch role_a2

role_a:
    s_sub_u32 s28, s28, 176
    s_lshl_b32 s28, s28, 2
    s_add_u32 s28, s28, s3
role_a2:
    v_bfe_u32 v10, v2, 3, 1
    v_and_b32 v11, 7, v2
    v_lshrrev_b32 v15, 4, v2
    v_lshlrev_b32 v8, 7, v15
    v_lshl_add_u32 v8, v11, 4, v8
    v_mul_u32_u24 v10, 20480, v10
    v_lshl_add_u32 v12, v11, 4, v10
    v_and_b32 v11, 1, v15
    v_lshl_add_u32 v12, v11, 3, v12
    v_lshrrev_b32 v11, 1, v15
    v_lshl_add_u32 v13, v11, 7, v12
    v_lshl_add_u32 v12, v11, 8, v12
    v_and_b32 v10, 15, v2
    v_lshlrev_b32 v11, 2, v15

    v_add_u32 v15, 0, v11
    v_cmp_le_u32 s[64:65], v15, v10
    v_add_u32 v15, 1, v11
    v_cmp_le_u32 s[66:67], v15, v10
    v_add_u32 v15, 2, v11
    v_cmp_le_u32 s[68:69], v15, v10
    v_add_u32 v15, 3, v11
    v_cmp_le_u32 s[70:71], v15, v10
    s_mov_b32 s54, 0
    s_mov_b32 s55, -1
    s_lshl_b32 s32, s28, 9
    s_add_u32 s32, s32, 0x800000
    s_lshr_b32 s40, s28, 2
    s_lshl_b32 s40, s40, 1
    s_and_b32 s41, s28, 1
    s_add_u32 s40, s40, s41
    s_lshl_b32 s40, s40, 8
    s_bfe_u32 s41, s28, 0x10001
    s_lshl_b32 s41, s41, 2
    s_add_u32 s40, s40, s41
    s_add_u32 s40, s40, 16384
    s_lshl_b32 s41, s28, 9
    s_sub_u32 s61, s40, s41
    s_lshl_b32 s58, s28, 7
    s_add_u32 s59, s58, 0x16800
    s_add_u32 s58, s58, 0x15800
    s_mov_b32 s60, 0
    s_lshl_b32 s33, s28, 13
    s_add_u32 s33, s33, 0x3800000
    s_lshl_b32 s57, s28, 11
    s_add_u32 s57, s57, 0xe00000
    s_lshl_b32 s34, s28, 7
    s_add_u32 s34, s34, 0x10080
    s_mov_b32 s35, 0
    s_mov_b32 s29, s100
    s_cmp_eq_u32 s100, 0
    s_cbranch_scc1 a_prim
    s_add_u32 s32, s32, 4669440
    s_add_u32 s33, s33, 14942208
    s_add_u32 s57, s57, 3735552
    s_mov_b32 s59, 0x1cd00

wf_63:
    s_cmp_ge_u32 s60, s100
    s_cbranch_scc1 wfd_64
    buffer_load_dword v120, off, s[8:11], s58 sc1
    s_waitcnt vmcnt(0)
    v_readfirstlane_b32 s60, v120
    s_nop 3
    s_cmp_ge_u32 s60, s100
    s_cbranch_scc1 wfd_64
    s_sub_u32 s30, s30, 1
    s_cmp_lt_i32 s30, 0
    s_cbranch_scc1 wfd_64
    s_sleep 32
    s_branch wf_63

wfd_64:
a_prim:
    s_add_u32 s36, s29, 1
wf_65:
    s_cmp_ge_u32 s35, s36
    s_cbranch_scc1 wfd_66
    buffer_load_dword v121, off, s[8:11], s34 sc1
    s_waitcnt vmcnt(0)
    v_readfirstlane_b32 s35, v121
    s_nop 3
    s_cmp_ge_u32 s35, s36
    s_cbranch_scc1 wfd_66
    s_sub_u32 s30, s30, 1
    s_cmp_lt_i32 s30, 0
    s_cbranch_scc1 wfd_66
    s_sleep 8
    s_branch wf_65

wfd_66:
    s_add_u32 s40, s33, 0x1000000
    buffer_load_dwordx4 v[16:19], v5, s[8:11], s33 offen offset:0 sc1
    buffer_load_dwordx4 v[20:23], v5, s[8:11], s33 offen offset:1024 sc1
    buffer_load_dwordx4 v[24:27], v5, s[8:11], s33 offen offset:2048 sc1
    buffer_load_dwordx4 v[28:31], v5, s[8:11], s33 offen offset:3072 sc1
    buffer_load_dwordx4 v[32:35], v6, s[8:11], s33 offen offset:0 sc1
    buffer_load_dwordx4 v[36:39], v6, s[8:11], s33 offen offset:1024 sc1
    buffer_load_dwordx4 v[40:43], v6, s[8:11], s33 offen offset:2048 sc1
    buffer_load_dwordx4 v[44:47], v6, s[8:11], s33 offen offset:3072 sc1
    buffer_load_dwordx4 v[48:51], v5, s[8:11], s40 offen offset:0 sc1
    buffer_load_dwordx4 v[52:55], v5, s[8:11], s40 offen offset:1024 sc1
    buffer_load_dwordx4 v[56:59], v5, s[8:11], s40 offen offset:2048 sc1
    buffer_load_dwordx4 v[60:63], v5, s[8:11], s40 offen offset:3072 sc1
    buffer_load_dwordx4 v[64:67], v6, s[8:11], s40 offen offset:0 sc1
    buffer_load_dwordx4 v[68:71], v6, s[8:11], s40 offen offset:1024 sc1
    buffer_load_dwordx4 v[72:75], v6, s[8:11], s40 offen offset:2048 sc1
    buffer_load_dwordx4 v[76:79], v6, s[8:11], s40 offen offset:3072 sc1
    s_add_u32 s33, s33, 262144
    s_mov_b32 s47, 0
a_loop:
    s_add_u32 s36, s29, 1
    s_cmp_eq_u32 s47, 1
    s_cbranch_scc1 a_chk0
    s_cmp_ge_u32 s29, 56
    s_cbranch_scc1 a_kml0

wf_67:
    s_cmp_ge_u32 s60, s36
    s_cbranch_scc1 wfd_68
    buffer_load_dword v120, off, s[8:11], s58 sc1
    s_waitcnt vmcnt(0)
    v_readfirstlane_b32 s60, v120
    s_nop 3
    s_cmp_ge_u32 s60, s36
    s_cbranch_scc1 wfd_68
    s_sub_u32 s30, s30, 1
    s_cmp_lt_i32 s30, 0
    s_cbranch_scc1 wfd_68
    s_sleep 4
    s_branch wf_67

wfd_68:
a_kml0:
    buffer_load_dwordx4 v[80:83], v8, s[8:11], s57 offen offset:0 sc1
    buffer_load_dwordx4 v[84:87], v8, s[8:11], s57 offen offset:512 sc1
    buffer_load_dwordx4 v[88:91], v8, s[8:11], s57 offen offset:1024 sc1
    buffer_load_dwordx4 v[92:95], v8, s[8:11], s57 offen offset:1536 sc1
a_chk0:
    s_waitcnt vmcnt(0)
    v_max3_u32 v120, v80, v81, v82
    v_max3_u32 v120, v120, v83, v84
    v_max3_u32 v120, v120, v85, v86
    v_max3_u32 v120, v120, v87, v88
    v_max3_u32 v120, v120, v89, v90
    v_max3_u32 v120, v120, v91, v92
    v_max3_u32 v120, v120, v93, v94
    v_max_u32 v120, v120, v95
    v_cmp_eq_u32 vcc, -1, v120
    s_cbranch_vccz pok_69
    s_sub_u32 s30, s30, 1
    s_cmp_lt_i32 s30, 0
    s_cbranch_scc1 pok_69
    s_sleep 3
    s_branch a_kml0

pok_69:
    s_cmp_ge_u32 s29, 56
    s_cselect_b32 s46, 2, 1
    s_cselect_b32 s45, 262144, 0
    s_add_u32 s33, s33, s45
    s_add_u32 s45, s36, s46
    s_min_u32 s45, s45, 64

    v_mfma_f32_16x16x32_bf16 v[96:99], v[16:19], v[48:51], 0
    v_mfma_f32_16x16x32_bf16 v[104:107], v[80:83], v[48:51], 0
    v_mfma_f32_16x16x32_bf16 v[96:99], v[20:23], v[52:55], v[96:99]
    v_mfma_f32_16x16x32_bf16 v[104:107], v[84:87], v[52:55], v[104:107]
    v_mfma_f32_16x16x32_bf16 v[96:99], v[24:27], v[56:59], v[96:99]
    v_mfma_f32_16x16x32_bf16 v[104:107], v[88:91], v[56:59], v[104:107]
    v_mfma_f32_16x16x32_bf16 v[96:99], v[28:31], v[60:63], v[96:99]
    v_mfma_f32_16x16x32_bf16 v[104:107], v[92:95], v[60:63], v[104:107]
    v_mfma_f32_16x16x32_bf16 v[108:111], v[16:19], v[64:67], 0
    v_mfma_f32_16x16x32_bf16 v[112:115], v[32:35], v[64:67], 0
    v_mfma_f32_16x16x32_bf16 v[116:119], v[80:83], v[64:67], 0
    v_mfma_f32_16x16x32_bf16 v[108:111], v[20:23], v[68:71], v[108:111]
    v_mfma_f32_16x16x32_bf16 v[112:115], v[36:39], v[68:71], v[112:115]
    v_mfma_f32_16x16x32_bf16 v[116:119], v[84:87], v[68:71], v[116:119]
    v_mfma_f32_16x16x32_bf16 v[108:111], v[24:27], v[72:75], v[108:111]
    v_mfma_f32_16x16x32_bf16 v[112:115], v[40:43], v[72:75], v[112:115]
    v_mfma_f32_16x16x32_bf16 v[116:119], v[88:91], v[72:75], v[116:119]
    v_mfma_f32_16x16x32_bf16 v[108:111], v[28:31], v[76:79], v[108:111]
    v_mfma_f32_16x16x32_bf16 v[112:115], v[44:47], v[76:79], v[112:115]
    v_mfma_f32_16x16x32_bf16 v[116:119], v[92:95], v[76:79], v[116:119]
    s_nop 1
    v_cndmask_b32 v104, v104, v106, s[54:55]
    v_cndmask_b32 v105, v105, v107, s[54:55]

    v_cvt_pk_bf16_f32 v128, v96, v97
    v_cvt_pk_bf16_f32 v129, v98, v99
    v_cvt_pk_bf16_f32 v130, v104, v105
    v_lshlrev_b32 v96, 16, v128
    v_and_b32 v97, 0xffff0000, v128
    v_lshlrev_b32 v98, 16, v129
    v_and_b32 v99, 0xffff0000, v129
    v_lshlrev_b32 v104, 16, v130
    v_and_b32 v105, 0xffff0000, v130
    v_mul_f32 v96, s50, v96
    v_mul_f32 v97, s50, v97
    v_mul_f32 v98, s50, v98
    v_mul_f32 v99, s50, v99
    v_mul_f32 v104, s50, v104
    v_mul_f32 v105, s50, v105
    v_cvt_pk_bf16_f32 v128, v96, v97
    v_cvt_pk_bf16_f32 v129, v98, v99
    v_cvt_pk_bf16_f32 v130, v104, v105
    v_lshlrev_b32 v96, 16, v128
    v_and_b32 v97, 0xffff0000, v128
    v_lshlrev_b32 v98, 16, v129
    v_and_b32 v99, 0xffff0000, v129
    v_lshlrev_b32 v104, 16, v130
    v_and_b32 v105, 0xffff0000, v130
    v_mov_b32 v120, 0xce6e6b28
    v_cndmask_b32 v96, v120, v96, s[64:65]
    v_cndmask_b32 v97, v120, v97, s[66:67]
    v_cndmask_b32 v98, v120, v98, s[68:69]
    v_cndmask_b32 v99, v120, v99, s[70:71]
    v_max3_f32 v126, v96, v97, v98
    v_max3_f32 v126, v126, v99, v104
    v_max_f32 v126, v126, v105
    v_mov_b32 v127, v126
    s_nop 1
    v_permlane16_swap_b32 v126, v127
    v_max_f32 v126, v126, v127
    v_mov_b32 v127, v126
    s_nop 1
    v_permlane32_swap_b32 v126, v127
    v_max_f32 v126, v126, v127
    v_sub_f32 v96, v96, v126
    v_sub_f32 v97, v97, v126
    v_sub_f32 v98, v98, v126
    v_sub_f32 v99, v99, v126
    v_sub_f32 v104, v104, v126
    v_sub_f32 v105, v105, v126
    v_mul_f32 v96, s51, v96
    v_mul_f32 v97, s51, v97
    v_mul_f32 v98, s51, v98
    v_mul_f32 v99, s51, v99
    v_mul_f32 v104, s51, v104
    v_mul_f32 v105, s51, v105
    v_exp_f32 v96, v96
    v_exp_f32 v97, v97
    v_exp_f32 v98, v98
    v_exp_f32 v99, v99
    v_exp_f32 v104, v104
    v_exp_f32 v105, v105
    v_add_f32 v126, v96, v97
    v_add_f32 v126, v126, v98
    v_add_f32 v126, v126, v99
    v_add_f32 v126, v126, v104
    v_add_f32 v126, v126, v105
    v_mov_b32 v127, v126
    s_nop 1
    v_permlane16_swap_b32 v126, v127
    v_add_f32 v126, v126, v127
    v_mov_b32 v127, v126
    s_nop 1
    v_permlane32_swap_b32 v126, v127
    v_add_f32 v126, v126, v127
    v_rcp_f32 v126, v126
    s_nop 0
    v_mul_f32 v96, v96, v126
    v_mul_f32 v97, v97, v126
    v_mul_f32 v98, v98, v126
    v_mul_f32 v99, v99, v126
    v_mul_f32 v104, v104, v126
    v_mul_f32 v105, v105, v126
    v_cvt_pk_bf16_f32 v208, v96, v97
    v_mov_b32 v209, 0
    v_cvt_pk_bf16_f32 v210, v98, v99
    v_mov_b32 v211, 0
    v_cvt_pk_bf16_f32 v212, v104, v105
    v_min_u32 v208, -2, v208
    v_min_u32 v209, -2, v209
    v_min_u32 v210, -2, v210
    v_min_u32 v211, -2, v211
    v_min_u32 v212, -2, v212
    s_add_u32 s40, s32, 0
    buffer_store_dwordx2 v[208:209], v12, s[8:11], s40 offen offset:0 sc1
    buffer_store_dwordx2 v[210:211], v12, s[8:11], s40 offen offset:128 sc1
    s_add_u32 s40, s40, s61
    buffer_store_dword v212, v13, s[8:11], s40 offen sc1
    buffer_load_dword v122, off, s[8:11], s58 sc1
wf_70:
    s_cmp_ge_u32 s35, s45
    s_cbranch_scc1 wfd_71
    buffer_load_dword v121, off, s[8:11], s34 sc1
    s_waitcnt vmcnt(0)
    v_readfirstlane_b32 s35, v121
    s_nop 3
    s_cmp_ge_u32 s35, s45
    s_cbranch_scc1 wfd_71
    s_sub_u32 s30, s30, 1
    s_cmp_lt_i32 s30, 0
    s_cbranch_scc1 wfd_71
    s_sleep 8
    s_branch wf_70

wfd_71:
    s_add_u32 s40, s33, 0x1000000
    buffer_load_dwordx4 v[144:147], v5, s[8:11], s33 offen offset:0 sc1
    buffer_load_dwordx4 v[148:151], v5, s[8:11], s33 offen offset:1024 sc1
    buffer_load_dwordx4 v[152:155], v5, s[8:11], s33 offen offset:2048 sc1
    buffer_load_dwordx4 v[156:159], v5, s[8:11], s33 offen offset:3072 sc1
    buffer_load_dwordx4 v[160:163], v6, s[8:11], s33 offen offset:0 sc1
    buffer_load_dwordx4 v[164:167], v6, s[8:11], s33 offen offset:1024 sc1
    buffer_load_dwordx4 v[168:171], v6, s[8:11], s33 offen offset:2048 sc1
    buffer_load_dwordx4 v[172:175], v6, s[8:11], s33 offen offset:3072 sc1
    buffer_load_dwordx4 v[176:179], v5, s[8:11], s40 offen offset:0 sc1
    buffer_load_dwordx4 v[180:183], v5, s[8:11], s40 offen offset:1024 sc1
    buffer_load_dwordx4 v[184:187], v5, s[8:11], s40 offen offset:2048 sc1
    buffer_load_dwordx4 v[188:191], v5, s[8:11], s40 offen offset:3072 sc1
    buffer_load_dwordx4 v[192:195], v6, s[8:11], s40 offen offset:0 sc1
    buffer_load_dwordx4 v[196:199], v6, s[8:11], s40 offen offset:1024 sc1
    buffer_load_dwordx4 v[200:203], v6, s[8:11], s40 offen offset:2048 sc1
    buffer_load_dwordx4 v[204:207], v6, s[8:11], s40 offen offset:3072 sc1
    s_add_u32 s33, s33, 262144
    v_cndmask_b32 v116, v116, v118, s[54:55]
    v_cndmask_b32 v117, v117, v119, s[54:55]

    v_cvt_pk_bf16_f32 v128, v108, v109
    v_cvt_pk_bf16_f32 v129, v110, v111
    v_cvt_pk_bf16_f32 v130, v112, v113
    v_cvt_pk_bf16_f32 v131, v114, v115
    v_cvt_pk_bf16_f32 v132, v116, v117
    v_lshlrev_b32 v108, 16, v128
    v_and_b32 v109, 0xffff0000, v128
    v_lshlrev_b32 v110, 16, v129
    v_and_b32 v111, 0xffff0000, v129
    v_lshlrev_b32 v112, 16, v130
    v_and_b32 v113, 0xffff0000, v130
    v_lshlrev_b32 v114, 16, v131
    v_and_b32 v115, 0xffff0000, v131
    v_lshlrev_b32 v116, 16, v132
    v_and_b32 v117, 0xffff0000, v132
    v_mul_f32 v108, s50, v108
    v_mul_f32 v109, s50, v109
    v_mul_f32 v110, s50, v110
    v_mul_f32 v111, s50, v111
    v_mul_f32 v112, s50, v112
    v_mul_f32 v113, s50, v113
    v_mul_f32 v114, s50, v114
    v_mul_f32 v115, s50, v115
    v_mul_f32 v116, s50, v116
    v_mul_f32 v117, s50, v117
    v_cvt_pk_bf16_f32 v128, v108, v109
    v_cvt_pk_bf16_f32 v129, v110, v111
    v_cvt_pk_bf16_f32 v130, v112, v113
    v_cvt_pk_bf16_f32 v131, v114, v115
    v_cvt_pk_bf16_f32 v132, v116, v117
    v_lshlrev_b32 v108, 16, v128
    v_and_b32 v109, 0xffff0000, v128
    v_lshlrev_b32 v110, 16, v129
    v_and_b32 v111, 0xffff0000, v129
    v_lshlrev_b32 v112, 16, v130
    v_and_b32 v113, 0xffff0000, v130
    v_lshlrev_b32 v114, 16, v131
    v_and_b32 v115, 0xffff0000, v131
    v_lshlrev_b32 v116, 16, v132
    v_and_b32 v117, 0xffff0000, v132
    v_mov_b32 v120, 0xce6e6b28
    v_cndmask_b32 v112, v120, v112, s[64:65]
    v_cndmask_b32 v113, v120, v113, s[66:67]
    v_cndmask_b32 v114, v120, v114, s[68:69]
    v_cndmask_b32 v115, v120, v115, s[70:71]
    v_max3_f32 v126, v108, v109, v110
    v_max3_f32 v126, v126, v111, v112
    v_max3_f32 v126, v126, v113, v114
    v_max3_f32 v126, v126, v115, v116
    v_max_f32 v126, v126, v117
    v_mov_b32 v127, v126
    s_nop 1
    v_permlane16_swap_b32 v126, v127
    v_max_f32 v126, v126, v127
    v_mov_b32 v127, v126
    s_nop 1
    v_permlane32_swap_b32 v126, v127
    v_max_f32 v126, v126, v127
    v_sub_f32 v108, v108, v126
    v_sub_f32 v109, v109, v126
    v_sub_f32 v110, v110, v126
    v_sub_f32 v111, v111, v126
    v_sub_f32 v112, v112, v126
    v_sub_f32 v113, v113, v126
    v_sub_f32 v114, v114, v126
    v_sub_f32 v115, v115, v126
    v_sub_f32 v116, v116, v126
    v_sub_f32 v117, v117, v126
    v_mul_f32 v108, s51, v108
    v_mul_f32 v109, s51, v109
    v_mul_f32 v110, s51, v110
    v_mul_f32 v111, s51, v111
    v_mul_f32 v112, s51, v112
    v_mul_f32 v113, s51, v113
    v_mul_f32 v114, s51, v114
    v_mul_f32 v115, s51, v115
    v_mul_f32 v116, s51, v116
    v_mul_f32 v117, s51, v117
    v_exp_f32 v108, v108
    v_exp_f32 v109, v109
    v_exp_f32 v110, v110
    v_exp_f32 v111, v111
    v_exp_f32 v112, v112
    v_exp_f32 v113, v113
    v_exp_f32 v114, v114
    v_exp_f32 v115, v115
    v_exp_f32 v116, v116
    v_exp_f32 v117, v117
    v_add_f32 v126, v108, v109
    v_add_f32 v126, v126, v110
    v_add_f32 v126, v126, v111
    v_add_f32 v126, v126, v112
    v_add_f32 v126, v126, v113
    v_add_f32 v126, v126, v114
    v_add_f32 v126, v126, v115
    v_add_f32 v126, v126, v116
    v_add_f32 v126, v126, v117
    v_mov_b32 v127, v126
    s_nop 1
    v_permlane16_swap_b32 v126, v127
    v_add_f32 v126, v126, v127
    v_mov_b32 v127, v126
    s_nop 1
    v_permlane32_swap_b32 v126, v127
    v_add_f32 v126, v126, v127
    v_rcp_f32 v126, v126
    s_nop 0
    v_mul_f32 v108, v108, v126
    v_mul_f32 v109, v109, v126
    v_mul_f32 v110, v110, v126
    v_mul_f32 v111, v111, v126
    v_mul_f32 v112, v112, v126
    v_mul_f32 v113, v113, v126
    v_mul_f32 v114, v114, v126
    v_mul_f32 v115, v115, v126
    v_mul_f32 v116, v116, v126
    v_mul_f32 v117, v117, v126
    v_cvt_pk_bf16_f32 v216, v108, v109
    v_cvt_pk_bf16_f32 v217, v112, v113
    v_cvt_pk_bf16_f32 v218, v110, v111
    v_cvt_pk_bf16_f32 v219, v114, v115
    v_cvt_pk_bf16_f32 v220, v116, v117
    v_min_u32 v216, -2, v216
    v_min_u32 v217, -2, v217
    v_min_u32 v218, -2, v218
    v_min_u32 v219, -2, v219
    v_min_u32 v220, -2, v220
    s_add_u32 s40, s32, 40960
    buffer_store_dwordx2 v[216:217], v12, s[8:11], s40 offen offset:0 sc1
    buffer_store_dwordx2 v[218:219], v12, s[8:11], s40 offen offset:128 sc1
    s_add_u32 s40, s40, s61
    buffer_store_dword v220, v13, s[8:11], s40 offen sc1
    s_lshl_b32 s40, s46, 16
    s_add_u32 s57, s57, s40
    s_mul_i32 s40, s46, 81920
    s_add_u32 s32, s32, s40
    v_mov_b32 v120, s36
    s_waitcnt vmcnt(19)
    v_readfirstlane_b32 s60, v122
    s_add_u32 s29, s29, s46
    s_mov_b32 s47, 0
    s_nop 1
    s_cmp_le_u32 s60, s29
    s_cbranch_scc1 a_nk0
    s_mov_b32 s47, 1

    buffer_load_dwordx4 v[80:83], v8, s[8:11], s57 offen offset:0 sc1
    buffer_load_dwordx4 v[84:87], v8, s[8:11], s57 offen offset:512 sc1
    buffer_load_dwordx4 v[88:91], v8, s[8:11], s57 offen offset:1024 sc1
    buffer_load_dwordx4 v[92:95], v8, s[8:11], s57 offen offset:1536 sc1
    s_waitcnt vmcnt(4)
    s_branch a_pub0
a_nk0:
    s_waitcnt vmcnt(0)
a_pub0:
    s_mov_b64 exec, 1
    buffer_store_dword v120, off, s[8:11], s59 sc1
    s_mov_b64 exec, -1

    s_cmp_ge_u32 s29, 64
    s_cbranch_scc1 r_end

    s_add_u32 s36, s29, 1
    s_cmp_eq_u32 s47, 1
    s_cbranch_scc1 a_chk1
    s_cmp_ge_u32 s29, 56
    s_cbranch_scc1 a_kml1

wf_72:
    s_cmp_ge_u32 s60, s36
    s_cbranch_scc1 wfd_73
    buffer_load_dword v120, off, s[8:11], s58 sc1
    s_waitcnt vmcnt(0)
    v_readfirstlane_b32 s60, v120
    s_nop 3
    s_cmp_ge_u32 s60, s36
    s_cbranch_scc1 wfd_73
    s_sub_u32 s30, s30, 1
    s_cmp_lt_i32 s30, 0
    s_cbranch_scc1 wfd_73
    s_sleep 4
    s_branch wf_72

wfd_73:
a_kml1:
    buffer_load_dwordx4 v[80:83], v8, s[8:11], s57 offen offset:0 sc1
    buffer_load_dwordx4 v[84:87], v8, s[8:11], s57 offen offset:512 sc1
    buffer_load_dwordx4 v[88:91], v8, s[8:11], s57 offen offset:1024 sc1
    buffer_load_dwordx4 v[92:95], v8, s[8:11], s57 offen offset:1536 sc1
a_chk1:
    s_waitcnt vmcnt(0)
    v_max3_u32 v120, v80, v81, v82
    v_max3_u32 v120, v120, v83, v84
    v_max3_u32 v120, v120, v85, v86
    v_max3_u32 v120, v120, v87, v88
    v_max3_u32 v120, v120, v89, v90
    v_max3_u32 v120, v120, v91, v92
    v_max3_u32 v120, v120, v93, v94
    v_max_u32 v120, v120, v95
    v_cmp_eq_u32 vcc, -1, v120
    s_cbranch_vccz pok_74
    s_sub_u32 s30, s30, 1
    s_cmp_lt_i32 s30, 0
    s_cbranch_scc1 pok_74
    s_sleep 3
    s_branch a_kml1

pok_74:
    s_cmp_ge_u32 s29, 56
    s_cselect_b32 s46, 2, 1
    s_cselect_b32 s45, 262144, 0
    s_add_u32 s33, s33, s45
    s_add_u32 s45, s36, s46
    s_min_u32 s45, s45, 64

    v_mfma_f32_16x16x32_bf16 v[96:99], v[144:147], v[176:179], 0
    v_mfma_f32_16x16x32_bf16 v[104:107], v[80:83], v[176:179], 0
    v_mfma_f32_16x16x32_bf16 v[96:99], v[148:151], v[180:183], v[96:99]
    v_mfma_f32_16x16x32_bf16 v[104:107], v[84:87], v[180:183], v[104:107]
    v_mfma_f32_16x16x32_bf16 v[96:99], v[152:155], v[184:187], v[96:99]
    v_mfma_f32_16x16x32_bf16 v[104:107], v[88:91], v[184:187], v[104:107]
    v_mfma_f32_16x16x32_bf16 v[96:99], v[156:159], v[188:191], v[96:99]
    v_mfma_f32_16x16x32_bf16 v[104:107], v[92:95], v[188:191], v[104:107]
    v_mfma_f32_16x16x32_bf16 v[108:111], v[144:147], v[192:195], 0
    v_mfma_f32_16x16x32_bf16 v[112:115], v[160:163], v[192:195], 0
    v_mfma_f32_16x16x32_bf16 v[116:119], v[80:83], v[192:195], 0
    v_mfma_f32_16x16x32_bf16 v[108:111], v[148:151], v[196:199], v[108:111]
    v_mfma_f32_16x16x32_bf16 v[112:115], v[164:167], v[196:199], v[112:115]
    v_mfma_f32_16x16x32_bf16 v[116:119], v[84:87], v[196:199], v[116:119]
    v_mfma_f32_16x16x32_bf16 v[108:111], v[152:155], v[200:203], v[108:111]
    v_mfma_f32_16x16x32_bf16 v[112:115], v[168:171], v[200:203], v[112:115]
    v_mfma_f32_16x16x32_bf16 v[116:119], v[88:91], v[200:203], v[116:119]
    v_mfma_f32_16x16x32_bf16 v[108:111], v[156:159], v[204:207], v[108:111]
    v_mfma_f32_16x16x32_bf16 v[112:115], v[172:175], v[204:207], v[112:115]
    v_mfma_f32_16x16x32_bf16 v[116:119], v[92:95], v[204:207], v[116:119]
    s_nop 1
    v_cndmask_b32 v104, v104, v106, s[54:55]
    v_cndmask_b32 v105, v105, v107, s[54:55]

    v_cvt_pk_bf16_f32 v128, v96, v97
    v_cvt_pk_bf16_f32 v129, v98, v99
    v_cvt_pk_bf16_f32 v130, v104, v105
    v_lshlrev_b32 v96, 16, v128
    v_and_b32 v97, 0xffff0000, v128
    v_lshlrev_b32 v98, 16, v129
    v_and_b32 v99, 0xffff0000, v129
    v_lshlrev_b32 v104, 16, v130
    v_and_b32 v105, 0xffff0000, v130
    v_mul_f32 v96, s50, v96
    v_mul_f32 v97, s50, v97
    v_mul_f32 v98, s50, v98
    v_mul_f32 v99, s50, v99
    v_mul_f32 v104, s50, v104
    v_mul_f32 v105, s50, v105
    v_cvt_pk_bf16_f32 v128, v96, v97
    v_cvt_pk_bf16_f32 v129, v98, v99
    v_cvt_pk_bf16_f32 v130, v104, v105
    v_lshlrev_b32 v96, 16, v128
    v_and_b32 v97, 0xffff0000, v128
    v_lshlrev_b32 v98, 16, v129
    v_and_b32 v99, 0xffff0000, v129
    v_lshlrev_b32 v104, 16, v130
    v_and_b32 v105, 0xffff0000, v130
    v_mov_b32 v120, 0xce6e6b28
    v_cndmask_b32 v96, v120, v96, s[64:65]
    v_cndmask_b32 v97, v120, v97, s[66:67]
    v_cndmask_b32 v98, v120, v98, s[68:69]
    v_cndmask_b32 v99, v120, v99, s[70:71]
    v_max3_f32 v126, v96, v97, v98
    v_max3_f32 v126, v126, v99, v104
    v_max_f32 v126, v126, v105
    v_mov_b32 v127, v126
    s_nop 1
    v_permlane16_swap_b32 v126, v127
    v_max_f32 v126, v126, v127
    v_mov_b32 v127, v126
    s_nop 1
    v_permlane32_swap_b32 v126, v127
    v_max_f32 v126, v126, v127
    v_sub_f32 v96, v96, v126
    v_sub_f32 v97, v97, v126
    v_sub_f32 v98, v98, v126
    v_sub_f32 v99, v99, v126
    v_sub_f32 v104, v104, v126
    v_sub_f32 v105, v105, v126
    v_mul_f32 v96, s51, v96
    v_mul_f32 v97, s51, v97
    v_mul_f32 v98, s51, v98
    v_mul_f32 v99, s51, v99
    v_mul_f32 v104, s51, v104
    v_mul_f32 v105, s51, v105
    v_exp_f32 v96, v96
    v_exp_f32 v97, v97
    v_exp_f32 v98, v98
    v_exp_f32 v99, v99
    v_exp_f32 v104, v104
    v_exp_f32 v105, v105
    v_add_f32 v126, v96, v97
    v_add_f32 v126, v126, v98
    v_add_f32 v126, v126, v99
    v_add_f32 v126, v126, v104
    v_add_f32 v126, v126, v105
    v_mov_b32 v127, v126
    s_nop 1
    v_permlane16_swap_b32 v126, v127
    v_add_f32 v126, v126, v127
    v_mov_b32 v127, v126
    s_nop 1
    v_permlane32_swap_b32 v126, v127
    v_add_f32 v126, v126, v127
    v_rcp_f32 v126, v126
    s_nop 0
    v_mul_f32 v96, v96, v126
    v_mul_f32 v97, v97, v126
    v_mul_f32 v98, v98, v126
    v_mul_f32 v99, v99, v126
    v_mul_f32 v104, v104, v126
    v_mul_f32 v105, v105, v126
    v_cvt_pk_bf16_f32 v208, v96, v97
    v_mov_b32 v209, 0
    v_cvt_pk_bf16_f32 v210, v98, v99
    v_mov_b32 v211, 0
    v_cvt_pk_bf16_f32 v212, v104, v105
    v_min_u32 v208, -2, v208
    v_min_u32 v209, -2, v209
    v_min_u32 v210, -2, v210
    v_min_u32 v211, -2, v211
    v_min_u32 v212, -2, v212
    s_add_u32 s40, s32, 0
    buffer_store_dwordx2 v[208:209], v12, s[8:11], s40 offen offset:0 sc1
    buffer_store_dwordx2 v[210:211], v12, s[8:11], s40 offen offset:128 sc1
    s_add_u32 s40, s40, s61
    buffer_store_dword v212, v13, s[8:11], s40 offen sc1
    buffer_load_dword v122, off, s[8:11], s58 sc1
wf_75:
    s_cmp_ge_u32 s35, s45
    s_cbranch_scc1 wfd_76
    buffer_load_dword v121, off, s[8:11], s34 sc1
    s_waitcnt vmcnt(0)
    v_readfirstlane_b32 s35, v121
    s_nop 3
    s_cmp_ge_u32 s35, s45
    s_cbranch_scc1 wfd_76
    s_sub_u32 s30, s30, 1
    s_cmp_lt_i32 s30, 0
    s_cbranch_scc1 wfd_76
    s_sleep 8
    s_branch wf_75

wfd_76:
    s_add_u32 s40, s33, 0x1000000
    buffer_load_dwordx4 v[16:19], v5, s[8:11], s33 offen offset:0 sc1
    buffer_load_dwordx4 v[20:23], v5, s[8:11], s33 offen offset:1024 sc1
    buffer_load_dwordx4 v[24:27], v5, s[8:11], s33 offen offset:2048 sc1
    buffer_load_dwordx4 v[28:31], v5, s[8:11], s33 offen offset:3072 sc1
    buffer_load_dwordx4 v[32:35], v6, s[8:11], s33 offen offset:0 sc1
    buffer_load_dwordx4 v[36:39], v6, s[8:11], s33 offen offset:1024 sc1
    buffer_load_dwordx4 v[40:43], v6, s[8:11], s33 offen offset:2048 sc1
    buffer_load_dwordx4 v[44:47], v6, s[8:11], s33 offen offset:3072 sc1
    buffer_load_dwordx4 v[48:51], v5, s[8:11], s40 offen offset:0 sc1
    buffer_load_dwordx4 v[52:55], v5, s[8:11], s40 offen offset:1024 sc1
    buffer_load_dwordx4 v[56:59], v5, s[8:11], s40 offen offset:2048 sc1
    buffer_load_dwordx4 v[60:63], v5, s[8:11], s40 offen offset:3072 sc1
    buffer_load_dwordx4 v[64:67], v6, s[8:11], s40 offen offset:0 sc1
    buffer_load_dwordx4 v[68:71], v6, s[8:11], s40 offen offset:1024 sc1
    buffer_load_dwordx4 v[72:75], v6, s[8:11], s40 offen offset:2048 sc1
    buffer_load_dwordx4 v[76:79], v6, s[8:11], s40 offen offset:3072 sc1
    s_add_u32 s33, s33, 262144
    v_cndmask_b32 v116, v116, v118, s[54:55]
    v_cndmask_b32 v117, v117, v119, s[54:55]

    v_cvt_pk_bf16_f32 v128, v108, v109
    v_cvt_pk_bf16_f32 v129, v110, v111
    v_cvt_pk_bf16_f32 v130, v112, v113
    v_cvt_pk_bf16_f32 v131, v114, v115
    v_cvt_pk_bf16_f32 v132, v116, v117
    v_lshlrev_b32 v108, 16, v128
    v_and_b32 v109, 0xffff0000, v128
    v_lshlrev_b32 v110, 16, v129
    v_and_b32 v111, 0xffff0000, v129
    v_lshlrev_b32 v112, 16, v130
    v_and_b32 v113, 0xffff0000, v130
    v_lshlrev_b32 v114, 16, v131
    v_and_b32 v115, 0xffff0000, v131
    v_lshlrev_b32 v116, 16, v132
    v_and_b32 v117, 0xffff0000, v132
    v_mul_f32 v108, s50, v108
    v_mul_f32 v109, s50, v109
    v_mul_f32 v110, s50, v110
    v_mul_f32 v111, s50, v111
    v_mul_f32 v112, s50, v112
    v_mul_f32 v113, s50, v113
    v_mul_f32 v114, s50, v114
    v_mul_f32 v115, s50, v115
    v_mul_f32 v116, s50, v116
    v_mul_f32 v117, s50, v117
    v_cvt_pk_bf16_f32 v128, v108, v109
    v_cvt_pk_bf16_f32 v129, v110, v111
    v_cvt_pk_bf16_f32 v130, v112, v113
    v_cvt_pk_bf16_f32 v131, v114, v115
    v_cvt_pk_bf16_f32 v132, v116, v117
    v_lshlrev_b32 v108, 16, v128
    v_and_b32 v109, 0xffff0000, v128
    v_lshlrev_b32 v110, 16, v129
    v_and_b32 v111, 0xffff0000, v129
    v_lshlrev_b32 v112, 16, v130
    v_and_b32 v113, 0xffff0000, v130
    v_lshlrev_b32 v114, 16, v131
    v_and_b32 v115, 0xffff0000, v131
    v_lshlrev_b32 v116, 16, v132
    v_and_b32 v117, 0xffff0000, v132
    v_mov_b32 v120, 0xce6e6b28
    v_cndmask_b32 v112, v120, v112, s[64:65]
    v_cndmask_b32 v113, v120, v113, s[66:67]
    v_cndmask_b32 v114, v120, v114, s[68:69]
    v_cndmask_b32 v115, v120, v115, s[70:71]
    v_max3_f32 v126, v108, v109, v110
    v_max3_f32 v126, v126, v111, v112
    v_max3_f32 v126, v126, v113, v114
    v_max3_f32 v126, v126, v115, v116
    v_max_f32 v126, v126, v117
    v_mov_b32 v127, v126
    s_nop 1
    v_permlane16_swap_b32 v126, v127
    v_max_f32 v126, v126, v127
    v_mov_b32 v127, v126
    s_nop 1
    v_permlane32_swap_b32 v126, v127
    v_max_f32 v126, v126, v127
    v_sub_f32 v108, v108, v126
    v_sub_f32 v109, v109, v126
    v_sub_f32 v110, v110, v126
    v_sub_f32 v111, v111, v126
    v_sub_f32 v112, v112, v126
    v_sub_f32 v113, v113, v126
    v_sub_f32 v114, v114, v126
    v_sub_f32 v115, v115, v126
    v_sub_f32 v116, v116, v126
    v_sub_f32 v117, v117, v126
    v_mul_f32 v108, s51, v108
    v_mul_f32 v109, s51, v109
    v_mul_f32 v110, s51, v110
    v_mul_f32 v111, s51, v111
    v_mul_f32 v112, s51, v112
    v_mul_f32 v113, s51, v113
    v_mul_f32 v114, s51, v114
    v_mul_f32 v115, s51, v115
    v_mul_f32 v116, s51, v116
    v_mul_f32 v117, s51, v117
    v_exp_f32 v108, v108
    v_exp_f32 v109, v109
    v_exp_f32 v110, v110
    v_exp_f32 v111, v111
    v_exp_f32 v112, v112
    v_exp_f32 v113, v113
    v_exp_f32 v114, v114
    v_exp_f32 v115, v115
    v_exp_f32 v116, v116
    v_exp_f32 v117, v117
    v_add_f32 v126, v108, v109
    v_add_f32 v126, v126, v110
    v_add_f32 v126, v126, v111
    v_add_f32 v126, v126, v112
    v_add_f32 v126, v126, v113
    v_add_f32 v126, v126, v114
    v_add_f32 v126, v126, v115
    v_add_f32 v126, v126, v116
    v_add_f32 v126, v126, v117
    v_mov_b32 v127, v126
    s_nop 1
    v_permlane16_swap_b32 v126, v127
    v_add_f32 v126, v126, v127
    v_mov_b32 v127, v126
    s_nop 1
    v_permlane32_swap_b32 v126, v127
    v_add_f32 v126, v126, v127
    v_rcp_f32 v126, v126
    s_nop 0
    v_mul_f32 v108, v108, v126
    v_mul_f32 v109, v109, v126
    v_mul_f32 v110, v110, v126
    v_mul_f32 v111, v111, v126
    v_mul_f32 v112, v112, v126
    v_mul_f32 v113, v113, v126
    v_mul_f32 v114, v114, v126
    v_mul_f32 v115, v115, v126
    v_mul_f32 v116, v116, v126
    v_mul_f32 v117, v117, v126
    v_cvt_pk_bf16_f32 v216, v108, v109
    v_cvt_pk_bf16_f32 v217, v112, v113
    v_cvt_pk_bf16_f32 v218, v110, v111
    v_cvt_pk_bf16_f32 v219, v114, v115
    v_cvt_pk_bf16_f32 v220, v116, v117
    v_min_u32 v216, -2, v216
    v_min_u32 v217, -2, v217
    v_min_u32 v218, -2, v218
    v_min_u32 v219, -2, v219
    v_min_u32 v220, -2, v220
    s_add_u32 s40, s32, 40960
    buffer_store_dwordx2 v[216:217], v12, s[8:11], s40 offen offset:0 sc1
    buffer_store_dwordx2 v[218:219], v12, s[8:11], s40 offen offset:128 sc1
    s_add_u32 s40, s40, s61
    buffer_store_dword v220, v13, s[8:11], s40 offen sc1
    s_lshl_b32 s40, s46, 16
    s_add_u32 s57, s57, s40
    s_mul_i32 s40, s46, 81920
    s_add_u32 s32, s32, s40
    v_mov_b32 v120, s36
    s_waitcnt vmcnt(19)
    v_readfirstlane_b32 s60, v122
    s_add_u32 s29, s29, s46
    s_mov_b32 s47, 0
    s_nop 1
    s_cmp_le_u32 s60, s29
    s_cbranch_scc1 a_nk1
    s_mov_b32 s47, 1

    buffer_load_dwordx4 v[80:83], v8, s[8:11], s57 offen offset:0 sc1
    buffer_load_dwordx4 v[84:87], v8, s[8:11], s57 offen offset:512 sc1
    buffer_load_dwordx4 v[88:91], v8, s[8:11], s57 offen offset:1024 sc1
    buffer_load_dwordx4 v[92:95], v8, s[8:11], s57 offen offset:1536 sc1
    s_waitcnt vmcnt(4)
    s_branch a_pub1
a_nk1:
    s_waitcnt vmcnt(0)
a_pub1:
    s_mov_b64 exec, 1
    buffer_store_dword v120, off, s[8:11], s59 sc1
    s_mov_b64 exec, -1

    s_cmp_ge_u32 s29, 64
    s_cbranch_scc1 r_end

    s_branch a_loop
role_l:
    v_cmp_gt_u32 vcc, 40, v2
    v_mov_b32 v144, 0x7ffffff0
    v_lshlrev_b32 v141, 4, v2

    v_mov_b32 v140, v141
    v_lshlrev_b32 v145, 1, v140
    v_cndmask_b32 v140, v144, v140, vcc
    v_cndmask_b32 v145, v144, v145, vcc
    v_cndmask_b32 v141, v144, v141, vcc
    s_mov_b64 s[76:77], vcc
    s_mov_b32 s72, 10240
    s_mov_b32 s73, 7680

    buffer_load_dwordx4 v[180:183], v145, s[8:11], s72 offen offset:0 sc1
    buffer_load_dwordx4 v[184:187], v145, s[8:11], s72 offen offset:16 sc1
    buffer_load_dwordx4 v[188:191], v145, s[8:11], s72 offen offset:1280 sc1
    buffer_load_dwordx4 v[192:195], v145, s[8:11], s72 offen offset:1296 sc1
    buffer_load_dwordx4 v[196:199], v145, s[8:11], s73 offen offset:0 sc1
    buffer_load_dwordx4 v[200:203], v145, s[8:11], s73 offen offset:16 sc1
    buffer_load_dwordx4 v[204:207], v145, s[8:11], s73 offen offset:1280 sc1
    buffer_load_dwordx4 v[208:211], v145, s[8:11], s73 offen offset:1296 sc1
    s_waitcnt vmcnt(0)
    v_add_f32 v180, 1.0, v180
    v_add_f32 v181, 1.0, v181
    v_cvt_pk_bf16_f32 v144, v180, v181
    v_lshlrev_b32 v180, 16, v144
    v_and_b32 v181, 0xffff0000, v144
    v_add_f32 v182, 1.0, v182
    v_add_f32 v183, 1.0, v183
    v_cvt_pk_bf16_f32 v144, v182, v183
    v_lshlrev_b32 v182, 16, v144
    v_and_b32 v183, 0xffff0000, v144
    v_add_f32 v184, 1.0, v184
    v_add_f32 v185, 1.0, v185
    v_cvt_pk_bf16_f32 v144, v184, v185
    v_lshlrev_b32 v184, 16, v144
    v_and_b32 v185, 0xffff0000, v144
    v_add_f32 v186, 1.0, v186
    v_add_f32 v187, 1.0, v187
    v_cvt_pk_bf16_f32 v144, v186, v187
    v_lshlrev_b32 v186, 16, v144
    v_and_b32 v187, 0xffff0000, v144
    v_add_f32 v188, 1.0, v188
    v_add_f32 v189, 1.0, v189
    v_cvt_pk_bf16_f32 v144, v188, v189
    v_lshlrev_b32 v188, 16, v144
    v_and_b32 v189, 0xffff0000, v144
    v_add_f32 v190, 1.0, v190
    v_add_f32 v191, 1.0, v191
    v_cvt_pk_bf16_f32 v144, v190, v191
    v_lshlrev_b32 v190, 16, v144
    v_and_b32 v191, 0xffff0000, v144
    v_add_f32 v192, 1.0, v192
    v_add_f32 v193, 1.0, v193
    v_cvt_pk_bf16_f32 v144, v192, v193
    v_lshlrev_b32 v192, 16, v144
    v_and_b32 v193, 0xffff0000, v144
    v_add_f32 v194, 1.0, v194
    v_add_f32 v195, 1.0, v195
    v_cvt_pk_bf16_f32 v144, v194, v195
    v_lshlrev_b32 v194, 16, v144
    v_and_b32 v195, 0xffff0000, v144
    s_mov_b32 s40, s28

    s_mul_i32 s46, s40, 1280
    s_add_u32 s47, s46, 0x2c00000
    s_lshl_b32 s48, s40, 7
    s_add_u32 s48, s48, 0x18200
    s_mov_b32 s49, 0x1a500
    v_lshlrev_b32 v9, 1, v141
    v_cndmask_b32 v9, v141, v9, s[76:77]
    s_mov_b32 s40, 5120
    s_mov_b32 s52, 20

    buffer_load_dwordx4 v[48:51], v9, s[8:11], s40 offen offset:0 sc1
    buffer_load_dwordx4 v[52:55], v9, s[8:11], s40 offen offset:16 sc1
    buffer_load_dwordx4 v[56:59], v9, s[8:11], s40 offen offset:1280 sc1
    buffer_load_dwordx4 v[60:63], v9, s[8:11], s40 offen offset:1296 sc1
    s_mov_b32 s54, 0
l_loop:
    s_add_u32 s45, s29, 1
    s_add_u32 s41, s46, 0x1400000
    s_add_u32 s42, s46, 0x2800000
    s_mov_b32 s53, 0
    s_cmp_eq_u32 s54, 1
    s_cbranch_scc1 l_chk

    buffer_load_dwordx4 v[24:27], v140, s[24:27], s46 offen offset:0
    buffer_load_dwordx4 v[28:31], v140, s[24:27], s46 offen offset:640
    s_cmp_ge_u32 s29, 56
    s_cbranch_scc1 l_ld

wf_77:
    s_cmp_ge_u32 s53, s52
    s_cbranch_scc1 wfd_78
    buffer_load_dword v16, off, s[8:11], s49 sc1
    s_waitcnt vmcnt(0)
    v_readfirstlane_b32 s53, v16
    s_nop 3
    s_cmp_ge_u32 s53, s52
    s_cbranch_scc1 wfd_78
    s_sub_u32 s30, s30, 1
    s_cmp_lt_i32 s30, 0
    s_cbranch_scc1 wfd_78
    s_sleep 3
    s_branch wf_77

wfd_78:
l_ld:
    buffer_load_dwordx4 v[148:151], v140, s[8:11], s41 offen offset:0 sc1
    buffer_load_dwordx4 v[152:155], v140, s[8:11], s41 offen offset:640 sc1
    buffer_load_dword v17, off, s[8:11], s49 offset:128 sc1
    s_waitcnt vmcnt(0)
l_chk:
    v_max3_u32 v16, v148, v149, v150
    v_max3_u32 v16, v16, v151, v152
    v_max3_u32 v16, v16, v153, v154
    v_max_u32 v16, v16, v155
    v_cmp_eq_u32 vcc, -1, v16
    s_cbranch_vccz pok_79
    s_sub_u32 s30, s30, 1
    s_cmp_lt_i32 s30, 0
    s_cbranch_scc1 pok_79
    s_sleep 3
    s_branch l_ld

pok_79:
    v_readfirstlane_b32 s55, v17
    v_lshlrev_b32 v164, 16, v148
    v_and_b32 v165, 0xffff0000, v148
    v_lshlrev_b32 v166, 16, v149
    v_and_b32 v167, 0xffff0000, v149
    v_lshlrev_b32 v168, 16, v150
    v_and_b32 v169, 0xffff0000, v150
    v_lshlrev_b32 v170, 16, v151
    v_and_b32 v171, 0xffff0000, v151
    v_lshlrev_b32 v172, 16, v152
    v_and_b32 v173, 0xffff0000, v152
    v_lshlrev_b32 v174, 16, v153
    v_and_b32 v175, 0xffff0000, v153
    v_lshlrev_b32 v176, 16, v154
    v_and_b32 v177, 0xffff0000, v154
    v_lshlrev_b32 v178, 16, v155
    v_and_b32 v179, 0xffff0000, v155
    v_mul_f32 v164, v164, v48
    v_mul_f32 v165, v165, v49
    v_cvt_pk_bf16_f32 v144, v164, v165
    v_lshlrev_b32 v164, 16, v144
    v_and_b32 v165, 0xffff0000, v144
    v_lshlrev_b32 v144, 16, v24
    v_and_b32 v145, 0xffff0000, v24
    v_add_f32 v164, v164, v144
    v_add_f32 v165, v165, v145
    v_cvt_pk_bf16_f32 v32, v164, v165
    v_lshlrev_b32 v164, 16, v32
    v_and_b32 v165, 0xffff0000, v32

    v_mul_f32 v166, v166, v50
    v_mul_f32 v167, v167, v51
    v_cvt_pk_bf16_f32 v144, v166, v167
    v_lshlrev_b32 v166, 16, v144
    v_and_b32 v167, 0xffff0000, v144
    v_lshlrev_b32 v144, 16, v25
    v_and_b32 v145, 0xffff0000, v25
    v_add_f32 v166, v166, v144
    v_add_f32 v167, v167, v145
    v_cvt_pk_bf16_f32 v33, v166, v167
    v_lshlrev_b32 v166, 16, v33
    v_and_b32 v167, 0xffff0000, v33

    v_mul_f32 v168, v168, v52
    v_mul_f32 v169, v169, v53
    v_cvt_pk_bf16_f32 v144, v168, v169
    v_lshlrev_b32 v168, 16, v144
    v_and_b32 v169, 0xffff0000, v144
    v_lshlrev_b32 v144, 16, v26
    v_and_b32 v145, 0xffff0000, v26
    v_add_f32 v168, v168, v144
    v_add_f32 v169, v169, v145
    v_cvt_pk_bf16_f32 v34, v168, v169
    v_lshlrev_b32 v168, 16, v34
    v_and_b32 v169, 0xffff0000, v34

    v_mul_f32 v170, v170, v54
    v_mul_f32 v171, v171, v55
    v_cvt_pk_bf16_f32 v144, v170, v171
    v_lshlrev_b32 v170, 16, v144
    v_and_b32 v171, 0xffff0000, v144
    v_lshlrev_b32 v144, 16, v27
    v_and_b32 v145, 0xffff0000, v27
    v_add_f32 v170, v170, v144
    v_add_f32 v171, v171, v145
    v_cvt_pk_bf16_f32 v35, v170, v171
    v_lshlrev_b32 v170, 16, v35
    v_and_b32 v171, 0xffff0000, v35

    v_mul_f32 v172, v172, v56
    v_mul_f32 v173, v173, v57
    v_cvt_pk_bf16_f32 v144, v172, v173
    v_lshlrev_b32 v172, 16, v144
    v_and_b32 v173, 0xffff0000, v144
    v_lshlrev_b32 v144, 16, v28
    v_and_b32 v145, 0xffff0000, v28
    v_add_f32 v172, v172, v144
    v_add_f32 v173, v173, v145
    v_cvt_pk_bf16_f32 v36, v172, v173
    v_lshlrev_b32 v172, 16, v36
    v_and_b32 v173, 0xffff0000, v36

    v_mul_f32 v174, v174, v58
    v_mul_f32 v175, v175, v59
    v_cvt_pk_bf16_f32 v144, v174, v175
    v_lshlrev_b32 v174, 16, v144
    v_and_b32 v175, 0xffff0000, v144
    v_lshlrev_b32 v144, 16, v29
    v_and_b32 v145, 0xffff0000, v29
    v_add_f32 v174, v174, v144
    v_add_f32 v175, v175, v145
    v_cvt_pk_bf16_f32 v37, v174, v175
    v_lshlrev_b32 v174, 16, v37
    v_and_b32 v175, 0xffff0000, v37

    v_mul_f32 v176, v176, v60
    v_mul_f32 v177, v177, v61
    v_cvt_pk_bf16_f32 v144, v176, v177
    v_lshlrev_b32 v176, 16, v144
    v_and_b32 v177, 0xffff0000, v144
    v_lshlrev_b32 v144, 16, v30
    v_and_b32 v145, 0xffff0000, v30
    v_add_f32 v176, v176, v144
    v_add_f32 v177, v177, v145
    v_cvt_pk_bf16_f32 v38, v176, v177
    v_lshlrev_b32 v176, 16, v38
    v_and_b32 v177, 0xffff0000, v38

    v_mul_f32 v178, v178, v62
    v_mul_f32 v179, v179, v63
    v_cvt_pk_bf16_f32 v144, v178, v179
    v_lshlrev_b32 v178, 16, v144
    v_and_b32 v179, 0xffff0000, v144
    v_lshlrev_b32 v144, 16, v31
    v_and_b32 v145, 0xffff0000, v31
    v_add_f32 v178, v178, v144
    v_add_f32 v179, v179, v145
    v_cvt_pk_bf16_f32 v39, v178, v179
    v_lshlrev_b32 v178, 16, v39
    v_and_b32 v179, 0xffff0000, v39

    v_min_u32 v32, -2, v32
    v_min_u32 v33, -2, v33
    v_min_u32 v34, -2, v34
    v_min_u32 v35, -2, v35
    v_min_u32 v36, -2, v36
    v_min_u32 v37, -2, v37
    v_min_u32 v38, -2, v38
    v_min_u32 v39, -2, v39
    buffer_store_dwordx4 v[32:35], v141, s[8:11], s42 offen sc1
    buffer_store_dwordx4 v[36:39], v141, s[8:11], s42 offen offset:640 sc1
    s_mov_b32 s54, 0
    s_cmp_ge_u32 s29, 55
    s_cselect_b32 s55, 20, s55
    s_cmp_lt_u32 s55, 20
    s_cbranch_scc1 l_nopf
    s_cmp_ge_u32 s29, 63
    s_cbranch_scc1 l_nopf
    s_mov_b32 s54, 1
    s_add_u32 s40, s46, 40960
    s_add_u32 s41, s41, 40960

    buffer_load_dwordx4 v[24:27], v140, s[24:27], s40 offen offset:0
    buffer_load_dwordx4 v[28:31], v140, s[24:27], s40 offen offset:640
    buffer_load_dwordx4 v[148:151], v140, s[8:11], s41 offen offset:0 sc1
    buffer_load_dwordx4 v[152:155], v140, s[8:11], s41 offen offset:640 sc1
    buffer_load_dword v17, off, s[8:11], s49 offset:256 sc1
l_nopf:
    v_add_f32 v142, v164, v165
    v_add_f32 v144, v166, v167
    v_add_f32 v142, v142, v168
    v_add_f32 v144, v144, v169
    v_add_f32 v142, v142, v170
    v_add_f32 v144, v144, v171
    v_add_f32 v142, v142, v172
    v_add_f32 v144, v144, v173
    v_add_f32 v142, v142, v174
    v_add_f32 v144, v144, v175
    v_add_f32 v142, v142, v176
    v_add_f32 v144, v144, v177
    v_add_f32 v142, v142, v178
    v_add_f32 v144, v144, v179
    v_add_f32 v142, v142, v144
    s_nop 1
    v_add_f32_dpp v142, v142, v142 quad_perm:[1,0,3,2] row_mask:0xf bank_mask:0xf
    s_nop 1
    v_add_f32_dpp v142, v142, v142 quad_perm:[2,3,0,1] row_mask:0xf bank_mask:0xf
    s_nop 1
    v_add_f32_dpp v142, v142, v142 row_half_mirror row_mask:0xf bank_mask:0xf
    s_nop 1
    v_add_f32_dpp v142, v142, v142 row_mirror row_mask:0xf bank_mask:0xf
    s_nop 0
    v_readlane_b32 s72, v142, 0
    v_readlane_b32 s73, v142, 16
    v_readlane_b32 s74, v142, 32
    s_nop 1
    v_mov_b32 v142, s72
    v_add_f32 v142, s73, v142
    v_add_f32 v142, s74, v142
    v_mul_f32 v142, 0x3acccccd, v142
    v_sub_f32 v144, v164, v142
    v_mul_f32 v143, v144, v144
    v_sub_f32 v145, v165, v142
    v_fmac_f32 v143, v145, v145
    v_sub_f32 v144, v166, v142
    v_fmac_f32 v143, v144, v144
    v_sub_f32 v145, v167, v142
    v_fmac_f32 v143, v145, v145
    v_sub_f32 v144, v168, v142
    v_fmac_f32 v143, v144, v144
    v_sub_f32 v145, v169, v142
    v_fmac_f32 v143, v145, v145
    v_sub_f32 v144, v170, v142
    v_fmac_f32 v143, v144, v144
    v_sub_f32 v145, v171, v142
    v_fmac_f32 v143, v145, v145
    v_sub_f32 v144, v172, v142
    v_fmac_f32 v143, v144, v144
    v_sub_f32 v145, v173, v142
    v_fmac_f32 v143, v145, v145
    v_sub_f32 v144, v174, v142
    v_fmac_f32 v143, v144, v144
    v_sub_f32 v145, v175, v142
    v_fmac_f32 v143, v145, v145
    v_sub_f32 v144, v176, v142
    v_fmac_f32 v143, v144, v144
    v_sub_f32 v145, v177, v142
    v_fmac_f32 v143, v145, v145
    v_sub_f32 v144, v178, v142
    v_fmac_f32 v143, v144, v144
    v_sub_f32 v145, v179, v142
    v_fmac_f32 v143, v145, v145
    v_cndmask_b32 v143, 0, v143, s[76:77]
    s_nop 1
    v_add_f32_dpp v143, v143, v143 quad_perm:[1,0,3,2] row_mask:0xf bank_mask:0xf
    s_nop 1
    v_add_f32_dpp v143, v143, v143 quad_perm:[2,3,0,1] row_mask:0xf bank_mask:0xf
    s_nop 1
    v_add_f32_dpp v143, v143, v143 row_half_mirror row_mask:0xf bank_mask:0xf
    s_nop 1
    v_add_f32_dpp v143, v143, v143 row_mirror row_mask:0xf bank_mask:0xf
    s_nop 0
    v_readlane_b32 s72, v143, 0
    v_readlane_b32 s73, v143, 16
    v_readlane_b32 s74, v143, 32
    s_nop 1
    v_mov_b32 v143, s72
    v_add_f32 v143, s73, v143
    v_add_f32 v143, s74, v143
    v_mul_f32 v143, 0x3acccccd, v143
    v_cvt_pk_bf16_f32 v143, v143, v143
    v_and_b32 v143, 0xffff0000, v143
    v_add_f32 v143, 0x3727c5ac, v143
    v_cvt_pk_bf16_f32 v143, v143, v143
    v_and_b32 v143, 0xffff0000, v143
    v_sqrt_f32 v143, v143
    s_nop 0
    v_cvt_pk_bf16_f32 v143, v143, v143
    v_and_b32 v143, 0xffff0000, v143
    v_rcp_f32 v143, v143
    v_cvt_pk_bf16_f32 v142, v142, v142
    v_and_b32 v142, 0xffff0000, v142
    v_sub_f32 v164, v164, v142
    v_sub_f32 v165, v165, v142
    v_cvt_pk_bf16_f32 v144, v164, v165
    v_lshlrev_b32 v164, 16, v144
    v_and_b32 v165, 0xffff0000, v144
    v_mul_f32 v164, v164, v143
    v_mul_f32 v165, v165, v143
    v_cvt_pk_bf16_f32 v144, v164, v165
    v_lshlrev_b32 v164, 16, v144
    v_and_b32 v165, 0xffff0000, v144
    v_mul_f32 v164, v164, v180
    v_mul_f32 v165, v165, v181
    v_cvt_pk_bf16_f32 v144, v164, v165
    v_lshlrev_b32 v164, 16, v144
    v_and_b32 v165, 0xffff0000, v144
    v_add_f32 v164, v164, v196
    v_add_f32 v165, v165, v197
    v_cvt_pk_bf16_f32 v156, v164, v165
    v_min_u32 v156, -2, v156

    v_sub_f32 v166, v166, v142
    v_sub_f32 v167, v167, v142
    v_cvt_pk_bf16_f32 v144, v166, v167
    v_lshlrev_b32 v166, 16, v144
    v_and_b32 v167, 0xffff0000, v144
    v_mul_f32 v166, v166, v143
    v_mul_f32 v167, v167, v143
    v_cvt_pk_bf16_f32 v144, v166, v167
    v_lshlrev_b32 v166, 16, v144
    v_and_b32 v167, 0xffff0000, v144
    v_mul_f32 v166, v166, v182
    v_mul_f32 v167, v167, v183
    v_cvt_pk_bf16_f32 v144, v166, v167
    v_lshlrev_b32 v166, 16, v144
    v_and_b32 v167, 0xffff0000, v144
    v_add_f32 v166, v166, v198
    v_add_f32 v167, v167, v199
    v_cvt_pk_bf16_f32 v157, v166, v167
    v_min_u32 v157, -2, v157

    v_sub_f32 v168, v168, v142
    v_sub_f32 v169, v169, v142
    v_cvt_pk_bf16_f32 v144, v168, v169
    v_lshlrev_b32 v168, 16, v144
    v_and_b32 v169, 0xffff0000, v144
    v_mul_f32 v168, v168, v143
    v_mul_f32 v169, v169, v143
    v_cvt_pk_bf16_f32 v144, v168, v169
    v_lshlrev_b32 v168, 16, v144
    v_and_b32 v169, 0xffff0000, v144
    v_mul_f32 v168, v168, v184
    v_mul_f32 v169, v169, v185
    v_cvt_pk_bf16_f32 v144, v168, v169
    v_lshlrev_b32 v168, 16, v144
    v_and_b32 v169, 0xffff0000, v144
    v_add_f32 v168, v168, v200
    v_add_f32 v169, v169, v201
    v_cvt_pk_bf16_f32 v158, v168, v169
    v_min_u32 v158, -2, v158

    v_sub_f32 v170, v170, v142
    v_sub_f32 v171, v171, v142
    v_cvt_pk_bf16_f32 v144, v170, v171
    v_lshlrev_b32 v170, 16, v144
    v_and_b32 v171, 0xffff0000, v144
    v_mul_f32 v170, v170, v143
    v_mul_f32 v171, v171, v143
    v_cvt_pk_bf16_f32 v144, v170, v171
    v_lshlrev_b32 v170, 16, v144
    v_and_b32 v171, 0xffff0000, v144
    v_mul_f32 v170, v170, v186
    v_mul_f32 v171, v171, v187
    v_cvt_pk_bf16_f32 v144, v170, v171
    v_lshlrev_b32 v170, 16, v144
    v_and_b32 v171, 0xffff0000, v144
    v_add_f32 v170, v170, v202
    v_add_f32 v171, v171, v203
    v_cvt_pk_bf16_f32 v159, v170, v171
    v_min_u32 v159, -2, v159

    v_sub_f32 v172, v172, v142
    v_sub_f32 v173, v173, v142
    v_cvt_pk_bf16_f32 v144, v172, v173
    v_lshlrev_b32 v172, 16, v144
    v_and_b32 v173, 0xffff0000, v144
    v_mul_f32 v172, v172, v143
    v_mul_f32 v173, v173, v143
    v_cvt_pk_bf16_f32 v144, v172, v173
    v_lshlrev_b32 v172, 16, v144
    v_and_b32 v173, 0xffff0000, v144
    v_mul_f32 v172, v172, v188
    v_mul_f32 v173, v173, v189
    v_cvt_pk_bf16_f32 v144, v172, v173
    v_lshlrev_b32 v172, 16, v144
    v_and_b32 v173, 0xffff0000, v144
    v_add_f32 v172, v172, v204
    v_add_f32 v173, v173, v205
    v_cvt_pk_bf16_f32 v160, v172, v173
    v_min_u32 v160, -2, v160

    v_sub_f32 v174, v174, v142
    v_sub_f32 v175, v175, v142
    v_cvt_pk_bf16_f32 v144, v174, v175
    v_lshlrev_b32 v174, 16, v144
    v_and_b32 v175, 0xffff0000, v144
    v_mul_f32 v174, v174, v143
    v_mul_f32 v175, v175, v143
    v_cvt_pk_bf16_f32 v144, v174, v175
    v_lshlrev_b32 v174, 16, v144
    v_and_b32 v175, 0xffff0000, v144
    v_mul_f32 v174, v174, v190
    v_mul_f32 v175, v175, v191
    v_cvt_pk_bf16_f32 v144, v174, v175
    v_lshlrev_b32 v174, 16, v144
    v_and_b32 v175, 0xffff0000, v144
    v_add_f32 v174, v174, v206
    v_add_f32 v175, v175, v207
    v_cvt_pk_bf16_f32 v161, v174, v175
    v_min_u32 v161, -2, v161

    v_sub_f32 v176, v176, v142
    v_sub_f32 v177, v177, v142
    v_cvt_pk_bf16_f32 v144, v176, v177
    v_lshlrev_b32 v176, 16, v144
    v_and_b32 v177, 0xffff0000, v144
    v_mul_f32 v176, v176, v143
    v_mul_f32 v177, v177, v143
    v_cvt_pk_bf16_f32 v144, v176, v177
    v_lshlrev_b32 v176, 16, v144
    v_and_b32 v177, 0xffff0000, v144
    v_mul_f32 v176, v176, v192
    v_mul_f32 v177, v177, v193
    v_cvt_pk_bf16_f32 v144, v176, v177
    v_lshlrev_b32 v176, 16, v144
    v_and_b32 v177, 0xffff0000, v144
    v_add_f32 v176, v176, v208
    v_add_f32 v177, v177, v209
    v_cvt_pk_bf16_f32 v162, v176, v177
    v_min_u32 v162, -2, v162

    v_sub_f32 v178, v178, v142
    v_sub_f32 v179, v179, v142
    v_cvt_pk_bf16_f32 v144, v178, v179
    v_lshlrev_b32 v178, 16, v144
    v_and_b32 v179, 0xffff0000, v144
    v_mul_f32 v178, v178, v143
    v_mul_f32 v179, v179, v143
    v_cvt_pk_bf16_f32 v144, v178, v179
    v_lshlrev_b32 v178, 16, v144
    v_and_b32 v179, 0xffff0000, v144
    v_mul_f32 v178, v178, v194
    v_mul_f32 v179, v179, v195
    v_cvt_pk_bf16_f32 v144, v178, v179
    v_lshlrev_b32 v178, 16, v144
    v_and_b32 v179, 0xffff0000, v144
    v_add_f32 v178, v178, v210
    v_add_f32 v179, v179, v211
    v_cvt_pk_bf16_f32 v163, v178, v179
    v_min_u32 v163, -2, v163

    buffer_store_dwordx4 v[156:159], v141, s[8:11], s47 offen offset:0 sc1
    buffer_store_dwordx4 v[160:163], v141, s[8:11], s47 offen offset:640 sc1
    s_add_u32 s49, s49, 128
    v_mov_b32 v16, s45
    s_add_u32 s46, s46, 40960
    s_add_u32 s47, s47, 40960
    s_waitcnt vmcnt(0)
    s_mov_b64 exec, 1
    buffer_store_dword v16, off, s[8:11], s48 sc1
    s_mov_b64 exec, -1

    s_add_u32 s29, s29, 1
    s_cmp_lt_u32 s29, 64
    s_cbranch_scc1 l_loop
    s_endpgm

role_c:
    s_sub_u32 s28, s28, 184
    v_bfe_u32 v10, v2, 3, 1
    v_and_b32 v11, 7, v2
    v_lshrrev_b32 v12, 4, v2
    v_lshrrev_b32 v13, 1, v12
    v_and_b32 v14, 1, v12
    s_mul_i32 s40, s3, 5120
    v_mul_u32_u24 v15, 640, v10
    v_add_u32 v15, s40, v15
    v_lshl_add_u32 v15, v13, 8, v15
    v_lshl_add_u32 v15, v11, 5, v15
    v_lshl_add_u32 v8, v14, 4, v15
    v_lshl_add_u32 v15, v13, 2, v14
    v_mul_u32_u24 v15, 640, v15
    v_add_u32 v15, s40, v15
    v_lshl_add_u32 v15, v10, 6, v15
    v_lshl_add_u32 v15, v11, 3, v15
    v_add_u32 v9, 512, v15
    s_mul_i32 s40, s3, 81920
    v_mul_u32_u24 v15, 10240, v13
    v_add_u32 v15, s40, v15
    v_lshl_add_u32 v15, v14, 7, v15
    v_and_b32 v11, 15, v2
    v_lshl_add_u32 v239, v11, 3, v15

    s_lshl_b32 s40, s3, 12
    v_add_u32 v240, s40, v5
    v_add_u32 v13, s40, v5
    s_lshl_b32 s40, s3, 10
    v_add_u32 v12, s40, v5
    v_add_u32 v241, 16384, v12
    v_and_b32 v10, 15, v2
    v_lshrrev_b32 v11, 5, v2
    v_lshl_add_u32 v10, v11, 4, v10
    v_bfe_u32 v11, v2, 4, 1
    v_lshlrev_b32 v11, 2, v11
    s_lshl_b32 s40, s3, 3
    v_add_u32 v11, s40, v11
    v_mul_u32_u24 v11, 1280, v11
    v_lshl_add_u32 v242, v10, 1, v11
    v_and_b32 v10, 1, v2
    v_mov_b32 v11, 0x7ffffff0
    v_cmp_ne_u32 vcc, 0, v10
    v_lshlrev_b32 v243, 7, v2
    v_mov_b32 v232, 0
    v_cndmask_b32 v242, v242, v11, vcc
    v_mov_b32 v231, 20
    s_lshl_b32 s40, s3, 10
    s_add_u32 s34, s40, 0x13000
    s_add_u32 s61, s40, 0x16800
    s_add_u32 s62, s40, 0x12000
    s_mov_b32 s56, 0x10000
    s_mul_i32 s73, s3, 327680
    s_add_u32 s73, s73, 0x8000000
    s_add_u32 s76, s28, 920
    s_cmp_ge_u32 s28, 25
    s_cselect_b32 s77, s76, s28
    s_mov_b32 s78, s77
    s_mov_b32 s79, s77

    s_mul_i32 s57, s77, 3277
    s_lshr_b32 s57, s57, 16
    s_mul_i32 s40, s57, 20
    s_sub_u32 s58, s77, s40

    s_mul_i32 s60, s78, 3277
    s_lshr_b32 s60, s60, 16
    s_mul_i32 s40, s60, 20
    s_sub_u32 s63, s78, s40

    s_mul_i32 s68, s79, 3277
    s_lshr_b32 s68, s68, 16
    s_mul_i32 s40, s68, 20
    s_sub_u32 s72, s79, s40

    v_mov_b32 v230, 0
    s_cmp_ge_u32 s68, 64
    s_cbranch_scc1 cux_81
    s_add_u32 s45, s68, 1
    s_mov_b64 exec, 255
    v_cmp_gt_u32 vcc, s45, v232
    s_mov_b64 exec, -1
    s_cbranch_vccz cux_80

wa_83:
    s_mov_b32 exec_lo, 0xff
    s_mov_b32 exec_hi, 0
    buffer_load_dword v232, v243, s[8:11], s62 offen sc1
    s_waitcnt vmcnt(0)

    v_cmp_gt_u32 vcc, s45, v232
    s_mov_b64 exec, -1
    s_cbranch_vccz wad_84
    s_sub_u32 s30, s30, 1
    s_cmp_lt_i32 s30, 0
    s_cbranch_scc1 wad_84
    s_sleep 4
    s_branch wa_83

wad_84:
cux_80:
    s_mul_i32 s33, s68, 1310720
    s_lshl_b32 s40, s72, 11
    s_add_u32 s33, s33, s40
    s_add_u32 s33, s33, s73

    buffer_load_dwordx4 a[0:3], v5, s[8:11], s33 offen offset:0 sc1
    buffer_load_dwordx4 a[32:35], v5, s[8:11], s33 offen offset:1024 sc1
    s_add_u32 s33, s33, 40960
    buffer_load_dwordx4 a[4:7], v5, s[8:11], s33 offen offset:0 sc1
    buffer_load_dwordx4 a[36:39], v5, s[8:11], s33 offen offset:1024 sc1
    s_add_u32 s33, s33, 40960
    buffer_load_dwordx4 a[8:11], v5, s[8:11], s33 offen offset:0 sc1
    buffer_load_dwordx4 a[40:43], v5, s[8:11], s33 offen offset:1024 sc1
    s_add_u32 s33, s33, 40960
    buffer_load_dwordx4 a[12:15], v5, s[8:11], s33 offen offset:0 sc1
    buffer_load_dwordx4 a[44:47], v5, s[8:11], s33 offen offset:1024 sc1
    s_add_u32 s33, s33, 40960
    buffer_load_dwordx4 a[16:19], v5, s[8:11], s33 offen offset:0 sc1
    buffer_load_dwordx4 a[48:51], v5, s[8:11], s33 offen offset:1024 sc1
    s_add_u32 s33, s33, 40960
    buffer_load_dwordx4 a[20:23], v5, s[8:11], s33 offen offset:0 sc1
    buffer_load_dwordx4 a[52:55], v5, s[8:11], s33 offen offset:1024 sc1
    s_add_u32 s33, s33, 40960
    buffer_load_dwordx4 a[24:27], v5, s[8:11], s33 offen offset:0 sc1
    buffer_load_dwordx4 a[56:59], v5, s[8:11], s33 offen offset:1024 sc1
    s_add_u32 s33, s33, 40960
    buffer_load_dwordx4 a[28:31], v5, s[8:11], s33 offen offset:0 sc1
    buffer_load_dwordx4 a[60:63], v5, s[8:11], s33 offen offset:1024 sc1
    s_add_u32 s33, s33, 40960
cux_81:
cux_82:
    s_add_u32 s40, s79, 25
    s_cmp_lt_u32 s40, 920
    s_cselect_b32 s40, s40, s76
    s_add_u32 s41, s79, 50
    s_cmp_lt_u32 s79, 920
    s_cselect_b32 s79, s40, s41

    s_mul_i32 s68, s79, 3277
    s_lshr_b32 s68, s68, 16
    s_mul_i32 s40, s68, 20
    s_sub_u32 s72, s79, s40

    s_cmp_ge_u32 s68, 64
    s_cbranch_scc1 cux_86
    s_add_u32 s45, s68, 1
    s_mov_b64 exec, 255
    v_cmp_gt_u32 vcc, s45, v232
    s_mov_b64 exec, -1
    s_cbranch_vccz cux_85

wa_88:
    s_mov_b32 exec_lo, 0xff
    s_mov_b32 exec_hi, 0
    buffer_load_dword v232, v243, s[8:11], s62 offen sc1
    s_waitcnt vmcnt(0)

    v_cmp_gt_u32 vcc, s45, v232
    s_mov_b64 exec, -1
    s_cbranch_vccz wad_89
    s_sub_u32 s30, s30, 1
    s_cmp_lt_i32 s30, 0
    s_cbranch_scc1 wad_89
    s_sleep 4
    s_branch wa_88

wad_89:
cux_85:
    s_mul_i32 s33, s68, 1310720
    s_lshl_b32 s40, s72, 11
    s_add_u32 s33, s33, s40
    s_add_u32 s33, s33, s73

    buffer_load_dwordx4 a[64:67], v5, s[8:11], s33 offen offset:0 sc1
    buffer_load_dwordx4 a[96:99], v5, s[8:11], s33 offen offset:1024 sc1
    s_add_u32 s33, s33, 40960
    buffer_load_dwordx4 a[68:71], v5, s[8:11], s33 offen offset:0 sc1
    buffer_load_dwordx4 a[100:103], v5, s[8:11], s33 offen offset:1024 sc1
    s_add_u32 s33, s33, 40960
    buffer_load_dwordx4 a[72:75], v5, s[8:11], s33 offen offset:0 sc1
    buffer_load_dwordx4 a[104:107], v5, s[8:11], s33 offen offset:1024 sc1
    s_add_u32 s33, s33, 40960
    buffer_load_dwordx4 a[76:79], v5, s[8:11], s33 offen offset:0 sc1
    buffer_load_dwordx4 a[108:111], v5, s[8:11], s33 offen offset:1024 sc1
    s_add_u32 s33, s33, 40960
    buffer_load_dwordx4 a[80:83], v5, s[8:11], s33 offen offset:0 sc1
    buffer_load_dwordx4 a[112:115], v5, s[8:11], s33 offen offset:1024 sc1
    s_add_u32 s33, s33, 40960
    buffer_load_dwordx4 a[84:87], v5, s[8:11], s33 offen offset:0 sc1
    buffer_load_dwordx4 a[116:119], v5, s[8:11], s33 offen offset:1024 sc1
    s_add_u32 s33, s33, 40960
    buffer_load_dwordx4 a[88:91], v5, s[8:11], s33 offen offset:0 sc1
    buffer_load_dwordx4 a[120:123], v5, s[8:11], s33 offen offset:1024 sc1
    s_add_u32 s33, s33, 40960
    buffer_load_dwordx4 a[92:95], v5, s[8:11], s33 offen offset:0 sc1
    buffer_load_dwordx4 a[124:127], v5, s[8:11], s33 offen offset:1024 sc1
    s_add_u32 s33, s33, 40960
cux_86:
cux_87:
    s_add_u32 s40, s79, 25
    s_cmp_lt_u32 s40, 920
    s_cselect_b32 s40, s40, s76
    s_add_u32 s41, s79, 50
    s_cmp_lt_u32 s79, 920
    s_cselect_b32 s79, s40, s41

    s_mul_i32 s68, s79, 3277
    s_lshr_b32 s68, s68, 16
    s_mul_i32 s40, s68, 20
    s_sub_u32 s72, s79, s40

    s_add_u32 s44, s60, 1
cb_90:
    s_mov_b64 exec, 255
    buffer_load_dword v233, v243, s[8:11], s61 offen sc1
    buffer_load_dwordx4 v[224:227], v243, s[8:11], s34 offen sc1
    s_mov_b64 exec, -1

    s_waitcnt vmcnt(0)
    s_cmp_lt_u32 s60, 56
    s_cbranch_scc1 cb_93
    v_mov_b32 v233, 64
cb_93:

    v_min3_u32 v234, v233, v224, v225
    v_min3_u32 v234, v234, v226, v227
    s_mov_b64 exec, 255
    v_cmp_gt_u32 vcc, s44, v234
    s_mov_b64 exec, -1
    s_cbranch_vccnz cb_91

    s_branch cb_92
cb_91:
    s_sub_u32 s30, s30, 1
    s_cmp_lt_i32 s30, 0
    s_cbranch_scc1 cb_92
    s_sleep 3
    s_branch cb_90

cb_92:
    s_mul_i32 s32, s60, 81920
    s_add_u32 s32, s32, 0x800000
    s_add_u32 s64, s32, 20480
    s_add_u32 s65, s32, 40960
    s_add_u32 s66, s32, 61440
    s_mul_i32 s67, s60, 327680
    s_lshl_b32 s40, s63, 9
    s_add_u32 s67, s67, s40
    s_add_u32 s67, s67, 0x6800000
    s_add_u32 s69, s67, 20480
    s_add_u32 s70, s67, 40960
    s_add_u32 s71, s67, 61440

cbl_94:
    buffer_load_dwordx4 v[16:19], v240, s[8:11], s32 offen offset:0 sc1
    buffer_load_dwordx4 v[20:23], v240, s[8:11], s32 offen offset:1024 sc1
    buffer_load_dwordx4 v[24:27], v240, s[8:11], s32 offen offset:2048 sc1
    buffer_load_dwordx4 v[28:31], v240, s[8:11], s32 offen offset:3072 sc1
    buffer_load_dwordx4 v[32:35], v241, s[8:11], s32 offen sc1
    buffer_load_dwordx4 v[36:39], v240, s[8:11], s64 offen offset:0 sc1
    buffer_load_dwordx4 v[40:43], v240, s[8:11], s64 offen offset:1024 sc1
    buffer_load_dwordx4 v[44:47], v240, s[8:11], s64 offen offset:2048 sc1
    buffer_load_dwordx4 v[48:51], v240, s[8:11], s64 offen offset:3072 sc1
    buffer_load_dwordx4 v[52:55], v241, s[8:11], s64 offen sc1
    buffer_load_dwordx4 v[56:59], v240, s[8:11], s65 offen offset:0 sc1
    buffer_load_dwordx4 v[60:63], v240, s[8:11], s65 offen offset:1024 sc1
    buffer_load_dwordx4 v[64:67], v240, s[8:11], s65 offen offset:2048 sc1
    buffer_load_dwordx4 v[68:71], v240, s[8:11], s65 offen offset:3072 sc1
    buffer_load_dwordx4 v[72:75], v241, s[8:11], s65 offen sc1
    buffer_load_dwordx4 v[76:79], v240, s[8:11], s66 offen offset:0 sc1
    buffer_load_dwordx4 v[80:83], v240, s[8:11], s66 offen offset:1024 sc1
    buffer_load_dwordx4 v[84:87], v240, s[8:11], s66 offen offset:2048 sc1
    buffer_load_dwordx4 v[88:91], v240, s[8:11], s66 offen offset:3072 sc1
    buffer_load_dwordx4 v[92:95], v241, s[8:11], s66 offen sc1
    buffer_load_dwordx2 a[128:129], v239, s[8:11], s67 offen offset:0 sc1
    buffer_load_dwordx2 a[136:137], v239, s[8:11], s67 offen offset:256 sc1
    buffer_load_dwordx2 a[130:131], v239, s[8:11], s69 offen offset:0 sc1
    buffer_load_dwordx2 a[138:139], v239, s[8:11], s69 offen offset:256 sc1
    buffer_load_dwordx2 a[132:133], v239, s[8:11], s70 offen offset:0 sc1
    buffer_load_dwordx2 a[140:141], v239, s[8:11], s70 offen offset:256 sc1
    buffer_load_dwordx2 a[134:135], v239, s[8:11], s71 offen offset:0 sc1
    buffer_load_dwordx2 a[142:143], v239, s[8:11], s71 offen offset:256 sc1
    s_mov_b64 exec, 255
    buffer_load_dword v233, v243, s[8:11], s61 offen sc1
    buffer_load_dwordx4 v[224:227], v243, s[8:11], s34 offen sc1
    s_mov_b64 exec, -1

    s_waitcnt vmcnt(0)
    v_max3_u32 v3, v16, v17, v18
    v_max3_u32 v3, v3, v19, v20
    v_max3_u32 v3, v3, v21, v22
    v_max3_u32 v3, v3, v23, v24
    v_max3_u32 v3, v3, v25, v26
    v_max3_u32 v3, v3, v27, v28
    v_max3_u32 v3, v3, v29, v30
    v_max3_u32 v3, v3, v31, v32
    v_max3_u32 v3, v3, v33, v34
    v_max3_u32 v3, v3, v35, v36
    v_max3_u32 v3, v3, v37, v38
    v_max3_u32 v3, v3, v39, v40
    v_max3_u32 v3, v3, v41, v42
    v_max3_u32 v3, v3, v43, v44
    v_max3_u32 v3, v3, v45, v46
    v_max3_u32 v3, v3, v47, v48
    v_max3_u32 v3, v3, v49, v50
    v_max3_u32 v3, v3, v51, v52
    v_max3_u32 v3, v3, v53, v54
    v_max3_u32 v3, v3, v55, v56
    v_max3_u32 v3, v3, v57, v58
    v_max3_u32 v3, v3, v59, v60
    v_max3_u32 v3, v3, v61, v62
    v_max3_u32 v3, v3, v63, v64
    v_max3_u32 v3, v3, v65, v66
    v_max3_u32 v3, v3, v67, v68
    v_max3_u32 v3, v3, v69, v70
    v_max3_u32 v3, v3, v71, v72
    v_max3_u32 v3, v3, v73, v74
    v_max3_u32 v3, v3, v75, v76
    v_max3_u32 v3, v3, v77, v78
    v_max3_u32 v3, v3, v79, v80
    v_max3_u32 v3, v3, v81, v82
    v_max3_u32 v3, v3, v83, v84
    v_max3_u32 v3, v3, v85, v86
    v_max3_u32 v3, v3, v87, v88
    v_max3_u32 v3, v3, v89, v90
    v_max3_u32 v3, v3, v91, v92
    v_max3_u32 v3, v3, v93, v94
    v_max_u32 v3, v3, v95
    v_cmp_eq_u32 vcc, -1, v3
    s_cbranch_vccz pok_95
    s_sub_u32 s30, s30, 1
    s_cmp_lt_i32 s30, 0
    s_cbranch_scc1 pok_95
    s_sleep 4
    s_branch cbl_94

pok_95:
    s_add_u32 s40, s78, 25
    s_cmp_lt_u32 s40, 920
    s_cselect_b32 s40, s40, s76
    s_add_u32 s41, s78, 50
    s_cmp_lt_u32 s78, 920
    s_cselect_b32 s78, s40, s41

    s_mul_i32 s60, s78, 3277
    s_lshr_b32 s60, s60, 16
    s_mul_i32 s40, s60, 20
    s_sub_u32 s63, s78, s40

c_loop:
    s_add_u32 s44, s60, 1
    s_mov_b32 s59, 0
    v_min3_u32 v234, v233, v224, v225
    v_min3_u32 v234, v234, v226, v227
    s_mov_b64 exec, 255
    v_cmp_gt_u32 vcc, s44, v234
    s_mov_b64 exec, -1
    s_cbranch_vccnz cpl_96

    s_cmp_ge_u32 s60, 56
    s_cbranch_scc1 cpl_96
    s_mov_b32 s59, 1

    s_mul_i32 s32, s60, 81920
    s_add_u32 s32, s32, 0x800000
    s_add_u32 s64, s32, 20480
    s_add_u32 s65, s32, 40960
    s_add_u32 s66, s32, 61440
    s_mul_i32 s67, s60, 327680
    s_lshl_b32 s40, s63, 9
    s_add_u32 s67, s67, s40
    s_add_u32 s67, s67, 0x6800000
    s_add_u32 s69, s67, 20480
    s_add_u32 s70, s67, 40960
    s_add_u32 s71, s67, 61440

    v_mov_b32 v176, 0
    v_mov_b32 v177, 0
    v_mov_b32 v178, 0
    v_mov_b32 v179, 0
    v_mov_b32 v180, 0
    v_mov_b32 v181, 0
    v_mov_b32 v182, 0
    v_mov_b32 v183, 0
    v_mov_b32 v184, 0
    v_mov_b32 v185, 0
    v_mov_b32 v186, 0
    v_mov_b32 v187, 0
    v_mov_b32 v188, 0
    v_mov_b32 v189, 0
    buffer_load_dwordx4 v[96:99], v240, s[8:11], s32 offen offset:0 sc1
    v_mov_b32 v190, 0
    v_mov_b32 v191, 0
    v_mov_b32 v192, 0
    v_mov_b32 v193, 0
    v_mov_b32 v194, 0
    v_mov_b32 v195, 0
    v_mov_b32 v196, 0
    v_mov_b32 v197, 0
    v_mov_b32 v198, 0
    v_mov_b32 v199, 0
    v_mov_b32 v200, 0
    v_mov_b32 v201, 0
    v_mov_b32 v202, 0
    v_mov_b32 v203, 0
    buffer_load_dwordx4 v[100:103], v240, s[8:11], s32 offen offset:1024 sc1
    v_mov_b32 v204, 0
    v_mov_b32 v205, 0
    v_mov_b32 v206, 0
    v_mov_b32 v207, 0
    s_nop 0
    v_smfmac_f32_16x16x64_bf16 v[176:179], v[16:19], a[0:7], v4
    v_smfmac_f32_16x16x64_bf16 v[180:183], v[36:39], a[0:7], v4
    v_smfmac_f32_16x16x64_bf16 v[184:187], v[56:59], a[0:7], v4
    buffer_load_dwordx4 v[104:107], v240, s[8:11], s32 offen offset:2048 sc1
    v_smfmac_f32_16x16x64_bf16 v[188:191], v[76:79], a[0:7], v4
    v_smfmac_f32_16x16x64_bf16 v[192:195], v[16:19], a[32:39], v4
    v_smfmac_f32_16x16x64_bf16 v[196:199], v[36:39], a[32:39], v4
    v_smfmac_f32_16x16x64_bf16 v[200:203], v[56:59], a[32:39], v4
    buffer_load_dwordx4 v[108:111], v240, s[8:11], s32 offen offset:3072 sc1
    v_smfmac_f32_16x16x64_bf16 v[204:207], v[76:79], a[32:39], v4
    v_smfmac_f32_16x16x64_bf16 v[176:179], v[20:23], a[8:15], v4
    v_smfmac_f32_16x16x64_bf16 v[180:183], v[40:43], a[8:15], v4
    v_smfmac_f32_16x16x64_bf16 v[184:187], v[60:63], a[8:15], v4
    buffer_load_dwordx4 v[112:115], v241, s[8:11], s32 offen sc1
    v_smfmac_f32_16x16x64_bf16 v[188:191], v[80:83], a[8:15], v4
    v_smfmac_f32_16x16x64_bf16 v[192:195], v[20:23], a[40:47], v4
    v_smfmac_f32_16x16x64_bf16 v[196:199], v[40:43], a[40:47], v4
    v_smfmac_f32_16x16x64_bf16 v[200:203], v[60:63], a[40:47], v4
    buffer_load_dwordx4 v[116:119], v240, s[8:11], s64 offen offset:0 sc1
    v_smfmac_f32_16x16x64_bf16 v[204:207], v[80:83], a[40:47], v4
    v_smfmac_f32_16x16x64_bf16 v[176:179], v[24:27], a[16:23], v4
    v_smfmac_f32_16x16x64_bf16 v[180:183], v[44:47], a[16:23], v4
    v_smfmac_f32_16x16x64_bf16 v[184:187], v[64:67], a[16:23], v4
    buffer_load_dwordx4 v[120:123], v240, s[8:11], s64 offen offset:1024 sc1
    v_smfmac_f32_16x16x64_bf16 v[188:191], v[84:87], a[16:23], v4
    v_smfmac_f32_16x16x64_bf16 v[192:195], v[24:27], a[48:55], v4
    v_smfmac_f32_16x16x64_bf16 v[196:199], v[44:47], a[48:55], v4
    v_smfmac_f32_16x16x64_bf16 v[200:203], v[64:67], a[48:55], v4
    buffer_load_dwordx4 v[124:127], v240, s[8:11], s64 offen offset:2048 sc1
    v_smfmac_f32_16x16x64_bf16 v[204:207], v[84:87], a[48:55], v4
    v_smfmac_f32_16x16x64_bf16 v[176:179], v[28:31], a[24:31], v4
    v_smfmac_f32_16x16x64_bf16 v[180:183], v[48:51], a[24:31], v4
    v_smfmac_f32_16x16x64_bf16 v[184:187], v[68:71], a[24:31], v4
    buffer_load_dwordx4 v[128:131], v240, s[8:11], s64 offen offset:3072 sc1
    v_smfmac_f32_16x16x64_bf16 v[188:191], v[88:91], a[24:31], v4
    v_smfmac_f32_16x16x64_bf16 v[192:195], v[28:31], a[56:63], v4
    v_smfmac_f32_16x16x64_bf16 v[196:199], v[48:51], a[56:63], v4
    v_smfmac_f32_16x16x64_bf16 v[200:203], v[68:71], a[56:63], v4
    buffer_load_dwordx4 v[132:135], v241, s[8:11], s64 offen sc1
    v_smfmac_f32_16x16x64_bf16 v[204:207], v[88:91], a[56:63], v4
    v_smfmac_f32_16x16x64_bf16 v[176:179], v[32:35], a[128:135], v4
    v_smfmac_f32_16x16x64_bf16 v[180:183], v[52:55], a[128:135], v4
    v_smfmac_f32_16x16x64_bf16 v[184:187], v[72:75], a[128:135], v4
    buffer_load_dwordx4 v[136:139], v240, s[8:11], s65 offen offset:0 sc1
    v_smfmac_f32_16x16x64_bf16 v[188:191], v[92:95], a[128:135], v4
    v_smfmac_f32_16x16x64_bf16 v[192:195], v[32:35], a[136:143], v4
    v_smfmac_f32_16x16x64_bf16 v[196:199], v[52:55], a[136:143], v4
    v_smfmac_f32_16x16x64_bf16 v[200:203], v[72:75], a[136:143], v4
    buffer_load_dwordx4 v[140:143], v240, s[8:11], s65 offen offset:1024 sc1
    v_smfmac_f32_16x16x64_bf16 v[204:207], v[92:95], a[136:143], v4
    s_nop 5
    v_permlane32_swap_b32 v176, v192
    v_permlane32_swap_b32 v177, v193
    v_permlane32_swap_b32 v178, v194
    v_permlane32_swap_b32 v179, v195
    v_add_f32 v176, v176, v192
    v_add_f32 v177, v177, v193
    v_add_f32 v178, v178, v194
    v_add_f32 v179, v179, v195
    ds_write_b128 v12, v[176:179] offset:0
    buffer_load_dwordx4 v[144:147], v240, s[8:11], s65 offen offset:2048 sc1
    v_permlane32_swap_b32 v180, v196
    v_permlane32_swap_b32 v181, v197
    v_permlane32_swap_b32 v182, v198
    v_permlane32_swap_b32 v183, v199
    v_add_f32 v180, v180, v196
    v_add_f32 v181, v181, v197
    v_add_f32 v182, v182, v198
    v_add_f32 v183, v183, v199
    ds_write_b128 v12, v[180:183] offset:4096
    buffer_load_dwordx4 v[148:151], v240, s[8:11], s65 offen offset:3072 sc1
    v_permlane32_swap_b32 v184, v200
    v_permlane32_swap_b32 v185, v201
    v_permlane32_swap_b32 v186, v202
    v_permlane32_swap_b32 v187, v203
    v_add_f32 v184, v184, v200
    v_add_f32 v185, v185, v201
    v_add_f32 v186, v186, v202
    v_add_f32 v187, v187, v203
    ds_write_b128 v12, v[184:187] offset:8192
    buffer_load_dwordx4 v[152:155], v241, s[8:11], s65 offen sc1
    v_permlane32_swap_b32 v188, v204
    v_permlane32_swap_b32 v189, v205
    v_permlane32_swap_b32 v190, v206
    v_permlane32_swap_b32 v191, v207
    v_add_f32 v188, v188, v204
    v_add_f32 v189, v189, v205
    v_add_f32 v190, v190, v206
    v_add_f32 v191, v191, v207
    ds_write_b128 v12, v[188:191] offset:12288
    buffer_load_dwordx4 v[156:159], v240, s[8:11], s66 offen offset:0 sc1
    s_waitcnt lgkmcnt(0)
    s_cmp_lg_u32 s3, 3
    s_cbranch_scc1 c_rsx0
    s_waitcnt vmcnt(16)
    s_mov_b64 exec, 1
    v_cmp_eq_u32 vcc, 19, v230
    v_mov_b32 v230, 0
    s_cbranch_vccz c_rtx0
    buffer_store_dword v231, off, s[8:11], s56 sc1
c_rtx0:
    s_mov_b64 exec, -1
c_rsx0:

    s_barrier

    ds_read_b128 v[208:211], v13 offset:0
    buffer_load_dwordx4 v[160:163], v240, s[8:11], s66 offen offset:1024 sc1
    ds_read_b128 v[212:215], v13 offset:1024
    ds_read_b128 v[216:219], v13 offset:2048
    ds_read_b128 v[220:223], v13 offset:3072
    buffer_load_dwordx4 v[164:167], v240, s[8:11], s66 offen offset:2048 sc1
    s_mul_i32 s74, s57, 40960
    s_lshl_b32 s75, s58, 6
    s_add_u32 s74, s74, s75
    s_add_u32 s74, s74, 0x1400000
    s_lshl_b32 s75, s57, 7
    s_add_u32 s75, s75, 0x1a500
    s_waitcnt lgkmcnt(0)

    v_add_f32 v208, v208, v212
    v_add_f32 v216, v216, v220
    buffer_load_dwordx4 v[168:171], v240, s[8:11], s66 offen offset:3072 sc1
    v_add_f32 v209, v209, v213
    v_add_f32 v217, v217, v221
    v_add_f32 v210, v210, v214
    v_add_f32 v218, v218, v222
    v_add_f32 v211, v211, v215
    v_add_f32 v219, v219, v223
    v_add_f32 v208, v208, v216
    v_add_f32 v209, v209, v217
    v_add_f32 v210, v210, v218
    v_add_f32 v211, v211, v219
    s_nop 0
    v_mov_b32_dpp v216, v208 quad_perm:[1,0,3,2] row_mask:0xf bank_mask:0xf
    v_mov_b32_dpp v217, v209 quad_perm:[1,0,3,2] row_mask:0xf bank_mask:0xf
    v_mov_b32_dpp v218, v210 quad_perm:[1,0,3,2] row_mask:0xf bank_mask:0xf
    buffer_load_dwordx4 v[172:175], v241, s[8:11], s66 offen sc1
    v_mov_b32_dpp v219, v211 quad_perm:[1,0,3,2] row_mask:0xf bank_mask:0xf
    v_cvt_pk_bf16_f32 v208, v208, v216
    v_min_u32 v208, -2, v208
    buffer_store_dword v208, v242, s[8:11], s74 offen offset:0 sc1
    v_cvt_pk_bf16_f32 v209, v209, v217
    v_min_u32 v209, -2, v209
    buffer_store_dword v209, v242, s[8:11], s74 offen offset:1280 sc1
    v_cvt_pk_bf16_f32 v210, v210, v218
    v_min_u32 v210, -2, v210
    buffer_store_dword v210, v242, s[8:11], s74 offen offset:2560 sc1
    v_cvt_pk_bf16_f32 v211, v211, v219
    v_min_u32 v211, -2, v211
    buffer_store_dword v211, v242, s[8:11], s74 offen offset:3840 sc1
    buffer_load_dwordx2 a[144:145], v239, s[8:11], s67 offen offset:0 sc1
    buffer_load_dwordx2 a[152:153], v239, s[8:11], s67 offen offset:256 sc1
    buffer_load_dwordx2 a[146:147], v239, s[8:11], s69 offen offset:0 sc1
    buffer_load_dwordx2 a[154:155], v239, s[8:11], s69 offen offset:256 sc1
    buffer_load_dwordx2 a[148:149], v239, s[8:11], s70 offen offset:0 sc1
    buffer_load_dwordx2 a[156:157], v239, s[8:11], s70 offen offset:256 sc1
    buffer_load_dwordx2 a[150:151], v239, s[8:11], s71 offen offset:0 sc1
    buffer_load_dwordx2 a[158:159], v239, s[8:11], s71 offen offset:256 sc1
    s_mov_b64 exec, 255
    buffer_load_dword v233, v243, s[8:11], s61 offen sc1
    buffer_load_dwordx4 v[224:227], v243, s[8:11], s34 offen sc1
    s_mov_b64 exec, -1
    s_add_u32 s40, s78, 25
    s_cmp_lt_u32 s40, 920
    s_cselect_b32 s40, s40, s76
    s_add_u32 s41, s78, 50
    s_cmp_lt_u32 s78, 920
    s_cselect_b32 s78, s40, s41

    s_mul_i32 s60, s78, 3277
    s_lshr_b32 s60, s60, 16
    s_mul_i32 s40, s60, 20
    s_sub_u32 s63, s78, s40

    s_cmp_ge_u32 s68, 64
    s_cbranch_scc1 cux_100
    s_add_u32 s45, s68, 1
    s_mov_b64 exec, 255
    v_cmp_gt_u32 vcc, s45, v232
    s_mov_b64 exec, -1
    s_cbranch_vccz cux_99

wa_102:
    s_mov_b32 exec_lo, 0xff
    s_mov_b32 exec_hi, 0
    buffer_load_dword v232, v243, s[8:11], s62 offen sc1
    s_waitcnt vmcnt(0)

    v_cmp_gt_u32 vcc, s45, v232
    s_mov_b64 exec, -1
    s_cbranch_vccz wad_103
    s_sub_u32 s30, s30, 1
    s_cmp_lt_i32 s30, 0
    s_cbranch_scc1 wad_103
    s_sleep 4
    s_branch wa_102

wad_103:
cux_99:
    s_mul_i32 s33, s68, 1310720
    s_lshl_b32 s40, s72, 11
    s_add_u32 s33, s33, s40
    s_add_u32 s33, s33, s73

    buffer_load_dwordx4 a[0:3], v5, s[8:11], s33 offen offset:0 sc1
    buffer_load_dwordx4 a[32:35], v5, s[8:11], s33 offen offset:1024 sc1
    s_add_u32 s33, s33, 40960
    buffer_load_dwordx4 a[4:7], v5, s[8:11], s33 offen offset:0 sc1
    buffer_load_dwordx4 a[36:39], v5, s[8:11], s33 offen offset:1024 sc1
    s_add_u32 s33, s33, 40960
    buffer_load_dwordx4 a[8:11], v5, s[8:11], s33 offen offset:0 sc1
    buffer_load_dwordx4 a[40:43], v5, s[8:11], s33 offen offset:1024 sc1
    s_add_u32 s33, s33, 40960
    buffer_load_dwordx4 a[12:15], v5, s[8:11], s33 offen offset:0 sc1
    buffer_load_dwordx4 a[44:47], v5, s[8:11], s33 offen offset:1024 sc1
    s_add_u32 s33, s33, 40960
    buffer_load_dwordx4 a[16:19], v5, s[8:11], s33 offen offset:0 sc1
    buffer_load_dwordx4 a[48:51], v5, s[8:11], s33 offen offset:1024 sc1
    s_add_u32 s33, s33, 40960
    buffer_load_dwordx4 a[20:23], v5, s[8:11], s33 offen offset:0 sc1
    buffer_load_dwordx4 a[52:55], v5, s[8:11], s33 offen offset:1024 sc1
    s_add_u32 s33, s33, 40960
    buffer_load_dwordx4 a[24:27], v5, s[8:11], s33 offen offset:0 sc1
    buffer_load_dwordx4 a[56:59], v5, s[8:11], s33 offen offset:1024 sc1
    s_add_u32 s33, s33, 40960
    buffer_load_dwordx4 a[28:31], v5, s[8:11], s33 offen offset:0 sc1
    buffer_load_dwordx4 a[60:63], v5, s[8:11], s33 offen offset:1024 sc1
    s_add_u32 s33, s33, 40960
    s_waitcnt vmcnt(16)
    s_branch cux_101
cux_100:
    s_waitcnt vmcnt(0)
cux_101:
    s_add_u32 s40, s79, 25
    s_cmp_lt_u32 s40, 920
    s_cselect_b32 s40, s40, s76
    s_add_u32 s41, s79, 50
    s_cmp_lt_u32 s79, 920
    s_cselect_b32 s79, s40, s41

    s_mul_i32 s68, s79, 3277
    s_lshr_b32 s68, s68, 16
    s_mul_i32 s40, s68, 20
    s_sub_u32 s72, s79, s40

    s_barrier
    s_cmp_lg_u32 s3, 3
    s_cbranch_scc1 c_nfa0
    s_lshl_b32 s40, s57, 2
    s_add_u32 s40, s40, 0x1c800
    s_mov_b32 s56, s75
    v_mov_b32 v230, 1
    s_mov_b64 exec, 1
    buffer_atomic_add v230, off, s[8:11], s40 sc0

    s_mov_b64 exec, -1
c_nfa0:

    s_branch cjn_97
cpl_96:
    v_mov_b32 v176, 0
    v_mov_b32 v177, 0
    v_mov_b32 v178, 0
    v_mov_b32 v179, 0
    v_mov_b32 v180, 0
    v_mov_b32 v181, 0
    v_mov_b32 v182, 0
    v_mov_b32 v183, 0
    v_mov_b32 v184, 0
    v_mov_b32 v185, 0
    v_mov_b32 v186, 0
    v_mov_b32 v187, 0
    v_mov_b32 v188, 0
    v_mov_b32 v189, 0
    v_mov_b32 v190, 0
    v_mov_b32 v191, 0
    v_mov_b32 v192, 0
    v_mov_b32 v193, 0
    v_mov_b32 v194, 0
    v_mov_b32 v195, 0
    v_mov_b32 v196, 0
    v_mov_b32 v197, 0
    v_mov_b32 v198, 0
    v_mov_b32 v199, 0
    v_mov_b32 v200, 0
    v_mov_b32 v201, 0
    v_mov_b32 v202, 0
    v_mov_b32 v203, 0
    v_mov_b32 v204, 0
    v_mov_b32 v205, 0
    v_mov_b32 v206, 0
    v_mov_b32 v207, 0
    s_nop 0
    v_smfmac_f32_16x16x64_bf16 v[176:179], v[16:19], a[0:7], v4
    v_smfmac_f32_16x16x64_bf16 v[180:183], v[36:39], a[0:7], v4
    v_smfmac_f32_16x16x64_bf16 v[184:187], v[56:59], a[0:7], v4
    v_smfmac_f32_16x16x64_bf16 v[188:191], v[76:79], a[0:7], v4
    v_smfmac_f32_16x16x64_bf16 v[192:195], v[16:19], a[32:39], v4
    v_smfmac_f32_16x16x64_bf16 v[196:199], v[36:39], a[32:39], v4
    v_smfmac_f32_16x16x64_bf16 v[200:203], v[56:59], a[32:39], v4
    v_smfmac_f32_16x16x64_bf16 v[204:207], v[76:79], a[32:39], v4
    v_smfmac_f32_16x16x64_bf16 v[176:179], v[20:23], a[8:15], v4
    v_smfmac_f32_16x16x64_bf16 v[180:183], v[40:43], a[8:15], v4
    v_smfmac_f32_16x16x64_bf16 v[184:187], v[60:63], a[8:15], v4
    v_smfmac_f32_16x16x64_bf16 v[188:191], v[80:83], a[8:15], v4
    v_smfmac_f32_16x16x64_bf16 v[192:195], v[20:23], a[40:47], v4
    v_smfmac_f32_16x16x64_bf16 v[196:199], v[40:43], a[40:47], v4
    v_smfmac_f32_16x16x64_bf16 v[200:203], v[60:63], a[40:47], v4
    v_smfmac_f32_16x16x64_bf16 v[204:207], v[80:83], a[40:47], v4
    v_smfmac_f32_16x16x64_bf16 v[176:179], v[24:27], a[16:23], v4
    v_smfmac_f32_16x16x64_bf16 v[180:183], v[44:47], a[16:23], v4
    v_smfmac_f32_16x16x64_bf16 v[184:187], v[64:67], a[16:23], v4
    v_smfmac_f32_16x16x64_bf16 v[188:191], v[84:87], a[16:23], v4
    v_smfmac_f32_16x16x64_bf16 v[192:195], v[24:27], a[48:55], v4
    v_smfmac_f32_16x16x64_bf16 v[196:199], v[44:47], a[48:55], v4
    v_smfmac_f32_16x16x64_bf16 v[200:203], v[64:67], a[48:55], v4
    v_smfmac_f32_16x16x64_bf16 v[204:207], v[84:87], a[48:55], v4
    v_smfmac_f32_16x16x64_bf16 v[176:179], v[28:31], a[24:31], v4
    v_smfmac_f32_16x16x64_bf16 v[180:183], v[48:51], a[24:31], v4
    v_smfmac_f32_16x16x64_bf16 v[184:187], v[68:71], a[24:31], v4
    v_smfmac_f32_16x16x64_bf16 v[188:191], v[88:91], a[24:31], v4
    v_smfmac_f32_16x16x64_bf16 v[192:195], v[28:31], a[56:63], v4
    v_smfmac_f32_16x16x64_bf16 v[196:199], v[48:51], a[56:63], v4
    v_smfmac_f32_16x16x64_bf16 v[200:203], v[68:71], a[56:63], v4
    v_smfmac_f32_16x16x64_bf16 v[204:207], v[88:91], a[56:63], v4
    v_smfmac_f32_16x16x64_bf16 v[176:179], v[32:35], a[128:135], v4
    v_smfmac_f32_16x16x64_bf16 v[180:183], v[52:55], a[128:135], v4
    v_smfmac_f32_16x16x64_bf16 v[184:187], v[72:75], a[128:135], v4
    v_smfmac_f32_16x16x64_bf16 v[188:191], v[92:95], a[128:135], v4
    v_smfmac_f32_16x16x64_bf16 v[192:195], v[32:35], a[136:143], v4
    v_smfmac_f32_16x16x64_bf16 v[196:199], v[52:55], a[136:143], v4
    v_smfmac_f32_16x16x64_bf16 v[200:203], v[72:75], a[136:143], v4
    v_smfmac_f32_16x16x64_bf16 v[204:207], v[92:95], a[136:143], v4
    s_nop 5
    v_permlane32_swap_b32 v176, v192
    v_permlane32_swap_b32 v177, v193
    v_permlane32_swap_b32 v178, v194
    v_permlane32_swap_b32 v179, v195
    v_add_f32 v176, v176, v192
    v_add_f32 v177, v177, v193
    v_add_f32 v178, v178, v194
    v_add_f32 v179, v179, v195
    ds_write_b128 v12, v[176:179] offset:0
    v_permlane32_swap_b32 v180, v196
    v_permlane32_swap_b32 v181, v197
    v_permlane32_swap_b32 v182, v198
    v_permlane32_swap_b32 v183, v199
    v_add_f32 v180, v180, v196
    v_add_f32 v181, v181, v197
    v_add_f32 v182, v182, v198
    v_add_f32 v183, v183, v199
    ds_write_b128 v12, v[180:183] offset:4096
    v_permlane32_swap_b32 v184, v200
    v_permlane32_swap_b32 v185, v201
    v_permlane32_swap_b32 v186, v202
    v_permlane32_swap_b32 v187, v203
    v_add_f32 v184, v184, v200
    v_add_f32 v185, v185, v201
    v_add_f32 v186, v186, v202
    v_add_f32 v187, v187, v203
    ds_write_b128 v12, v[184:187] offset:8192
    v_permlane32_swap_b32 v188, v204
    v_permlane32_swap_b32 v189, v205
    v_permlane32_swap_b32 v190, v206
    v_permlane32_swap_b32 v191, v207
    v_add_f32 v188, v188, v204
    v_add_f32 v189, v189, v205
    v_add_f32 v190, v190, v206
    v_add_f32 v191, v191, v207
    ds_write_b128 v12, v[188:191] offset:12288
    s_waitcnt lgkmcnt(0)
    s_cmp_lg_u32 s3, 3
    s_cbranch_scc1 c_rsy0
    s_waitcnt vmcnt(0)
    s_mov_b64 exec, 1
    v_cmp_eq_u32 vcc, 19, v230
    v_mov_b32 v230, 0
    s_cbranch_vccz c_rty0
    buffer_store_dword v231, off, s[8:11], s56 sc1
c_rty0:
    s_mov_b64 exec, -1
c_rsy0:

    s_barrier

    ds_read_b128 v[208:211], v13 offset:0
    ds_read_b128 v[212:215], v13 offset:1024
    ds_read_b128 v[216:219], v13 offset:2048
    ds_read_b128 v[220:223], v13 offset:3072
    s_mul_i32 s74, s57, 40960
    s_lshl_b32 s75, s58, 6
    s_add_u32 s74, s74, s75
    s_add_u32 s74, s74, 0x1400000
    s_lshl_b32 s75, s57, 7
    s_add_u32 s75, s75, 0x1a500
    s_waitcnt lgkmcnt(0)

    v_add_f32 v208, v208, v212
    v_add_f32 v216, v216, v220
    v_add_f32 v209, v209, v213
    v_add_f32 v217, v217, v221
    v_add_f32 v210, v210, v214
    v_add_f32 v218, v218, v222
    v_add_f32 v211, v211, v215
    v_add_f32 v219, v219, v223
    v_add_f32 v208, v208, v216
    v_add_f32 v209, v209, v217
    v_add_f32 v210, v210, v218
    v_add_f32 v211, v211, v219
    s_nop 0
    v_mov_b32_dpp v216, v208 quad_perm:[1,0,3,2] row_mask:0xf bank_mask:0xf
    v_mov_b32_dpp v217, v209 quad_perm:[1,0,3,2] row_mask:0xf bank_mask:0xf
    v_mov_b32_dpp v218, v210 quad_perm:[1,0,3,2] row_mask:0xf bank_mask:0xf
    v_mov_b32_dpp v219, v211 quad_perm:[1,0,3,2] row_mask:0xf bank_mask:0xf
    v_cvt_pk_bf16_f32 v208, v208, v216
    v_min_u32 v208, -2, v208
    buffer_store_dword v208, v242, s[8:11], s74 offen offset:0 sc1
    v_cvt_pk_bf16_f32 v209, v209, v217
    v_min_u32 v209, -2, v209
    buffer_store_dword v209, v242, s[8:11], s74 offen offset:1280 sc1
    v_cvt_pk_bf16_f32 v210, v210, v218
    v_min_u32 v210, -2, v210
    buffer_store_dword v210, v242, s[8:11], s74 offen offset:2560 sc1
    v_cvt_pk_bf16_f32 v211, v211, v219
    v_min_u32 v211, -2, v211
    buffer_store_dword v211, v242, s[8:11], s74 offen offset:3840 sc1
    s_mov_b64 exec, 255
    buffer_load_dword v233, v243, s[8:11], s61 offen sc1
    buffer_load_dwordx4 v[224:227], v243, s[8:11], s34 offen sc1
    s_mov_b64 exec, -1
    s_waitcnt vmcnt(0)
    s_barrier
    s_cmp_lg_u32 s3, 3
    s_cbranch_scc1 c_nfb0
    s_lshl_b32 s40, s57, 2
    s_add_u32 s40, s40, 0x1c800
    s_mov_b32 s56, s75
    v_mov_b32 v230, 1
    s_mov_b64 exec, 1
    buffer_atomic_add v230, off, s[8:11], s40 sc0

    s_mov_b64 exec, -1
c_nfb0:

    v_min3_u32 v234, v233, v224, v225
    v_min3_u32 v234, v234, v226, v227
    s_mov_b64 exec, 255
    v_cmp_gt_u32 vcc, s44, v234
    s_mov_b64 exec, -1
    s_cbranch_vccnz csl_104

    s_cmp_ge_u32 s60, 56
    s_cbranch_scc1 csl_104
    s_mov_b32 s59, 1

    s_mul_i32 s32, s60, 81920
    s_add_u32 s32, s32, 0x800000
    s_add_u32 s64, s32, 20480
    s_add_u32 s65, s32, 40960
    s_add_u32 s66, s32, 61440
    s_mul_i32 s67, s60, 327680
    s_lshl_b32 s40, s63, 9
    s_add_u32 s67, s67, s40
    s_add_u32 s67, s67, 0x6800000
    s_add_u32 s69, s67, 20480
    s_add_u32 s70, s67, 40960
    s_add_u32 s71, s67, 61440

    buffer_load_dwordx4 v[96:99], v240, s[8:11], s32 offen offset:0 sc1
    buffer_load_dwordx4 v[100:103], v240, s[8:11], s32 offen offset:1024 sc1
    buffer_load_dwordx4 v[104:107], v240, s[8:11], s32 offen offset:2048 sc1
    buffer_load_dwordx4 v[108:111], v240, s[8:11], s32 offen offset:3072 sc1
    buffer_load_dwordx4 v[112:115], v241, s[8:11], s32 offen sc1
    buffer_load_dwordx4 v[116:119], v240, s[8:11], s64 offen offset:0 sc1
    buffer_load_dwordx4 v[120:123], v240, s[8:11], s64 offen offset:1024 sc1
    buffer_load_dwordx4 v[124:127], v240, s[8:11], s64 offen offset:2048 sc1
    buffer_load_dwordx4 v[128:131], v240, s[8:11], s64 offen offset:3072 sc1
    buffer_load_dwordx4 v[132:135], v241, s[8:11], s64 offen sc1
    buffer_load_dwordx4 v[136:139], v240, s[8:11], s65 offen offset:0 sc1
    buffer_load_dwordx4 v[140:143], v240, s[8:11], s65 offen offset:1024 sc1
    buffer_load_dwordx4 v[144:147], v240, s[8:11], s65 offen offset:2048 sc1
    buffer_load_dwordx4 v[148:151], v240, s[8:11], s65 offen offset:3072 sc1
    buffer_load_dwordx4 v[152:155], v241, s[8:11], s65 offen sc1
    buffer_load_dwordx4 v[156:159], v240, s[8:11], s66 offen offset:0 sc1
    buffer_load_dwordx4 v[160:163], v240, s[8:11], s66 offen offset:1024 sc1
    buffer_load_dwordx4 v[164:167], v240, s[8:11], s66 offen offset:2048 sc1
    buffer_load_dwordx4 v[168:171], v240, s[8:11], s66 offen offset:3072 sc1
    buffer_load_dwordx4 v[172:175], v241, s[8:11], s66 offen sc1
    buffer_load_dwordx2 a[144:145], v239, s[8:11], s67 offen offset:0 sc1
    buffer_load_dwordx2 a[152:153], v239, s[8:11], s67 offen offset:256 sc1
    buffer_load_dwordx2 a[146:147], v239, s[8:11], s69 offen offset:0 sc1
    buffer_load_dwordx2 a[154:155], v239, s[8:11], s69 offen offset:256 sc1
    buffer_load_dwordx2 a[148:149], v239, s[8:11], s70 offen offset:0 sc1
    buffer_load_dwordx2 a[156:157], v239, s[8:11], s70 offen offset:256 sc1
    buffer_load_dwordx2 a[150:151], v239, s[8:11], s71 offen offset:0 sc1
    buffer_load_dwordx2 a[158:159], v239, s[8:11], s71 offen offset:256 sc1
    s_cmp_lg_u32 s3, 3
    s_cbranch_scc1 c_qf0
    s_waitcnt vmcnt(28)
    s_mov_b64 exec, 1
    v_cmp_eq_u32 vcc, 19, v230
    v_mov_b32 v230, 0
    s_cbranch_vccz c_pf0
    buffer_store_dword v231, off, s[8:11], s56 sc1
c_pf0:
    s_mov_b64 exec, -1
c_qf0:

    s_mov_b64 exec, 255
    buffer_load_dword v233, v243, s[8:11], s61 offen sc1
    buffer_load_dwordx4 v[224:227], v243, s[8:11], s34 offen sc1
    s_mov_b64 exec, -1
    s_add_u32 s40, s78, 25
    s_cmp_lt_u32 s40, 920
    s_cselect_b32 s40, s40, s76
    s_add_u32 s41, s78, 50
    s_cmp_lt_u32 s78, 920
    s_cselect_b32 s78, s40, s41

    s_mul_i32 s60, s78, 3277
    s_lshr_b32 s60, s60, 16
    s_mul_i32 s40, s60, 20
    s_sub_u32 s63, s78, s40

    s_cmp_ge_u32 s68, 64
    s_cbranch_scc1 cux_106
    s_add_u32 s45, s68, 1
    s_mov_b64 exec, 255
    v_cmp_gt_u32 vcc, s45, v232
    s_mov_b64 exec, -1
    s_cbranch_vccz cux_105

wa_108:
    s_mov_b32 exec_lo, 0xff
    s_mov_b32 exec_hi, 0
    buffer_load_dword v232, v243, s[8:11], s62 offen sc1
    s_waitcnt vmcnt(0)

    v_cmp_gt_u32 vcc, s45, v232
    s_mov_b64 exec, -1
    s_cbranch_vccz wad_109
    s_sub_u32 s30, s30, 1
    s_cmp_lt_i32 s30, 0
    s_cbranch_scc1 wad_109
    s_sleep 4
    s_branch wa_108

wad_109:
cux_105:
    s_mul_i32 s33, s68, 1310720
    s_lshl_b32 s40, s72, 11
    s_add_u32 s33, s33, s40
    s_add_u32 s33, s33, s73

    buffer_load_dwordx4 a[0:3], v5, s[8:11], s33 offen offset:0 sc1
    buffer_load_dwordx4 a[32:35], v5, s[8:11], s33 offen offset:1024 sc1
    s_add_u32 s33, s33, 40960
    buffer_load_dwordx4 a[4:7], v5, s[8:11], s33 offen offset:0 sc1
    buffer_load_dwordx4 a[36:39], v5, s[8:11], s33 offen offset:1024 sc1
    s_add_u32 s33, s33, 40960
    buffer_load_dwordx4 a[8:11], v5, s[8:11], s33 offen offset:0 sc1
    buffer_load_dwordx4 a[40:43], v5, s[8:11], s33 offen offset:1024 sc1
    s_add_u32 s33, s33, 40960
    buffer_load_dwordx4 a[12:15], v5, s[8:11], s33 offen offset:0 sc1
    buffer_load_dwordx4 a[44:47], v5, s[8:11], s33 offen offset:1024 sc1
    s_add_u32 s33, s33, 40960
    buffer_load_dwordx4 a[16:19], v5, s[8:11], s33 offen offset:0 sc1
    buffer_load_dwordx4 a[48:51], v5, s[8:11], s33 offen offset:1024 sc1
    s_add_u32 s33, s33, 40960
    buffer_load_dwordx4 a[20:23], v5, s[8:11], s33 offen offset:0 sc1
    buffer_load_dwordx4 a[52:55], v5, s[8:11], s33 offen offset:1024 sc1
    s_add_u32 s33, s33, 40960
    buffer_load_dwordx4 a[24:27], v5, s[8:11], s33 offen offset:0 sc1
    buffer_load_dwordx4 a[56:59], v5, s[8:11], s33 offen offset:1024 sc1
    s_add_u32 s33, s33, 40960
    buffer_load_dwordx4 a[28:31], v5, s[8:11], s33 offen offset:0 sc1
    buffer_load_dwordx4 a[60:63], v5, s[8:11], s33 offen offset:1024 sc1
    s_add_u32 s33, s33, 40960
    s_waitcnt vmcnt(16)
    s_branch cux_107
cux_106:
    s_waitcnt vmcnt(0)
cux_107:
    s_add_u32 s40, s79, 25
    s_cmp_lt_u32 s40, 920
    s_cselect_b32 s40, s40, s76
    s_add_u32 s41, s79, 50
    s_cmp_lt_u32 s79, 920
    s_cselect_b32 s79, s40, s41

    s_mul_i32 s68, s79, 3277
    s_lshr_b32 s68, s68, 16
    s_mul_i32 s40, s68, 20
    s_sub_u32 s72, s79, s40

    s_branch cjn_97
csl_104:
    s_cmp_lg_u32 s3, 3
    s_cbranch_scc1 c_qs0
    s_waitcnt vmcnt(0)
    s_mov_b64 exec, 1
    v_cmp_eq_u32 vcc, 19, v230
    v_mov_b32 v230, 0
    s_cbranch_vccz c_ps0
    buffer_store_dword v231, off, s[8:11], s56 sc1
c_ps0:
    s_mov_b64 exec, -1
c_qs0:

    s_cmp_ge_u32 s68, 64
    s_cbranch_scc1 cux_111
    s_add_u32 s45, s68, 1
    s_mov_b64 exec, 255
    v_cmp_gt_u32 vcc, s45, v232
    s_mov_b64 exec, -1
    s_cbranch_vccz cux_110

wa_113:
    s_mov_b32 exec_lo, 0xff
    s_mov_b32 exec_hi, 0
    buffer_load_dword v232, v243, s[8:11], s62 offen sc1
    s_waitcnt vmcnt(0)

    v_cmp_gt_u32 vcc, s45, v232
    s_mov_b64 exec, -1
    s_cbranch_vccz wad_114
    s_sub_u32 s30, s30, 1
    s_cmp_lt_i32 s30, 0
    s_cbranch_scc1 wad_114
    s_sleep 4
    s_branch wa_113

wad_114:
cux_110:
    s_mul_i32 s33, s68, 1310720
    s_lshl_b32 s40, s72, 11
    s_add_u32 s33, s33, s40
    s_add_u32 s33, s33, s73

    buffer_load_dwordx4 a[0:3], v5, s[8:11], s33 offen offset:0 sc1
    buffer_load_dwordx4 a[32:35], v5, s[8:11], s33 offen offset:1024 sc1
    s_add_u32 s33, s33, 40960
    buffer_load_dwordx4 a[4:7], v5, s[8:11], s33 offen offset:0 sc1
    buffer_load_dwordx4 a[36:39], v5, s[8:11], s33 offen offset:1024 sc1
    s_add_u32 s33, s33, 40960
    buffer_load_dwordx4 a[8:11], v5, s[8:11], s33 offen offset:0 sc1
    buffer_load_dwordx4 a[40:43], v5, s[8:11], s33 offen offset:1024 sc1
    s_add_u32 s33, s33, 40960
    buffer_load_dwordx4 a[12:15], v5, s[8:11], s33 offen offset:0 sc1
    buffer_load_dwordx4 a[44:47], v5, s[8:11], s33 offen offset:1024 sc1
    s_add_u32 s33, s33, 40960
    buffer_load_dwordx4 a[16:19], v5, s[8:11], s33 offen offset:0 sc1
    buffer_load_dwordx4 a[48:51], v5, s[8:11], s33 offen offset:1024 sc1
    s_add_u32 s33, s33, 40960
    buffer_load_dwordx4 a[20:23], v5, s[8:11], s33 offen offset:0 sc1
    buffer_load_dwordx4 a[52:55], v5, s[8:11], s33 offen offset:1024 sc1
    s_add_u32 s33, s33, 40960
    buffer_load_dwordx4 a[24:27], v5, s[8:11], s33 offen offset:0 sc1
    buffer_load_dwordx4 a[56:59], v5, s[8:11], s33 offen offset:1024 sc1
    s_add_u32 s33, s33, 40960
    buffer_load_dwordx4 a[28:31], v5, s[8:11], s33 offen offset:0 sc1
    buffer_load_dwordx4 a[60:63], v5, s[8:11], s33 offen offset:1024 sc1
    s_add_u32 s33, s33, 40960
cux_111:
cux_112:
    s_add_u32 s40, s79, 25
    s_cmp_lt_u32 s40, 920
    s_cselect_b32 s40, s40, s76
    s_add_u32 s41, s79, 50
    s_cmp_lt_u32 s79, 920
    s_cselect_b32 s79, s40, s41

    s_mul_i32 s68, s79, 3277
    s_lshr_b32 s68, s68, 16
    s_mul_i32 s40, s68, 20
    s_sub_u32 s72, s79, s40

cjn_97:
    s_add_u32 s40, s77, 25
    s_cmp_lt_u32 s40, 920
    s_cselect_b32 s40, s40, s76
    s_add_u32 s41, s77, 50
    s_cmp_lt_u32 s77, 920
    s_cselect_b32 s77, s40, s41

    s_mul_i32 s57, s77, 3277
    s_lshr_b32 s57, s57, 16
    s_mul_i32 s40, s57, 20
    s_sub_u32 s58, s77, s40

    s_add_u32 s29, s29, 1
    s_cmp_ge_u32 s57, 64
    s_cbranch_scc1 r_end
    s_cmp_eq_u32 s59, 1
    s_cbranch_scc1 cnb_98

    s_add_u32 s44, s60, 1
cb_115:
    s_mov_b64 exec, 255
    buffer_load_dword v233, v243, s[8:11], s61 offen sc1
    buffer_load_dwordx4 v[224:227], v243, s[8:11], s34 offen sc1
    s_mov_b64 exec, -1

    s_waitcnt vmcnt(0)
    s_cmp_lt_u32 s60, 56
    s_cbranch_scc1 cb_118
    v_mov_b32 v233, 64
cb_118:

    v_min3_u32 v234, v233, v224, v225
    v_min3_u32 v234, v234, v226, v227
    s_mov_b64 exec, 255
    v_cmp_gt_u32 vcc, s44, v234
    s_mov_b64 exec, -1
    s_cbranch_vccnz cb_116

    s_branch cb_117
cb_116:
    s_sub_u32 s30, s30, 1
    s_cmp_lt_i32 s30, 0
    s_cbranch_scc1 cb_117
    s_sleep 3
    s_branch cb_115

cb_117:
    s_mul_i32 s32, s60, 81920
    s_add_u32 s32, s32, 0x800000
    s_add_u32 s64, s32, 20480
    s_add_u32 s65, s32, 40960
    s_add_u32 s66, s32, 61440
    s_mul_i32 s67, s60, 327680
    s_lshl_b32 s40, s63, 9
    s_add_u32 s67, s67, s40
    s_add_u32 s67, s67, 0x6800000
    s_add_u32 s69, s67, 20480
    s_add_u32 s70, s67, 40960
    s_add_u32 s71, s67, 61440

cbl_119:
    buffer_load_dwordx4 v[96:99], v240, s[8:11], s32 offen offset:0 sc1
    buffer_load_dwordx4 v[100:103], v240, s[8:11], s32 offen offset:1024 sc1
    buffer_load_dwordx4 v[104:107], v240, s[8:11], s32 offen offset:2048 sc1
    buffer_load_dwordx4 v[108:111], v240, s[8:11], s32 offen offset:3072 sc1
    buffer_load_dwordx4 v[112:115], v241, s[8:11], s32 offen sc1
    buffer_load_dwordx4 v[116:119], v240, s[8:11], s64 offen offset:0 sc1
    buffer_load_dwordx4 v[120:123], v240, s[8:11], s64 offen offset:1024 sc1
    buffer_load_dwordx4 v[124:127], v240, s[8:11], s64 offen offset:2048 sc1
    buffer_load_dwordx4 v[128:131], v240, s[8:11], s64 offen offset:3072 sc1
    buffer_load_dwordx4 v[132:135], v241, s[8:11], s64 offen sc1
    buffer_load_dwordx4 v[136:139], v240, s[8:11], s65 offen offset:0 sc1
    buffer_load_dwordx4 v[140:143], v240, s[8:11], s65 offen offset:1024 sc1
    buffer_load_dwordx4 v[144:147], v240, s[8:11], s65 offen offset:2048 sc1
    buffer_load_dwordx4 v[148:151], v240, s[8:11], s65 offen offset:3072 sc1
    buffer_load_dwordx4 v[152:155], v241, s[8:11], s65 offen sc1
    buffer_load_dwordx4 v[156:159], v240, s[8:11], s66 offen offset:0 sc1
    buffer_load_dwordx4 v[160:163], v240, s[8:11], s66 offen offset:1024 sc1
    buffer_load_dwordx4 v[164:167], v240, s[8:11], s66 offen offset:2048 sc1
    buffer_load_dwordx4 v[168:171], v240, s[8:11], s66 offen offset:3072 sc1
    buffer_load_dwordx4 v[172:175], v241, s[8:11], s66 offen sc1
    buffer_load_dwordx2 a[144:145], v239, s[8:11], s67 offen offset:0 sc1
    buffer_load_dwordx2 a[152:153], v239, s[8:11], s67 offen offset:256 sc1
    buffer_load_dwordx2 a[146:147], v239, s[8:11], s69 offen offset:0 sc1
    buffer_load_dwordx2 a[154:155], v239, s[8:11], s69 offen offset:256 sc1
    buffer_load_dwordx2 a[148:149], v239, s[8:11], s70 offen offset:0 sc1
    buffer_load_dwordx2 a[156:157], v239, s[8:11], s70 offen offset:256 sc1
    buffer_load_dwordx2 a[150:151], v239, s[8:11], s71 offen offset:0 sc1
    buffer_load_dwordx2 a[158:159], v239, s[8:11], s71 offen offset:256 sc1
    s_mov_b64 exec, 255
    buffer_load_dword v233, v243, s[8:11], s61 offen sc1
    buffer_load_dwordx4 v[224:227], v243, s[8:11], s34 offen sc1
    s_mov_b64 exec, -1

    s_waitcnt vmcnt(0)
    v_max3_u32 v3, v96, v97, v98
    v_max3_u32 v3, v3, v99, v100
    v_max3_u32 v3, v3, v101, v102
    v_max3_u32 v3, v3, v103, v104
    v_max3_u32 v3, v3, v105, v106
    v_max3_u32 v3, v3, v107, v108
    v_max3_u32 v3, v3, v109, v110
    v_max3_u32 v3, v3, v111, v112
    v_max3_u32 v3, v3, v113, v114
    v_max3_u32 v3, v3, v115, v116
    v_max3_u32 v3, v3, v117, v118
    v_max3_u32 v3, v3, v119, v120
    v_max3_u32 v3, v3, v121, v122
    v_max3_u32 v3, v3, v123, v124
    v_max3_u32 v3, v3, v125, v126
    v_max3_u32 v3, v3, v127, v128
    v_max3_u32 v3, v3, v129, v130
    v_max3_u32 v3, v3, v131, v132
    v_max3_u32 v3, v3, v133, v134
    v_max3_u32 v3, v3, v135, v136
    v_max3_u32 v3, v3, v137, v138
    v_max3_u32 v3, v3, v139, v140
    v_max3_u32 v3, v3, v141, v142
    v_max3_u32 v3, v3, v143, v144
    v_max3_u32 v3, v3, v145, v146
    v_max3_u32 v3, v3, v147, v148
    v_max3_u32 v3, v3, v149, v150
    v_max3_u32 v3, v3, v151, v152
    v_max3_u32 v3, v3, v153, v154
    v_max3_u32 v3, v3, v155, v156
    v_max3_u32 v3, v3, v157, v158
    v_max3_u32 v3, v3, v159, v160
    v_max3_u32 v3, v3, v161, v162
    v_max3_u32 v3, v3, v163, v164
    v_max3_u32 v3, v3, v165, v166
    v_max3_u32 v3, v3, v167, v168
    v_max3_u32 v3, v3, v169, v170
    v_max3_u32 v3, v3, v171, v172
    v_max3_u32 v3, v3, v173, v174
    v_max_u32 v3, v3, v175
    v_cmp_eq_u32 vcc, -1, v3
    s_cbranch_vccz pok_120
    s_sub_u32 s30, s30, 1
    s_cmp_lt_i32 s30, 0
    s_cbranch_scc1 pok_120
    s_sleep 4
    s_branch cbl_119

pok_120:
    s_add_u32 s40, s78, 25
    s_cmp_lt_u32 s40, 920
    s_cselect_b32 s40, s40, s76
    s_add_u32 s41, s78, 50
    s_cmp_lt_u32 s78, 920
    s_cselect_b32 s78, s40, s41

    s_mul_i32 s60, s78, 3277
    s_lshr_b32 s60, s60, 16
    s_mul_i32 s40, s60, 20
    s_sub_u32 s63, s78, s40

cnb_98:
    s_add_u32 s44, s60, 1
    s_mov_b32 s59, 0
    v_min3_u32 v234, v233, v224, v225
    v_min3_u32 v234, v234, v226, v227
    s_mov_b64 exec, 255
    v_cmp_gt_u32 vcc, s44, v234
    s_mov_b64 exec, -1
    s_cbranch_vccnz cpl_121

    s_cmp_ge_u32 s60, 56
    s_cbranch_scc1 cpl_121
    s_mov_b32 s59, 1

    s_mul_i32 s32, s60, 81920
    s_add_u32 s32, s32, 0x800000
    s_add_u32 s64, s32, 20480
    s_add_u32 s65, s32, 40960
    s_add_u32 s66, s32, 61440
    s_mul_i32 s67, s60, 327680
    s_lshl_b32 s40, s63, 9
    s_add_u32 s67, s67, s40
    s_add_u32 s67, s67, 0x6800000
    s_add_u32 s69, s67, 20480
    s_add_u32 s70, s67, 40960
    s_add_u32 s71, s67, 61440

    v_mov_b32 v176, 0
    v_mov_b32 v177, 0
    v_mov_b32 v178, 0
    v_mov_b32 v179, 0
    v_mov_b32 v180, 0
    v_mov_b32 v181, 0
    v_mov_b32 v182, 0
    v_mov_b32 v183, 0
    v_mov_b32 v184, 0
    v_mov_b32 v185, 0
    v_mov_b32 v186, 0
    v_mov_b32 v187, 0
    v_mov_b32 v188, 0
    v_mov_b32 v189, 0
    buffer_load_dwordx4 v[16:19], v240, s[8:11], s32 offen offset:0 sc1
    v_mov_b32 v190, 0
    v_mov_b32 v191, 0
    v_mov_b32 v192, 0
    v_mov_b32 v193, 0
    v_mov_b32 v194, 0
    v_mov_b32 v195, 0
    v_mov_b32 v196, 0
    v_mov_b32 v197, 0
    v_mov_b32 v198, 0
    v_mov_b32 v199, 0
    v_mov_b32 v200, 0
    v_mov_b32 v201, 0
    v_mov_b32 v202, 0
    v_mov_b32 v203, 0
    buffer_load_dwordx4 v[20:23], v240, s[8:11], s32 offen offset:1024 sc1
    v_mov_b32 v204, 0
    v_mov_b32 v205, 0
    v_mov_b32 v206, 0
    v_mov_b32 v207, 0
    s_nop 0
    v_smfmac_f32_16x16x64_bf16 v[176:179], v[96:99], a[64:71], v4
    v_smfmac_f32_16x16x64_bf16 v[180:183], v[116:119], a[64:71], v4
    v_smfmac_f32_16x16x64_bf16 v[184:187], v[136:139], a[64:71], v4
    buffer_load_dwordx4 v[24:27], v240, s[8:11], s32 offen offset:2048 sc1
    v_smfmac_f32_16x16x64_bf16 v[188:191], v[156:159], a[64:71], v4
    v_smfmac_f32_16x16x64_bf16 v[192:195], v[96:99], a[96:103], v4
    v_smfmac_f32_16x16x64_bf16 v[196:199], v[116:119], a[96:103], v4
    v_smfmac_f32_16x16x64_bf16 v[200:203], v[136:139], a[96:103], v4
    buffer_load_dwordx4 v[28:31], v240, s[8:11], s32 offen offset:3072 sc1
    v_smfmac_f32_16x16x64_bf16 v[204:207], v[156:159], a[96:103], v4
    v_smfmac_f32_16x16x64_bf16 v[176:179], v[100:103], a[72:79], v4
    v_smfmac_f32_16x16x64_bf16 v[180:183], v[120:123], a[72:79], v4
    v_smfmac_f32_16x16x64_bf16 v[184:187], v[140:143], a[72:79], v4
    buffer_load_dwordx4 v[32:35], v241, s[8:11], s32 offen sc1
    v_smfmac_f32_16x16x64_bf16 v[188:191], v[160:163], a[72:79], v4
    v_smfmac_f32_16x16x64_bf16 v[192:195], v[100:103], a[104:111], v4
    v_smfmac_f32_16x16x64_bf16 v[196:199], v[120:123], a[104:111], v4
    v_smfmac_f32_16x16x64_bf16 v[200:203], v[140:143], a[104:111], v4
    buffer_load_dwordx4 v[36:39], v240, s[8:11], s64 offen offset:0 sc1
    v_smfmac_f32_16x16x64_bf16 v[204:207], v[160:163], a[104:111], v4
    v_smfmac_f32_16x16x64_bf16 v[176:179], v[104:107], a[80:87], v4
    v_smfmac_f32_16x16x64_bf16 v[180:183], v[124:127], a[80:87], v4
    v_smfmac_f32_16x16x64_bf16 v[184:187], v[144:147], a[80:87], v4
    buffer_load_dwordx4 v[40:43], v240, s[8:11], s64 offen offset:1024 sc1
    v_smfmac_f32_16x16x64_bf16 v[188:191], v[164:167], a[80:87], v4
    v_smfmac_f32_16x16x64_bf16 v[192:195], v[104:107], a[112:119], v4
    v_smfmac_f32_16x16x64_bf16 v[196:199], v[124:127], a[112:119], v4
    v_smfmac_f32_16x16x64_bf16 v[200:203], v[144:147], a[112:119], v4
    buffer_load_dwordx4 v[44:47], v240, s[8:11], s64 offen offset:2048 sc1
    v_smfmac_f32_16x16x64_bf16 v[204:207], v[164:167], a[112:119], v4
    v_smfmac_f32_16x16x64_bf16 v[176:179], v[108:111], a[88:95], v4
    v_smfmac_f32_16x16x64_bf16 v[180:183], v[128:131], a[88:95], v4
    v_smfmac_f32_16x16x64_bf16 v[184:187], v[148:151], a[88:95], v4
    buffer_load_dwordx4 v[48:51], v240, s[8:11], s64 offen offset:3072 sc1
    v_smfmac_f32_16x16x64_bf16 v[188:191], v[168:171], a[88:95], v4
    v_smfmac_f32_16x16x64_bf16 v[192:195], v[108:111], a[120:127], v4
    v_smfmac_f32_16x16x64_bf16 v[196:199], v[128:131], a[120:127], v4
    v_smfmac_f32_16x16x64_bf16 v[200:203], v[148:151], a[120:127], v4
    buffer_load_dwordx4 v[52:55], v241, s[8:11], s64 offen sc1
    v_smfmac_f32_16x16x64_bf16 v[204:207], v[168:171], a[120:127], v4
    v_smfmac_f32_16x16x64_bf16 v[176:179], v[112:115], a[144:151], v4
    v_smfmac_f32_16x16x64_bf16 v[180:183], v[132:135], a[144:151], v4
    v_smfmac_f32_16x16x64_bf16 v[184:187], v[152:155], a[144:151], v4
    buffer_load_dwordx4 v[56:59], v240, s[8:11], s65 offen offset:0 sc1
    v_smfmac_f32_16x16x64_bf16 v[188:191], v[172:175], a[144:151], v4
    v_smfmac_f32_16x16x64_bf16 v[192:195], v[112:115], a[152:159], v4
    v_smfmac_f32_16x16x64_bf16 v[196:199], v[132:135], a[152:159], v4
    v_smfmac_f32_16x16x64_bf16 v[200:203], v[152:155], a[152:159], v4
    buffer_load_dwordx4 v[60:63], v240, s[8:11], s65 offen offset:1024 sc1
    v_smfmac_f32_16x16x64_bf16 v[204:207], v[172:175], a[152:159], v4
    s_nop 5
    v_permlane32_swap_b32 v176, v192
    v_permlane32_swap_b32 v177, v193
    v_permlane32_swap_b32 v178, v194
    v_permlane32_swap_b32 v179, v195
    v_add_f32 v176, v176, v192
    v_add_f32 v177, v177, v193
    v_add_f32 v178, v178, v194
    v_add_f32 v179, v179, v195
    ds_write_b128 v12, v[176:179] offset:0
    buffer_load_dwordx4 v[64:67], v240, s[8:11], s65 offen offset:2048 sc1
    v_permlane32_swap_b32 v180, v196
    v_permlane32_swap_b32 v181, v197
    v_permlane32_swap_b32 v182, v198
    v_permlane32_swap_b32 v183, v199
    v_add_f32 v180, v180, v196
    v_add_f32 v181, v181, v197
    v_add_f32 v182, v182, v198
    v_add_f32 v183, v183, v199
    ds_write_b128 v12, v[180:183] offset:4096
    buffer_load_dwordx4 v[68:71], v240, s[8:11], s65 offen offset:3072 sc1
    v_permlane32_swap_b32 v184, v200
    v_permlane32_swap_b32 v185, v201
    v_permlane32_swap_b32 v186, v202
    v_permlane32_swap_b32 v187, v203
    v_add_f32 v184, v184, v200
    v_add_f32 v185, v185, v201
    v_add_f32 v186, v186, v202
    v_add_f32 v187, v187, v203
    ds_write_b128 v12, v[184:187] offset:8192
    buffer_load_dwordx4 v[72:75], v241, s[8:11], s65 offen sc1
    v_permlane32_swap_b32 v188, v204
    v_permlane32_swap_b32 v189, v205
    v_permlane32_swap_b32 v190, v206
    v_permlane32_swap_b32 v191, v207
    v_add_f32 v188, v188, v204
    v_add_f32 v189, v189, v205
    v_add_f32 v190, v190, v206
    v_add_f32 v191, v191, v207
    ds_write_b128 v12, v[188:191] offset:12288
    buffer_load_dwordx4 v[76:79], v240, s[8:11], s66 offen offset:0 sc1
    s_waitcnt lgkmcnt(0)
    s_cmp_lg_u32 s3, 3
    s_cbranch_scc1 c_rsx1
    s_waitcnt vmcnt(16)
    s_mov_b64 exec, 1
    v_cmp_eq_u32 vcc, 19, v230
    v_mov_b32 v230, 0
    s_cbranch_vccz c_rtx1
    buffer_store_dword v231, off, s[8:11], s56 sc1
c_rtx1:
    s_mov_b64 exec, -1
c_rsx1:

    s_barrier

    ds_read_b128 v[208:211], v13 offset:0
    buffer_load_dwordx4 v[80:83], v240, s[8:11], s66 offen offset:1024 sc1
    ds_read_b128 v[212:215], v13 offset:1024
    ds_read_b128 v[216:219], v13 offset:2048
    ds_read_b128 v[220:223], v13 offset:3072
    buffer_load_dwordx4 v[84:87], v240, s[8:11], s66 offen offset:2048 sc1
    s_mul_i32 s74, s57, 40960
    s_lshl_b32 s75, s58, 6
    s_add_u32 s74, s74, s75
    s_add_u32 s74, s74, 0x1400000
    s_lshl_b32 s75, s57, 7
    s_add_u32 s75, s75, 0x1a500
    s_waitcnt lgkmcnt(0)

    v_add_f32 v208, v208, v212
    v_add_f32 v216, v216, v220
    buffer_load_dwordx4 v[88:91], v240, s[8:11], s66 offen offset:3072 sc1
    v_add_f32 v209, v209, v213
    v_add_f32 v217, v217, v221
    v_add_f32 v210, v210, v214
    v_add_f32 v218, v218, v222
    v_add_f32 v211, v211, v215
    v_add_f32 v219, v219, v223
    v_add_f32 v208, v208, v216
    v_add_f32 v209, v209, v217
    v_add_f32 v210, v210, v218
    v_add_f32 v211, v211, v219
    s_nop 0
    v_mov_b32_dpp v216, v208 quad_perm:[1,0,3,2] row_mask:0xf bank_mask:0xf
    v_mov_b32_dpp v217, v209 quad_perm:[1,0,3,2] row_mask:0xf bank_mask:0xf
    v_mov_b32_dpp v218, v210 quad_perm:[1,0,3,2] row_mask:0xf bank_mask:0xf
    buffer_load_dwordx4 v[92:95], v241, s[8:11], s66 offen sc1
    v_mov_b32_dpp v219, v211 quad_perm:[1,0,3,2] row_mask:0xf bank_mask:0xf
    v_cvt_pk_bf16_f32 v208, v208, v216
    v_min_u32 v208, -2, v208
    buffer_store_dword v208, v242, s[8:11], s74 offen offset:0 sc1
    v_cvt_pk_bf16_f32 v209, v209, v217
    v_min_u32 v209, -2, v209
    buffer_store_dword v209, v242, s[8:11], s74 offen offset:1280 sc1
    v_cvt_pk_bf16_f32 v210, v210, v218
    v_min_u32 v210, -2, v210
    buffer_store_dword v210, v242, s[8:11], s74 offen offset:2560 sc1
    v_cvt_pk_bf16_f32 v211, v211, v219
    v_min_u32 v211, -2, v211
    buffer_store_dword v211, v242, s[8:11], s74 offen offset:3840 sc1
    buffer_load_dwordx2 a[128:129], v239, s[8:11], s67 offen offset:0 sc1
    buffer_load_dwordx2 a[136:137], v239, s[8:11], s67 offen offset:256 sc1
    buffer_load_dwordx2 a[130:131], v239, s[8:11], s69 offen offset:0 sc1
    buffer_load_dwordx2 a[138:139], v239, s[8:11], s69 offen offset:256 sc1
    buffer_load_dwordx2 a[132:133], v239, s[8:11], s70 offen offset:0 sc1
    buffer_load_dwordx2 a[140:141], v239, s[8:11], s70 offen offset:256 sc1
    buffer_load_dwordx2 a[134:135], v239, s[8:11], s71 offen offset:0 sc1
    buffer_load_dwordx2 a[142:143], v239, s[8:11], s71 offen offset:256 sc1
    s_mov_b64 exec, 255
    buffer_load_dword v233, v243, s[8:11], s61 offen sc1
    buffer_load_dwordx4 v[224:227], v243, s[8:11], s34 offen sc1
    s_mov_b64 exec, -1
    s_add_u32 s40, s78, 25
    s_cmp_lt_u32 s40, 920
    s_cselect_b32 s40, s40, s76
    s_add_u32 s41, s78, 50
    s_cmp_lt_u32 s78, 920
    s_cselect_b32 s78, s40, s41

    s_mul_i32 s60, s78, 3277
    s_lshr_b32 s60, s60, 16
    s_mul_i32 s40, s60, 20
    s_sub_u32 s63, s78, s40

    s_cmp_ge_u32 s68, 64
    s_cbranch_scc1 cux_125
    s_add_u32 s45, s68, 1
    s_mov_b64 exec, 255
    v_cmp_gt_u32 vcc, s45, v232
    s_mov_b64 exec, -1
    s_cbranch_vccz cux_124

wa_127:
    s_mov_b32 exec_lo, 0xff
    s_mov_b32 exec_hi, 0
    buffer_load_dword v232, v243, s[8:11], s62 offen sc1
    s_waitcnt vmcnt(0)

    v_cmp_gt_u32 vcc, s45, v232
    s_mov_b64 exec, -1
    s_cbranch_vccz wad_128
    s_sub_u32 s30, s30, 1
    s_cmp_lt_i32 s30, 0
    s_cbranch_scc1 wad_128
    s_sleep 4
    s_branch wa_127

wad_128:
cux_124:
    s_mul_i32 s33, s68, 1310720
    s_lshl_b32 s40, s72, 11
    s_add_u32 s33, s33, s40
    s_add_u32 s33, s33, s73

    buffer_load_dwordx4 a[64:67], v5, s[8:11], s33 offen offset:0 sc1
    buffer_load_dwordx4 a[96:99], v5, s[8:11], s33 offen offset:1024 sc1
    s_add_u32 s33, s33, 40960
    buffer_load_dwordx4 a[68:71], v5, s[8:11], s33 offen offset:0 sc1
    buffer_load_dwordx4 a[100:103], v5, s[8:11], s33 offen offset:1024 sc1
    s_add_u32 s33, s33, 40960
    buffer_load_dwordx4 a[72:75], v5, s[8:11], s33 offen offset:0 sc1
    buffer_load_dwordx4 a[104:107], v5, s[8:11], s33 offen offset:1024 sc1
    s_add_u32 s33, s33, 40960
    buffer_load_dwordx4 a[76:79], v5, s[8:11], s33 offen offset:0 sc1
    buffer_load_dwordx4 a[108:111], v5, s[8:11], s33 offen offset:1024 sc1
    s_add_u32 s33, s33, 40960
    buffer_load_dwordx4 a[80:83], v5, s[8:11], s33 offen offset:0 sc1
    buffer_load_dwordx4 a[112:115], v5, s[8:11], s33 offen offset:1024 sc1
    s_add_u32 s33, s33, 40960
    buffer_load_dwordx4 a[84:87], v5, s[8:11], s33 offen offset:0 sc1
    buffer_load_dwordx4 a[116:119], v5, s[8:11], s33 offen offset:1024 sc1
    s_add_u32 s33, s33, 40960
    buffer_load_dwordx4 a[88:91], v5, s[8:11], s33 offen offset:0 sc1
    buffer_load_dwordx4 a[120:123], v5, s[8:11], s33 offen offset:1024 sc1
    s_add_u32 s33, s33, 40960
    buffer_load_dwordx4 a[92:95], v5, s[8:11], s33 offen offset:0 sc1
    buffer_load_dwordx4 a[124:127], v5, s[8:11], s33 offen offset:1024 sc1
    s_add_u32 s33, s33, 40960
    s_waitcnt vmcnt(16)
    s_branch cux_126
cux_125:
    s_waitcnt vmcnt(0)
cux_126:
    s_add_u32 s40, s79, 25
    s_cmp_lt_u32 s40, 920
    s_cselect_b32 s40, s40, s76
    s_add_u32 s41, s79, 50
    s_cmp_lt_u32 s79, 920
    s_cselect_b32 s79, s40, s41

    s_mul_i32 s68, s79, 3277
    s_lshr_b32 s68, s68, 16
    s_mul_i32 s40, s68, 20
    s_sub_u32 s72, s79, s40

    s_barrier
    s_cmp_lg_u32 s3, 3
    s_cbranch_scc1 c_nfa1
    s_lshl_b32 s40, s57, 2
    s_add_u32 s40, s40, 0x1c800
    s_mov_b32 s56, s75
    v_mov_b32 v230, 1
    s_mov_b64 exec, 1
    buffer_atomic_add v230, off, s[8:11], s40 sc0

    s_mov_b64 exec, -1
c_nfa1:

    s_branch cjn_122
cpl_121:
    v_mov_b32 v176, 0
    v_mov_b32 v177, 0
    v_mov_b32 v178, 0
    v_mov_b32 v179, 0
    v_mov_b32 v180, 0
    v_mov_b32 v181, 0
    v_mov_b32 v182, 0
    v_mov_b32 v183, 0
    v_mov_b32 v184, 0
    v_mov_b32 v185, 0
    v_mov_b32 v186, 0
    v_mov_b32 v187, 0
    v_mov_b32 v188, 0
    v_mov_b32 v189, 0
    v_mov_b32 v190, 0
    v_mov_b32 v191, 0
    v_mov_b32 v192, 0
    v_mov_b32 v193, 0
    v_mov_b32 v194, 0
    v_mov_b32 v195, 0
    v_mov_b32 v196, 0
    v_mov_b32 v197, 0
    v_mov_b32 v198, 0
    v_mov_b32 v199, 0
    v_mov_b32 v200, 0
    v_mov_b32 v201, 0
    v_mov_b32 v202, 0
    v_mov_b32 v203, 0
    v_mov_b32 v204, 0
    v_mov_b32 v205, 0
    v_mov_b32 v206, 0
    v_mov_b32 v207, 0
    s_nop 0
    v_smfmac_f32_16x16x64_bf16 v[176:179], v[96:99], a[64:71], v4
    v_smfmac_f32_16x16x64_bf16 v[180:183], v[116:119], a[64:71], v4
    v_smfmac_f32_16x16x64_bf16 v[184:187], v[136:139], a[64:71], v4
    v_smfmac_f32_16x16x64_bf16 v[188:191], v[156:159], a[64:71], v4
    v_smfmac_f32_16x16x64_bf16 v[192:195], v[96:99], a[96:103], v4
    v_smfmac_f32_16x16x64_bf16 v[196:199], v[116:119], a[96:103], v4
    v_smfmac_f32_16x16x64_bf16 v[200:203], v[136:139], a[96:103], v4
    v_smfmac_f32_16x16x64_bf16 v[204:207], v[156:159], a[96:103], v4
    v_smfmac_f32_16x16x64_bf16 v[176:179], v[100:103], a[72:79], v4
    v_smfmac_f32_16x16x64_bf16 v[180:183], v[120:123], a[72:79], v4
    v_smfmac_f32_16x16x64_bf16 v[184:187], v[140:143], a[72:79], v4
    v_smfmac_f32_16x16x64_bf16 v[188:191], v[160:163], a[72:79], v4
    v_smfmac_f32_16x16x64_bf16 v[192:195], v[100:103], a[104:111], v4
    v_smfmac_f32_16x16x64_bf16 v[196:199], v[120:123], a[104:111], v4
    v_smfmac_f32_16x16x64_bf16 v[200:203], v[140:143], a[104:111], v4
    v_smfmac_f32_16x16x64_bf16 v[204:207], v[160:163], a[104:111], v4
    v_smfmac_f32_16x16x64_bf16 v[176:179], v[104:107], a[80:87], v4
    v_smfmac_f32_16x16x64_bf16 v[180:183], v[124:127], a[80:87], v4
    v_smfmac_f32_16x16x64_bf16 v[184:187], v[144:147], a[80:87], v4
    v_smfmac_f32_16x16x64_bf16 v[188:191], v[164:167], a[80:87], v4
    v_smfmac_f32_16x16x64_bf16 v[192:195], v[104:107], a[112:119], v4
    v_smfmac_f32_16x16x64_bf16 v[196:199], v[124:127], a[112:119], v4
    v_smfmac_f32_16x16x64_bf16 v[200:203], v[144:147], a[112:119], v4
    v_smfmac_f32_16x16x64_bf16 v[204:207], v[164:167], a[112:119], v4
    v_smfmac_f32_16x16x64_bf16 v[176:179], v[108:111], a[88:95], v4
    v_smfmac_f32_16x16x64_bf16 v[180:183], v[128:131], a[88:95], v4
    v_smfmac_f32_16x16x64_bf16 v[184:187], v[148:151], a[88:95], v4
    v_smfmac_f32_16x16x64_bf16 v[188:191], v[168:171], a[88:95], v4
    v_smfmac_f32_16x16x64_bf16 v[192:195], v[108:111], a[120:127], v4
    v_smfmac_f32_16x16x64_bf16 v[196:199], v[128:131], a[120:127], v4
    v_smfmac_f32_16x16x64_bf16 v[200:203], v[148:151], a[120:127], v4
    v_smfmac_f32_16x16x64_bf16 v[204:207], v[168:171], a[120:127], v4
    v_smfmac_f32_16x16x64_bf16 v[176:179], v[112:115], a[144:151], v4
    v_smfmac_f32_16x16x64_bf16 v[180:183], v[132:135], a[144:151], v4
    v_smfmac_f32_16x16x64_bf16 v[184:187], v[152:155], a[144:151], v4
    v_smfmac_f32_16x16x64_bf16 v[188:191], v[172:175], a[144:151], v4
    v_smfmac_f32_16x16x64_bf16 v[192:195], v[112:115], a[152:159], v4
    v_smfmac_f32_16x16x64_bf16 v[196:199], v[132:135], a[152:159], v4
    v_smfmac_f32_16x16x64_bf16 v[200:203], v[152:155], a[152:159], v4
    v_smfmac_f32_16x16x64_bf16 v[204:207], v[172:175], a[152:159], v4
    s_nop 5
    v_permlane32_swap_b32 v176, v192
    v_permlane32_swap_b32 v177, v193
    v_permlane32_swap_b32 v178, v194
    v_permlane32_swap_b32 v179, v195
    v_add_f32 v176, v176, v192
    v_add_f32 v177, v177, v193
    v_add_f32 v178, v178, v194
    v_add_f32 v179, v179, v195
    ds_write_b128 v12, v[176:179] offset:0
    v_permlane32_swap_b32 v180, v196
    v_permlane32_swap_b32 v181, v197
    v_permlane32_swap_b32 v182, v198
    v_permlane32_swap_b32 v183, v199
    v_add_f32 v180, v180, v196
    v_add_f32 v181, v181, v197
    v_add_f32 v182, v182, v198
    v_add_f32 v183, v183, v199
    ds_write_b128 v12, v[180:183] offset:4096
    v_permlane32_swap_b32 v184, v200
    v_permlane32_swap_b32 v185, v201
    v_permlane32_swap_b32 v186, v202
    v_permlane32_swap_b32 v187, v203
    v_add_f32 v184, v184, v200
    v_add_f32 v185, v185, v201
    v_add_f32 v186, v186, v202
    v_add_f32 v187, v187, v203
    ds_write_b128 v12, v[184:187] offset:8192
    v_permlane32_swap_b32 v188, v204
    v_permlane32_swap_b32 v189, v205
    v_permlane32_swap_b32 v190, v206
    v_permlane32_swap_b32 v191, v207
    v_add_f32 v188, v188, v204
    v_add_f32 v189, v189, v205
    v_add_f32 v190, v190, v206
    v_add_f32 v191, v191, v207
    ds_write_b128 v12, v[188:191] offset:12288
    s_waitcnt lgkmcnt(0)
    s_cmp_lg_u32 s3, 3
    s_cbranch_scc1 c_rsy1
    s_waitcnt vmcnt(0)
    s_mov_b64 exec, 1
    v_cmp_eq_u32 vcc, 19, v230
    v_mov_b32 v230, 0
    s_cbranch_vccz c_rty1
    buffer_store_dword v231, off, s[8:11], s56 sc1
c_rty1:
    s_mov_b64 exec, -1
c_rsy1:

    s_barrier

    ds_read_b128 v[208:211], v13 offset:0
    ds_read_b128 v[212:215], v13 offset:1024
    ds_read_b128 v[216:219], v13 offset:2048
    ds_read_b128 v[220:223], v13 offset:3072
    s_mul_i32 s74, s57, 40960
    s_lshl_b32 s75, s58, 6
    s_add_u32 s74, s74, s75
    s_add_u32 s74, s74, 0x1400000
    s_lshl_b32 s75, s57, 7
    s_add_u32 s75, s75, 0x1a500
    s_waitcnt lgkmcnt(0)

    v_add_f32 v208, v208, v212
    v_add_f32 v216, v216, v220
    v_add_f32 v209, v209, v213
    v_add_f32 v217, v217, v221
    v_add_f32 v210, v210, v214
    v_add_f32 v218, v218, v222
    v_add_f32 v211, v211, v215
    v_add_f32 v219, v219, v223
    v_add_f32 v208, v208, v216
    v_add_f32 v209, v209, v217
    v_add_f32 v210, v210, v218
    v_add_f32 v211, v211, v219
    s_nop 0
    v_mov_b32_dpp v216, v208 quad_perm:[1,0,3,2] row_mask:0xf bank_mask:0xf
    v_mov_b32_dpp v217, v209 quad_perm:[1,0,3,2] row_mask:0xf bank_mask:0xf
    v_mov_b32_dpp v218, v210 quad_perm:[1,0,3,2] row_mask:0xf bank_mask:0xf
    v_mov_b32_dpp v219, v211 quad_perm:[1,0,3,2] row_mask:0xf bank_mask:0xf
    v_cvt_pk_bf16_f32 v208, v208, v216
    v_min_u32 v208, -2, v208
    buffer_store_dword v208, v242, s[8:11], s74 offen offset:0 sc1
    v_cvt_pk_bf16_f32 v209, v209, v217
    v_min_u32 v209, -2, v209
    buffer_store_dword v209, v242, s[8:11], s74 offen offset:1280 sc1
    v_cvt_pk_bf16_f32 v210, v210, v218
    v_min_u32 v210, -2, v210
    buffer_store_dword v210, v242, s[8:11], s74 offen offset:2560 sc1
    v_cvt_pk_bf16_f32 v211, v211, v219
    v_min_u32 v211, -2, v211
    buffer_store_dword v211, v242, s[8:11], s74 offen offset:3840 sc1
    s_mov_b64 exec, 255
    buffer_load_dword v233, v243, s[8:11], s61 offen sc1
    buffer_load_dwordx4 v[224:227], v243, s[8:11], s34 offen sc1
    s_mov_b64 exec, -1
    s_waitcnt vmcnt(0)
    s_barrier
    s_cmp_lg_u32 s3, 3
    s_cbranch_scc1 c_nfb1
    s_lshl_b32 s40, s57, 2
    s_add_u32 s40, s40, 0x1c800
    s_mov_b32 s56, s75
    v_mov_b32 v230, 1
    s_mov_b64 exec, 1
    buffer_atomic_add v230, off, s[8:11], s40 sc0

    s_mov_b64 exec, -1
c_nfb1:

    v_min3_u32 v234, v233, v224, v225
    v_min3_u32 v234, v234, v226, v227
    s_mov_b64 exec, 255
    v_cmp_gt_u32 vcc, s44, v234
    s_mov_b64 exec, -1
    s_cbranch_vccnz csl_129

    s_cmp_ge_u32 s60, 56
    s_cbranch_scc1 csl_129
    s_mov_b32 s59, 1

    s_mul_i32 s32, s60, 81920
    s_add_u32 s32, s32, 0x800000
    s_add_u32 s64, s32, 20480
    s_add_u32 s65, s32, 40960
    s_add_u32 s66, s32, 61440
    s_mul_i32 s67, s60, 327680
    s_lshl_b32 s40, s63, 9
    s_add_u32 s67, s67, s40
    s_add_u32 s67, s67, 0x6800000
    s_add_u32 s69, s67, 20480
    s_add_u32 s70, s67, 40960
    s_add_u32 s71, s67, 61440

    buffer_load_dwordx4 v[16:19], v240, s[8:11], s32 offen offset:0 sc1
    buffer_load_dwordx4 v[20:23], v240, s[8:11], s32 offen offset:1024 sc1
    buffer_load_dwordx4 v[24:27], v240, s[8:11], s32 offen offset:2048 sc1
    buffer_load_dwordx4 v[28:31], v240, s[8:11], s32 offen offset:3072 sc1
    buffer_load_dwordx4 v[32:35], v241, s[8:11], s32 offen sc1
    buffer_load_dwordx4 v[36:39], v240, s[8:11], s64 offen offset:0 sc1
    buffer_load_dwordx4 v[40:43], v240, s[8:11], s64 offen offset:1024 sc1
    buffer_load_dwordx4 v[44:47], v240, s[8:11], s64 offen offset:2048 sc1
    buffer_load_dwordx4 v[48:51], v240, s[8:11], s64 offen offset:3072 sc1
    buffer_load_dwordx4 v[52:55], v241, s[8:11], s64 offen sc1
    buffer_load_dwordx4 v[56:59], v240, s[8:11], s65 offen offset:0 sc1
    buffer_load_dwordx4 v[60:63], v240, s[8:11], s65 offen offset:1024 sc1
    buffer_load_dwordx4 v[64:67], v240, s[8:11], s65 offen offset:2048 sc1
    buffer_load_dwordx4 v[68:71], v240, s[8:11], s65 offen offset:3072 sc1
    buffer_load_dwordx4 v[72:75], v241, s[8:11], s65 offen sc1
    buffer_load_dwordx4 v[76:79], v240, s[8:11], s66 offen offset:0 sc1
    buffer_load_dwordx4 v[80:83], v240, s[8:11], s66 offen offset:1024 sc1
    buffer_load_dwordx4 v[84:87], v240, s[8:11], s66 offen offset:2048 sc1
    buffer_load_dwordx4 v[88:91], v240, s[8:11], s66 offen offset:3072 sc1
    buffer_load_dwordx4 v[92:95], v241, s[8:11], s66 offen sc1
    buffer_load_dwordx2 a[128:129], v239, s[8:11], s67 offen offset:0 sc1
    buffer_load_dwordx2 a[136:137], v239, s[8:11], s67 offen offset:256 sc1
    buffer_load_dwordx2 a[130:131], v239, s[8:11], s69 offen offset:0 sc1
    buffer_load_dwordx2 a[138:139], v239, s[8:11], s69 offen offset:256 sc1
    buffer_load_dwordx2 a[132:133], v239, s[8:11], s70 offen offset:0 sc1
    buffer_load_dwordx2 a[140:141], v239, s[8:11], s70 offen offset:256 sc1
    buffer_load_dwordx2 a[134:135], v239, s[8:11], s71 offen offset:0 sc1
    buffer_load_dwordx2 a[142:143], v239, s[8:11], s71 offen offset:256 sc1
    s_cmp_lg_u32 s3, 3
    s_cbranch_scc1 c_qf1
    s_waitcnt vmcnt(28)
    s_mov_b64 exec, 1
    v_cmp_eq_u32 vcc, 19, v230
    v_mov_b32 v230, 0
    s_cbranch_vccz c_pf1
    buffer_store_dword v231, off, s[8:11], s56 sc1
c_pf1:
    s_mov_b64 exec, -1
c_qf1:

    s_mov_b64 exec, 255
    buffer_load_dword v233, v243, s[8:11], s61 offen sc1
    buffer_load_dwordx4 v[224:227], v243, s[8:11], s34 offen sc1
    s_mov_b64 exec, -1
    s_add_u32 s40, s78, 25
    s_cmp_lt_u32 s40, 920
    s_cselect_b32 s40, s40, s76
    s_add_u32 s41, s78, 50
    s_cmp_lt_u32 s78, 920
    s_cselect_b32 s78, s40, s41

    s_mul_i32 s60, s78, 3277
    s_lshr_b32 s60, s60, 16
    s_mul_i32 s40, s60, 20
    s_sub_u32 s63, s78, s40

    s_cmp_ge_u32 s68, 64
    s_cbranch_scc1 cux_131
    s_add_u32 s45, s68, 1
    s_mov_b64 exec, 255
    v_cmp_gt_u32 vcc, s45, v232
    s_mov_b64 exec, -1
    s_cbranch_vccz cux_130

wa_133:
    s_mov_b32 exec_lo, 0xff
    s_mov_b32 exec_hi, 0
    buffer_load_dword v232, v243, s[8:11], s62 offen sc1
    s_waitcnt vmcnt(0)

    v_cmp_gt_u32 vcc, s45, v232
    s_mov_b64 exec, -1
    s_cbranch_vccz wad_134
    s_sub_u32 s30, s30, 1
    s_cmp_lt_i32 s30, 0
    s_cbranch_scc1 wad_134
    s_sleep 4
    s_branch wa_133

wad_134:
cux_130:
    s_mul_i32 s33, s68, 1310720
    s_lshl_b32 s40, s72, 11
    s_add_u32 s33, s33, s40
    s_add_u32 s33, s33, s73

    buffer_load_dwordx4 a[64:67], v5, s[8:11], s33 offen offset:0 sc1
    buffer_load_dwordx4 a[96:99], v5, s[8:11], s33 offen offset:1024 sc1
    s_add_u32 s33, s33, 40960
    buffer_load_dwordx4 a[68:71], v5, s[8:11], s33 offen offset:0 sc1
    buffer_load_dwordx4 a[100:103], v5, s[8:11], s33 offen offset:1024 sc1
    s_add_u32 s33, s33, 40960
    buffer_load_dwordx4 a[72:75], v5, s[8:11], s33 offen offset:0 sc1
    buffer_load_dwordx4 a[104:107], v5, s[8:11], s33 offen offset:1024 sc1
    s_add_u32 s33, s33, 40960
    buffer_load_dwordx4 a[76:79], v5, s[8:11], s33 offen offset:0 sc1
    buffer_load_dwordx4 a[108:111], v5, s[8:11], s33 offen offset:1024 sc1
    s_add_u32 s33, s33, 40960
    buffer_load_dwordx4 a[80:83], v5, s[8:11], s33 offen offset:0 sc1
    buffer_load_dwordx4 a[112:115], v5, s[8:11], s33 offen offset:1024 sc1
    s_add_u32 s33, s33, 40960
    buffer_load_dwordx4 a[84:87], v5, s[8:11], s33 offen offset:0 sc1
    buffer_load_dwordx4 a[116:119], v5, s[8:11], s33 offen offset:1024 sc1
    s_add_u32 s33, s33, 40960
    buffer_load_dwordx4 a[88:91], v5, s[8:11], s33 offen offset:0 sc1
    buffer_load_dwordx4 a[120:123], v5, s[8:11], s33 offen offset:1024 sc1
    s_add_u32 s33, s33, 40960
    buffer_load_dwordx4 a[92:95], v5, s[8:11], s33 offen offset:0 sc1
    buffer_load_dwordx4 a[124:127], v5, s[8:11], s33 offen offset:1024 sc1
    s_add_u32 s33, s33, 40960
    s_waitcnt vmcnt(16)
    s_branch cux_132
cux_131:
    s_waitcnt vmcnt(0)
cux_132:
    s_add_u32 s40, s79, 25
    s_cmp_lt_u32 s40, 920
    s_cselect_b32 s40, s40, s76
    s_add_u32 s41, s79, 50
    s_cmp_lt_u32 s79, 920
    s_cselect_b32 s79, s40, s41

    s_mul_i32 s68, s79, 3277
    s_lshr_b32 s68, s68, 16
    s_mul_i32 s40, s68, 20
    s_sub_u32 s72, s79, s40

    s_branch cjn_122
csl_129:
    s_cmp_lg_u32 s3, 3
    s_cbranch_scc1 c_qs1
    s_waitcnt vmcnt(0)
    s_mov_b64 exec, 1
    v_cmp_eq_u32 vcc, 19, v230
    v_mov_b32 v230, 0
    s_cbranch_vccz c_ps1
    buffer_store_dword v231, off, s[8:11], s56 sc1
c_ps1:
    s_mov_b64 exec, -1
c_qs1:

    s_cmp_ge_u32 s68, 64
    s_cbranch_scc1 cux_136
    s_add_u32 s45, s68, 1
    s_mov_b64 exec, 255
    v_cmp_gt_u32 vcc, s45, v232
    s_mov_b64 exec, -1
    s_cbranch_vccz cux_135

wa_138:
    s_mov_b32 exec_lo, 0xff
    s_mov_b32 exec_hi, 0
    buffer_load_dword v232, v243, s[8:11], s62 offen sc1
    s_waitcnt vmcnt(0)

    v_cmp_gt_u32 vcc, s45, v232
    s_mov_b64 exec, -1
    s_cbranch_vccz wad_139
    s_sub_u32 s30, s30, 1
    s_cmp_lt_i32 s30, 0
    s_cbranch_scc1 wad_139
    s_sleep 4
    s_branch wa_138

wad_139:
cux_135:
    s_mul_i32 s33, s68, 1310720
    s_lshl_b32 s40, s72, 11
    s_add_u32 s33, s33, s40
    s_add_u32 s33, s33, s73

    buffer_load_dwordx4 a[64:67], v5, s[8:11], s33 offen offset:0 sc1
    buffer_load_dwordx4 a[96:99], v5, s[8:11], s33 offen offset:1024 sc1
    s_add_u32 s33, s33, 40960
    buffer_load_dwordx4 a[68:71], v5, s[8:11], s33 offen offset:0 sc1
    buffer_load_dwordx4 a[100:103], v5, s[8:11], s33 offen offset:1024 sc1
    s_add_u32 s33, s33, 40960
    buffer_load_dwordx4 a[72:75], v5, s[8:11], s33 offen offset:0 sc1
    buffer_load_dwordx4 a[104:107], v5, s[8:11], s33 offen offset:1024 sc1
    s_add_u32 s33, s33, 40960
    buffer_load_dwordx4 a[76:79], v5, s[8:11], s33 offen offset:0 sc1
    buffer_load_dwordx4 a[108:111], v5, s[8:11], s33 offen offset:1024 sc1
    s_add_u32 s33, s33, 40960
    buffer_load_dwordx4 a[80:83], v5, s[8:11], s33 offen offset:0 sc1
    buffer_load_dwordx4 a[112:115], v5, s[8:11], s33 offen offset:1024 sc1
    s_add_u32 s33, s33, 40960
    buffer_load_dwordx4 a[84:87], v5, s[8:11], s33 offen offset:0 sc1
    buffer_load_dwordx4 a[116:119], v5, s[8:11], s33 offen offset:1024 sc1
    s_add_u32 s33, s33, 40960
    buffer_load_dwordx4 a[88:91], v5, s[8:11], s33 offen offset:0 sc1
    buffer_load_dwordx4 a[120:123], v5, s[8:11], s33 offen offset:1024 sc1
    s_add_u32 s33, s33, 40960
    buffer_load_dwordx4 a[92:95], v5, s[8:11], s33 offen offset:0 sc1
    buffer_load_dwordx4 a[124:127], v5, s[8:11], s33 offen offset:1024 sc1
    s_add_u32 s33, s33, 40960
cux_136:
cux_137:
    s_add_u32 s40, s79, 25
    s_cmp_lt_u32 s40, 920
    s_cselect_b32 s40, s40, s76
    s_add_u32 s41, s79, 50
    s_cmp_lt_u32 s79, 920
    s_cselect_b32 s79, s40, s41

    s_mul_i32 s68, s79, 3277
    s_lshr_b32 s68, s68, 16
    s_mul_i32 s40, s68, 20
    s_sub_u32 s72, s79, s40

cjn_122:
    s_add_u32 s40, s77, 25
    s_cmp_lt_u32 s40, 920
    s_cselect_b32 s40, s40, s76
    s_add_u32 s41, s77, 50
    s_cmp_lt_u32 s77, 920
    s_cselect_b32 s77, s40, s41

    s_mul_i32 s57, s77, 3277
    s_lshr_b32 s57, s57, 16
    s_mul_i32 s40, s57, 20
    s_sub_u32 s58, s77, s40

    s_add_u32 s29, s29, 1
    s_cmp_ge_u32 s57, 64
    s_cbranch_scc1 r_end
    s_cmp_eq_u32 s59, 1
    s_cbranch_scc1 cnb_123

    s_add_u32 s44, s60, 1
cb_140:
    s_mov_b64 exec, 255
    buffer_load_dword v233, v243, s[8:11], s61 offen sc1
    buffer_load_dwordx4 v[224:227], v243, s[8:11], s34 offen sc1
    s_mov_b64 exec, -1

    s_waitcnt vmcnt(0)
    s_cmp_lt_u32 s60, 56
    s_cbranch_scc1 cb_143
    v_mov_b32 v233, 64
cb_143:

    v_min3_u32 v234, v233, v224, v225
    v_min3_u32 v234, v234, v226, v227
    s_mov_b64 exec, 255
    v_cmp_gt_u32 vcc, s44, v234
    s_mov_b64 exec, -1
    s_cbranch_vccnz cb_141

    s_branch cb_142
cb_141:
    s_sub_u32 s30, s30, 1
    s_cmp_lt_i32 s30, 0
    s_cbranch_scc1 cb_142
    s_sleep 3
    s_branch cb_140

cb_142:
    s_mul_i32 s32, s60, 81920
    s_add_u32 s32, s32, 0x800000
    s_add_u32 s64, s32, 20480
    s_add_u32 s65, s32, 40960
    s_add_u32 s66, s32, 61440
    s_mul_i32 s67, s60, 327680
    s_lshl_b32 s40, s63, 9
    s_add_u32 s67, s67, s40
    s_add_u32 s67, s67, 0x6800000
    s_add_u32 s69, s67, 20480
    s_add_u32 s70, s67, 40960
    s_add_u32 s71, s67, 61440

cbl_144:
    buffer_load_dwordx4 v[16:19], v240, s[8:11], s32 offen offset:0 sc1
    buffer_load_dwordx4 v[20:23], v240, s[8:11], s32 offen offset:1024 sc1
    buffer_load_dwordx4 v[24:27], v240, s[8:11], s32 offen offset:2048 sc1
    buffer_load_dwordx4 v[28:31], v240, s[8:11], s32 offen offset:3072 sc1
    buffer_load_dwordx4 v[32:35], v241, s[8:11], s32 offen sc1
    buffer_load_dwordx4 v[36:39], v240, s[8:11], s64 offen offset:0 sc1
    buffer_load_dwordx4 v[40:43], v240, s[8:11], s64 offen offset:1024 sc1
    buffer_load_dwordx4 v[44:47], v240, s[8:11], s64 offen offset:2048 sc1
    buffer_load_dwordx4 v[48:51], v240, s[8:11], s64 offen offset:3072 sc1
    buffer_load_dwordx4 v[52:55], v241, s[8:11], s64 offen sc1
    buffer_load_dwordx4 v[56:59], v240, s[8:11], s65 offen offset:0 sc1
    buffer_load_dwordx4 v[60:63], v240, s[8:11], s65 offen offset:1024 sc1
    buffer_load_dwordx4 v[64:67], v240, s[8:11], s65 offen offset:2048 sc1
    buffer_load_dwordx4 v[68:71], v240, s[8:11], s65 offen offset:3072 sc1
    buffer_load_dwordx4 v[72:75], v241, s[8:11], s65 offen sc1
    buffer_load_dwordx4 v[76:79], v240, s[8:11], s66 offen offset:0 sc1
    buffer_load_dwordx4 v[80:83], v240, s[8:11], s66 offen offset:1024 sc1
    buffer_load_dwordx4 v[84:87], v240, s[8:11], s66 offen offset:2048 sc1
    buffer_load_dwordx4 v[88:91], v240, s[8:11], s66 offen offset:3072 sc1
    buffer_load_dwordx4 v[92:95], v241, s[8:11], s66 offen sc1
    buffer_load_dwordx2 a[128:129], v239, s[8:11], s67 offen offset:0 sc1
    buffer_load_dwordx2 a[136:137], v239, s[8:11], s67 offen offset:256 sc1
    buffer_load_dwordx2 a[130:131], v239, s[8:11], s69 offen offset:0 sc1
    buffer_load_dwordx2 a[138:139], v239, s[8:11], s69 offen offset:256 sc1
    buffer_load_dwordx2 a[132:133], v239, s[8:11], s70 offen offset:0 sc1
    buffer_load_dwordx2 a[140:141], v239, s[8:11], s70 offen offset:256 sc1
    buffer_load_dwordx2 a[134:135], v239, s[8:11], s71 offen offset:0 sc1
    buffer_load_dwordx2 a[142:143], v239, s[8:11], s71 offen offset:256 sc1
    s_mov_b64 exec, 255
    buffer_load_dword v233, v243, s[8:11], s61 offen sc1
    buffer_load_dwordx4 v[224:227], v243, s[8:11], s34 offen sc1
    s_mov_b64 exec, -1

    s_waitcnt vmcnt(0)
    v_max3_u32 v3, v16, v17, v18
    v_max3_u32 v3, v3, v19, v20
    v_max3_u32 v3, v3, v21, v22
    v_max3_u32 v3, v3, v23, v24
    v_max3_u32 v3, v3, v25, v26
    v_max3_u32 v3, v3, v27, v28
    v_max3_u32 v3, v3, v29, v30
    v_max3_u32 v3, v3, v31, v32
    v_max3_u32 v3, v3, v33, v34
    v_max3_u32 v3, v3, v35, v36
    v_max3_u32 v3, v3, v37, v38
    v_max3_u32 v3, v3, v39, v40
    v_max3_u32 v3, v3, v41, v42
    v_max3_u32 v3, v3, v43, v44
    v_max3_u32 v3, v3, v45, v46
    v_max3_u32 v3, v3, v47, v48
    v_max3_u32 v3, v3, v49, v50
    v_max3_u32 v3, v3, v51, v52
    v_max3_u32 v3, v3, v53, v54
    v_max3_u32 v3, v3, v55, v56
    v_max3_u32 v3, v3, v57, v58
    v_max3_u32 v3, v3, v59, v60
    v_max3_u32 v3, v3, v61, v62
    v_max3_u32 v3, v3, v63, v64
    v_max3_u32 v3, v3, v65, v66
    v_max3_u32 v3, v3, v67, v68
    v_max3_u32 v3, v3, v69, v70
    v_max3_u32 v3, v3, v71, v72
    v_max3_u32 v3, v3, v73, v74
    v_max3_u32 v3, v3, v75, v76
    v_max3_u32 v3, v3, v77, v78
    v_max3_u32 v3, v3, v79, v80
    v_max3_u32 v3, v3, v81, v82
    v_max3_u32 v3, v3, v83, v84
    v_max3_u32 v3, v3, v85, v86
    v_max3_u32 v3, v3, v87, v88
    v_max3_u32 v3, v3, v89, v90
    v_max3_u32 v3, v3, v91, v92
    v_max3_u32 v3, v3, v93, v94
    v_max_u32 v3, v3, v95
    v_cmp_eq_u32 vcc, -1, v3
    s_cbranch_vccz pok_145
    s_sub_u32 s30, s30, 1
    s_cmp_lt_i32 s30, 0
    s_cbranch_scc1 pok_145
    s_sleep 4
    s_branch cbl_144

pok_145:
    s_add_u32 s40, s78, 25
    s_cmp_lt_u32 s40, 920
    s_cselect_b32 s40, s40, s76
    s_add_u32 s41, s78, 50
    s_cmp_lt_u32 s78, 920
    s_cselect_b32 s78, s40, s41

    s_mul_i32 s60, s78, 3277
    s_lshr_b32 s60, s60, 16
    s_mul_i32 s40, s60, 20
    s_sub_u32 s63, s78, s40

cnb_123:
    s_branch c_loop
pre_boot:
    v_mov_b32 v134, -1
    s_sub_u32 s40, s28, 102
    s_lshl_b32 s40, s40, 21
    s_add_u32 s40, s40, 0x61f0000
    s_lshl_b32 s41, s3, 14
    s_add_u32 s40, s40, s41
    s_mov_b32 s42, -1
    s_mov_b32 s43, -1
    s_mov_b64 exec, 1

    s_add_u32 s41, s40, 0
    s_memtime s[44:45]
    s_waitcnt lgkmcnt(0)
    buffer_store_dword v134, off, s[8:11], s41 sc1
    s_waitcnt vmcnt(0)
    buffer_load_dword v135, off, s[8:11], s41 sc1
    s_waitcnt vmcnt(0)
    s_memtime s[46:47]
    s_waitcnt lgkmcnt(0)
    s_sub_u32 s46, s46, s44
    s_min_u32 s42, s42, s46

    s_add_u32 s41, s40, 8192
    s_memtime s[44:45]
    s_waitcnt lgkmcnt(0)
    buffer_store_dword v134, off, s[8:11], s41 sc1
    s_waitcnt vmcnt(0)
    buffer_load_dword v135, off, s[8:11], s41 sc1
    s_waitcnt vmcnt(0)
    s_memtime s[46:47]
    s_waitcnt lgkmcnt(0)
    s_sub_u32 s46, s46, s44
    s_min_u32 s43, s43, s46

    s_add_u32 s41, s40, 5248
    s_memtime s[44:45]
    s_waitcnt lgkmcnt(0)
    buffer_store_dword v134, off, s[8:11], s41 sc1
    s_waitcnt vmcnt(0)
    buffer_load_dword v135, off, s[8:11], s41 sc1
    s_waitcnt vmcnt(0)
    s_memtime s[46:47]
    s_waitcnt lgkmcnt(0)
    s_sub_u32 s46, s46, s44
    s_min_u32 s42, s42, s46

    s_add_u32 s41, s40, 13440
    s_memtime s[44:45]
    s_waitcnt lgkmcnt(0)
    buffer_store_dword v134, off, s[8:11], s41 sc1
    s_waitcnt vmcnt(0)
    buffer_load_dword v135, off, s[8:11], s41 sc1
    s_waitcnt vmcnt(0)
    s_memtime s[46:47]
    s_waitcnt lgkmcnt(0)
    s_sub_u32 s46, s46, s44
    s_min_u32 s43, s43, s46

    s_add_u32 s41, s40, 2304
    s_memtime s[44:45]
    s_waitcnt lgkmcnt(0)
    buffer_store_dword v134, off, s[8:11], s41 sc1
    s_waitcnt vmcnt(0)
    buffer_load_dword v135, off, s[8:11], s41 sc1
    s_waitcnt vmcnt(0)
    s_memtime s[46:47]
    s_waitcnt lgkmcnt(0)
    s_sub_u32 s46, s46, s44
    s_min_u32 s42, s42, s46

    s_add_u32 s41, s40, 10496
    s_memtime s[44:45]
    s_waitcnt lgkmcnt(0)
    buffer_store_dword v134, off, s[8:11], s41 sc1
    s_waitcnt vmcnt(0)
    buffer_load_dword v135, off, s[8:11], s41 sc1
    s_waitcnt vmcnt(0)
    s_memtime s[46:47]
    s_waitcnt lgkmcnt(0)
    s_sub_u32 s46, s46, s44
    s_min_u32 s43, s43, s46

    v_mov_b32 v136, s42
    v_mov_b32 v137, s43
    s_lshl_b32 s40, s3, 3
    v_mov_b32 v135, s40
    ds_write_b64 v135, v[136:137]
    s_mov_b64 exec, -1
    s_waitcnt lgkmcnt(0)
    s_barrier
    v_mov_b32 v135, 0
    ds_read_b128 v[124:127], v135
    ds_read_b128 v[128:131], v135 offset:16
    s_waitcnt lgkmcnt(0)
    v_add3_u32 v124, v124, v126, v128
    v_add3_u32 v125, v125, v127, v129
    v_add_u32 v124, v124, v130
    v_add_u32 v125, v125, v131
    v_cmp_lt_u32 vcc, v125, v124
    v_mov_b32 v126, 1
    v_mov_b32 v127, 3
    v_cndmask_b32 v126, v126, v127, vcc

    s_sub_u32 s40, s28, 102
    s_lshl_b32 s40, s40, 2
    s_barrier
    s_cmp_lg_u32 s3, 0
    s_cbranch_scc1 boot_nrm0
    s_mov_b64 exec, 1
    buffer_store_dword v126, off, s[12:15], s40 offset:176 sc1
    s_mov_b64 exec, -1
    s_branch boot_nrm0

boot:
    s_sub_u32 s31, s28, 64
    s_cmp_lt_u32 s28, 112
    s_cbranch_scc1 boot_go
    s_sub_u32 s31, s28, 136
    s_cmp_lt_u32 s28, 259
    s_cbranch_scc1 boot_go
    s_sub_u32 s31, s28, 137
boot_go:
    s_load_dwordx4 s[64:67], s[0:1], 88
    s_load_dwordx2 s[68:69], s[0:1], 8
    s_lshl_b32 s32, s31, 3
    s_lshl_b32 s40, s3, 1
    s_add_u32 s32, s32, s40
    v_cmp_gt_u32 vcc, 40, v2
    v_lshlrev_b32 v100, 5, v2
    v_mov_b32 v10, 0x7ffffff0
    v_cndmask_b32 v100, v10, v100, vcc
    v_lshlrev_b32 v101, 6, v2
    v_cndmask_b32 v101, v10, v101, vcc
    s_mov_b64 s[76:77], vcc
    s_mul_i32 s33, s32, 1280
    s_add_u32 s34, s33, 1310720

    v_lshlrev_b32 v3, 4, v0
    s_sub_u32 s35, s31, 64
    s_waitcnt lgkmcnt(0)

    s_mov_b32 s16, s64
    s_and_b32 s17, s65, 0xffff
    s_mov_b32 s18, 0x500
    s_mov_b32 s19, 0x00020000
    s_mov_b32 s20, s66
    s_and_b32 s21, s67, 0xffff
    s_mov_b32 s22, 0x4b0000
    s_mov_b32 s23, 0x00020000
    s_mov_b32 s72, s68
    s_and_b32 s73, s69, 0xffff
    s_mov_b32 s74, 0x2800
    s_mov_b32 s75, 0x00020000
    s_cmp_lt_u32 s35, 60
    s_cbranch_scc1 boot_mod
    s_sub_u32 s42, s31, 60
    s_cmp_lt_u32 s31, 64
    s_cselect_b32 s42, s31, s42

    buffer_load_dwordx4 v[160:163], v100, s[24:27], s33 offen offset:0
    buffer_load_dwordx4 v[164:167], v100, s[24:27], s33 offen offset:16
    buffer_load_dwordx4 v[168:171], v100, s[24:27], s33 offen offset:1280
    buffer_load_dwordx4 v[172:175], v100, s[24:27], s33 offen offset:1296
    buffer_load_dwordx4 v[176:179], v100, s[24:27], s34 offen offset:0
    buffer_load_dwordx4 v[180:183], v100, s[24:27], s34 offen offset:16
    buffer_load_dwordx4 v[184:187], v100, s[24:27], s34 offen offset:1280
    buffer_load_dwordx4 v[188:191], v100, s[24:27], s34 offen offset:1296
boot_init:
    s_lshl_b32 s41, s42, 12
    s_add_u32 s43, s41, 0x6000000
    s_add_u32 s45, s41, 0x6030000
    s_cmp_ge_u32 s42, 480
    s_cselect_b32 s43, s45, s43
    s_sub_u32 s45, s41, 2359296
    s_cmp_ge_u32 s42, 592
    s_cselect_b32 s43, s45, s43
    s_cselect_b32 s46, 0, -1
    s_lshl_b32 s45, s42, 13
    s_add_u32 s45, s45, 0x5dc0000
    s_cmp_ge_u32 s42, 608
    s_cselect_b32 s43, s45, s43
    v_mov_b32 v12, s46
    v_mov_b32 v13, s46
    v_mov_b32 v14, s46
    v_mov_b32 v15, s46
    buffer_store_dwordx4 v[12:15], v3, s[8:11], s43 offen sc1
    s_add_u32 s42, s42, 68
    s_cmp_lt_u32 s42, 610
    s_cbranch_scc1 boot_init
    s_sub_u32 s42, s42, 610
    v_mov_b32 v12, -1
    v_mov_b32 v13, -1
    v_mov_b32 v14, -1
    v_mov_b32 v15, -1

boot_arm:
    s_lshl_b32 s41, s42, 12
    s_add_u32 s43, s41, 0xc60000
    s_add_u32 s45, s41, 0x10e0000
    s_cmp_ge_u32 s42, 160
    s_cselect_b32 s43, s45, s43

    s_add_u32 s45, s41, 0x1510000
    s_cmp_ge_u32 s42, 288
    s_cselect_b32 s43, s45, s43

    s_add_u32 s45, s41, 0x28c0000
    s_cmp_ge_u32 s42, 368
    s_cselect_b32 s43, s45, s43

    s_add_u32 s45, s41, 0x2c70000
    s_cmp_ge_u32 s42, 448
    s_cselect_b32 s43, s45, s43

    s_add_u32 s45, s41, 0x33d8000
    s_cmp_ge_u32 s42, 528
    s_cselect_b32 s43, s45, s43

    buffer_store_dwordx4 v[12:15], v3, s[8:11], s43 offen sc1
    s_add_u32 s42, s42, 68
    s_cmp_lt_u32 s42, 744
    s_cbranch_scc1 boot_arm
    s_cmp_lg_u32 s31, 2
    s_cbranch_scc1 boot_nomem
    v_and_b32 v8, 7, v0
    v_mul_u32_u24 v8, 1280, v8
    v_lshrrev_b32 v9, 3, v0
    v_lshl_add_u32 v8, v9, 4, v8
    buffer_load_dwordx4 v[16:19], v8, s[72:75], 0 offen
    buffer_load_dwordx4 v[20:23], v8, s[72:75], 0 offen offset:512
    buffer_load_dwordx4 v[24:27], v8, s[72:75], 0 offen offset:1024
    s_waitcnt vmcnt(0)

    v_min_u32 v16, -2, v16
    v_min_u32 v17, -2, v17
    v_min_u32 v18, -2, v18
    v_min_u32 v19, -2, v19
    v_min_u32 v20, -2, v20
    v_min_u32 v21, -2, v21
    v_min_u32 v22, -2, v22
    v_min_u32 v23, -2, v23
    v_min_u32 v24, -2, v24
    v_min_u32 v25, -2, v25
    v_min_u32 v26, -2, v26
    v_min_u32 v27, -2, v27
    s_mov_b32 s41, 0x6200000
    buffer_store_dwordx4 v[16:19], v3, s[8:11], s41 offen sc1
    s_mov_b32 s41, 0x6201000
    buffer_store_dwordx4 v[20:23], v3, s[8:11], s41 offen sc1

    s_mov_b32 s41, 0x6202000
    buffer_store_dwordx4 v[16:19], v3, s[8:11], s41 offen sc1
    s_mov_b32 s41, 0x6203000
    buffer_store_dwordx4 v[20:23], v3, s[8:11], s41 offen sc1

    s_mov_b32 s41, 0x6208000
    buffer_store_dwordx4 v[16:19], v3, s[8:11], s41 offen sc1
    s_mov_b32 s41, 0x6209000
    buffer_store_dwordx4 v[20:23], v3, s[8:11], s41 offen sc1

    s_mov_b32 s41, 0x620a000
    buffer_store_dwordx4 v[16:19], v3, s[8:11], s41 offen sc1
    s_mov_b32 s41, 0x620b000
    buffer_store_dwordx4 v[20:23], v3, s[8:11], s41 offen sc1

    s_cmp_ge_u32 s3, 2
    s_cbranch_scc1 boot_nomem

    s_mov_b32 s41, 0x6204000
    buffer_store_dwordx4 v[24:27], v3, s[8:11], s41 offen sc1

    s_mov_b32 s41, 0x6206000
    buffer_store_dwordx4 v[24:27], v3, s[8:11], s41 offen sc1

    s_mov_b32 s41, 0x620c000
    buffer_store_dwordx4 v[24:27], v3, s[8:11], s41 offen sc1

    s_mov_b32 s41, 0x620e000
    buffer_store_dwordx4 v[24:27], v3, s[8:11], s41 offen sc1

boot_nomem:
    s_waitcnt vmcnt(0)
    s_barrier
    s_cmp_lg_u32 s3, 3
    s_cbranch_scc1 da_146
    s_mov_b64 exec, 1

    v_mov_b32 v12, 1
    buffer_atomic_add v12, off, s[12:15], 0 offset:32 sc0
    s_waitcnt vmcnt(0)
    v_cmp_eq_u32 vcc, 67, v12
    v_mov_b32 v12, 1
    s_cbranch_vccz ar_147
    buffer_store_dword v12, off, s[12:15], 0 offset:160 sc1
ar_147:

    s_mov_b64 exec, -1
da_146:

    s_and_b32 s40, s28, 0xfffe
    s_cmp_eq_u32 s40, 102
    s_cbranch_scc1 pre_boot
    s_branch boot_nrm0

boot_mod:
    s_add_u32 s35, s35, 21
    s_cmp_ge_u32 s35, 60
    s_cselect_b32 s40, 60, 0
    s_sub_u32 s35, s35, s40
    v_and_b32 v8, 7, v0
    v_lshrrev_b32 v9, 3, v0
    v_mul_u32_u24 v10, 40, v9

    buffer_load_dwordx2 v[104:105], v10, s[16:19], 0 offen offset:0
    buffer_load_dwordx2 v[106:107], v10, s[16:19], 0 offen offset:8
    buffer_load_dwordx2 v[108:109], v10, s[16:19], 0 offen offset:16
    buffer_load_dwordx2 v[110:111], v10, s[16:19], 0 offen offset:24
    buffer_load_dwordx2 v[112:113], v10, s[16:19], 0 offen offset:32
    v_mul_u32_u24 v11, 153600, v9
    v_lshl_add_u32 v11, v8, 4, v11
    s_lshl_b32 s41, s35, 7

    buffer_load_dwordx4 v[16:19], v11, s[20:23], s41 offen
    s_add_u32 s41, s41, 7680
    buffer_load_dwordx4 v[20:23], v11, s[20:23], s41 offen
    s_add_u32 s41, s41, 7680
    buffer_load_dwordx4 v[24:27], v11, s[20:23], s41 offen
    s_add_u32 s41, s41, 7680
    buffer_load_dwordx4 v[28:31], v11, s[20:23], s41 offen
    s_add_u32 s41, s41, 7680
    buffer_load_dwordx4 v[32:35], v11, s[20:23], s41 offen
    s_add_u32 s41, s41, 7680
    buffer_load_dwordx4 v[36:39], v11, s[20:23], s41 offen
    s_add_u32 s41, s41, 7680
    buffer_load_dwordx4 v[40:43], v11, s[20:23], s41 offen
    s_add_u32 s41, s41, 7680
    buffer_load_dwordx4 v[44:47], v11, s[20:23], s41 offen
    s_add_u32 s41, s41, 7680
    buffer_load_dwordx4 v[48:51], v11, s[20:23], s41 offen
    s_add_u32 s41, s41, 7680
    buffer_load_dwordx4 v[52:55], v11, s[20:23], s41 offen
    s_add_u32 s41, s41, 7680
    buffer_load_dwordx4 v[56:59], v11, s[20:23], s41 offen
    s_add_u32 s41, s41, 7680
    buffer_load_dwordx4 v[60:63], v11, s[20:23], s41 offen
    s_add_u32 s41, s41, 7680
    buffer_load_dwordx4 v[64:67], v11, s[20:23], s41 offen
    s_add_u32 s41, s41, 7680
    buffer_load_dwordx4 v[68:71], v11, s[20:23], s41 offen
    s_add_u32 s41, s41, 7680
    buffer_load_dwordx4 v[72:75], v11, s[20:23], s41 offen
    s_add_u32 s41, s41, 7680
    buffer_load_dwordx4 v[76:79], v11, s[20:23], s41 offen
    s_add_u32 s41, s41, 7680
    buffer_load_dwordx4 v[80:83], v11, s[20:23], s41 offen
    s_add_u32 s41, s41, 7680
    buffer_load_dwordx4 v[84:87], v11, s[20:23], s41 offen
    s_add_u32 s41, s41, 7680
    buffer_load_dwordx4 v[88:91], v11, s[20:23], s41 offen
    s_add_u32 s41, s41, 7680
    buffer_load_dwordx4 v[92:95], v11, s[20:23], s41 offen
    s_add_u32 s41, s41, 7680
    buffer_load_dwordx4 v[160:163], v100, s[24:27], s33 offen offset:0
    buffer_load_dwordx4 v[164:167], v100, s[24:27], s33 offen offset:16
    buffer_load_dwordx4 v[168:171], v100, s[24:27], s33 offen offset:1280
    buffer_load_dwordx4 v[172:175], v100, s[24:27], s33 offen offset:1296
    buffer_load_dwordx4 v[176:179], v100, s[24:27], s34 offen offset:0
    buffer_load_dwordx4 v[180:183], v100, s[24:27], s34 offen offset:16
    buffer_load_dwordx4 v[184:187], v100, s[24:27], s34 offen offset:1280
    buffer_load_dwordx4 v[188:191], v100, s[24:27], s34 offen offset:1296
    s_waitcnt vmcnt(28)
    s_mov_b32 s42, 0xbfb8aa3b
    v_lshlrev_b32 v116, 16, v104
    v_and_b32 v117, 0xffff0000, v104
    v_lshlrev_b32 v118, 16, v105
    v_and_b32 v119, 0xffff0000, v105
    v_lshlrev_b32 v120, 16, v106
    v_and_b32 v121, 0xffff0000, v106
    v_lshlrev_b32 v122, 16, v107
    v_and_b32 v123, 0xffff0000, v107
    v_lshlrev_b32 v124, 16, v108
    v_and_b32 v125, 0xffff0000, v108
    v_lshlrev_b32 v126, 16, v109
    v_and_b32 v127, 0xffff0000, v109
    v_lshlrev_b32 v128, 16, v110
    v_and_b32 v129, 0xffff0000, v110
    v_lshlrev_b32 v130, 16, v111
    v_and_b32 v131, 0xffff0000, v111
    v_lshlrev_b32 v132, 16, v112
    v_and_b32 v133, 0xffff0000, v112
    v_lshlrev_b32 v134, 16, v113
    v_and_b32 v135, 0xffff0000, v113
    v_mul_f32 v136, s42, v116
    v_mul_f32 v137, s42, v117
    v_mul_f32 v138, s42, v118
    v_mul_f32 v139, s42, v119
    v_mul_f32 v140, s42, v120
    v_mul_f32 v141, s42, v121
    v_mul_f32 v142, s42, v122
    v_mul_f32 v143, s42, v123
    v_mul_f32 v144, s42, v124
    v_mul_f32 v145, s42, v125
    v_mul_f32 v146, s42, v126
    v_mul_f32 v147, s42, v127
    v_mul_f32 v148, s42, v128
    v_mul_f32 v149, s42, v129
    v_mul_f32 v150, s42, v130
    v_mul_f32 v151, s42, v131
    v_mul_f32 v152, s42, v132
    v_mul_f32 v153, s42, v133
    v_mul_f32 v154, s42, v134
    v_mul_f32 v155, s42, v135
    v_exp_f32 v136, v136
    v_exp_f32 v137, v137
    v_exp_f32 v138, v138
    v_exp_f32 v139, v139
    v_exp_f32 v140, v140
    v_exp_f32 v141, v141
    v_exp_f32 v142, v142
    v_exp_f32 v143, v143
    v_exp_f32 v144, v144
    v_exp_f32 v145, v145
    v_exp_f32 v146, v146
    v_exp_f32 v147, v147
    v_exp_f32 v148, v148
    v_exp_f32 v149, v149
    v_exp_f32 v150, v150
    v_exp_f32 v151, v151
    v_exp_f32 v152, v152
    v_exp_f32 v153, v153
    v_exp_f32 v154, v154
    v_exp_f32 v155, v155
    v_add_f32 v136, 1.0, v136
    v_add_f32 v137, 1.0, v137
    v_add_f32 v138, 1.0, v138
    v_add_f32 v139, 1.0, v139
    v_add_f32 v140, 1.0, v140
    v_add_f32 v141, 1.0, v141
    v_add_f32 v142, 1.0, v142
    v_add_f32 v143, 1.0, v143
    v_add_f32 v144, 1.0, v144
    v_add_f32 v145, 1.0, v145
    v_add_f32 v146, 1.0, v146
    v_add_f32 v147, 1.0, v147
    v_add_f32 v148, 1.0, v148
    v_add_f32 v149, 1.0, v149
    v_add_f32 v150, 1.0, v150
    v_add_f32 v151, 1.0, v151
    v_add_f32 v152, 1.0, v152
    v_add_f32 v153, 1.0, v153
    v_add_f32 v154, 1.0, v154
    v_add_f32 v155, 1.0, v155
    v_rcp_f32 v136, v136
    v_rcp_f32 v137, v137
    v_rcp_f32 v138, v138
    v_rcp_f32 v139, v139
    v_rcp_f32 v140, v140
    v_rcp_f32 v141, v141
    v_rcp_f32 v142, v142
    v_rcp_f32 v143, v143
    v_rcp_f32 v144, v144
    v_rcp_f32 v145, v145
    v_rcp_f32 v146, v146
    v_rcp_f32 v147, v147
    v_rcp_f32 v148, v148
    v_rcp_f32 v149, v149
    v_rcp_f32 v150, v150
    v_rcp_f32 v151, v151
    v_rcp_f32 v152, v152
    v_rcp_f32 v153, v153
    v_rcp_f32 v154, v154
    v_rcp_f32 v155, v155
    v_mul_f32 v136, v136, v116
    v_mul_f32 v137, v137, v117
    v_mul_f32 v138, v138, v118
    v_mul_f32 v139, v139, v119
    v_mul_f32 v140, v140, v120
    v_mul_f32 v141, v141, v121
    v_mul_f32 v142, v142, v122
    v_mul_f32 v143, v143, v123
    v_mul_f32 v144, v144, v124
    v_mul_f32 v145, v145, v125
    v_mul_f32 v146, v146, v126
    v_mul_f32 v147, v147, v127
    v_mul_f32 v148, v148, v128
    v_mul_f32 v149, v149, v129
    v_mul_f32 v150, v150, v130
    v_mul_f32 v151, v151, v131
    v_mul_f32 v152, v152, v132
    v_mul_f32 v153, v153, v133
    v_mul_f32 v154, v154, v134
    v_mul_f32 v155, v155, v135
    v_cvt_pk_bf16_f32 v12, v136, v137
    v_lshlrev_b32 v116, 16, v12
    v_and_b32 v117, 0xffff0000, v12
    v_cvt_pk_bf16_f32 v12, v138, v139
    v_lshlrev_b32 v118, 16, v12
    v_and_b32 v119, 0xffff0000, v12
    v_cvt_pk_bf16_f32 v12, v140, v141
    v_lshlrev_b32 v120, 16, v12
    v_and_b32 v121, 0xffff0000, v12
    v_cvt_pk_bf16_f32 v12, v142, v143
    v_lshlrev_b32 v122, 16, v12
    v_and_b32 v123, 0xffff0000, v12
    v_cvt_pk_bf16_f32 v12, v144, v145
    v_lshlrev_b32 v124, 16, v12
    v_and_b32 v125, 0xffff0000, v12
    v_cvt_pk_bf16_f32 v12, v146, v147
    v_lshlrev_b32 v126, 16, v12
    v_and_b32 v127, 0xffff0000, v12
    v_cvt_pk_bf16_f32 v12, v148, v149
    v_lshlrev_b32 v128, 16, v12
    v_and_b32 v129, 0xffff0000, v12
    v_cvt_pk_bf16_f32 v12, v150, v151
    v_lshlrev_b32 v130, 16, v12
    v_and_b32 v131, 0xffff0000, v12
    v_cvt_pk_bf16_f32 v12, v152, v153
    v_lshlrev_b32 v132, 16, v12
    v_and_b32 v133, 0xffff0000, v12
    v_cvt_pk_bf16_f32 v12, v154, v155
    v_lshlrev_b32 v134, 16, v12
    v_and_b32 v135, 0xffff0000, v12
    v_mov_b32 v104, 0
    v_mov_b32 v105, 0
    v_mov_b32 v106, 0
    v_mov_b32 v107, 0
    v_mov_b32 v108, 0
    v_mov_b32 v109, 0
    v_mov_b32 v110, 0
    v_mov_b32 v111, 0
    s_waitcnt vmcnt(27)
    v_lshlrev_b32 v12, 16, v16
    v_and_b32 v13, 0xffff0000, v16
    v_fmac_f32 v104, v12, v116
    v_fmac_f32 v105, v13, v116
    v_lshlrev_b32 v12, 16, v17
    v_and_b32 v13, 0xffff0000, v17
    v_fmac_f32 v106, v12, v116
    v_fmac_f32 v107, v13, v116
    v_lshlrev_b32 v12, 16, v18
    v_and_b32 v13, 0xffff0000, v18
    v_fmac_f32 v108, v12, v116
    v_fmac_f32 v109, v13, v116
    v_lshlrev_b32 v12, 16, v19
    v_and_b32 v13, 0xffff0000, v19
    v_fmac_f32 v110, v12, v116
    v_fmac_f32 v111, v13, v116
    s_waitcnt vmcnt(26)
    v_lshlrev_b32 v12, 16, v20
    v_and_b32 v13, 0xffff0000, v20
    v_fmac_f32 v104, v12, v117
    v_fmac_f32 v105, v13, v117
    v_lshlrev_b32 v12, 16, v21
    v_and_b32 v13, 0xffff0000, v21
    v_fmac_f32 v106, v12, v117
    v_fmac_f32 v107, v13, v117
    v_lshlrev_b32 v12, 16, v22
    v_and_b32 v13, 0xffff0000, v22
    v_fmac_f32 v108, v12, v117
    v_fmac_f32 v109, v13, v117
    v_lshlrev_b32 v12, 16, v23
    v_and_b32 v13, 0xffff0000, v23
    v_fmac_f32 v110, v12, v117
    v_fmac_f32 v111, v13, v117
    s_waitcnt vmcnt(25)
    v_lshlrev_b32 v12, 16, v24
    v_and_b32 v13, 0xffff0000, v24
    v_fmac_f32 v104, v12, v118
    v_fmac_f32 v105, v13, v118
    v_lshlrev_b32 v12, 16, v25
    v_and_b32 v13, 0xffff0000, v25
    v_fmac_f32 v106, v12, v118
    v_fmac_f32 v107, v13, v118
    v_lshlrev_b32 v12, 16, v26
    v_and_b32 v13, 0xffff0000, v26
    v_fmac_f32 v108, v12, v118
    v_fmac_f32 v109, v13, v118
    v_lshlrev_b32 v12, 16, v27
    v_and_b32 v13, 0xffff0000, v27
    v_fmac_f32 v110, v12, v118
    v_fmac_f32 v111, v13, v118
    s_waitcnt vmcnt(24)
    v_lshlrev_b32 v12, 16, v28
    v_and_b32 v13, 0xffff0000, v28
    v_fmac_f32 v104, v12, v119
    v_fmac_f32 v105, v13, v119
    v_lshlrev_b32 v12, 16, v29
    v_and_b32 v13, 0xffff0000, v29
    v_fmac_f32 v106, v12, v119
    v_fmac_f32 v107, v13, v119
    v_lshlrev_b32 v12, 16, v30
    v_and_b32 v13, 0xffff0000, v30
    v_fmac_f32 v108, v12, v119
    v_fmac_f32 v109, v13, v119
    v_lshlrev_b32 v12, 16, v31
    v_and_b32 v13, 0xffff0000, v31
    v_fmac_f32 v110, v12, v119
    v_fmac_f32 v111, v13, v119
    s_waitcnt vmcnt(23)
    v_lshlrev_b32 v12, 16, v32
    v_and_b32 v13, 0xffff0000, v32
    v_fmac_f32 v104, v12, v120
    v_fmac_f32 v105, v13, v120
    v_lshlrev_b32 v12, 16, v33
    v_and_b32 v13, 0xffff0000, v33
    v_fmac_f32 v106, v12, v120
    v_fmac_f32 v107, v13, v120
    v_lshlrev_b32 v12, 16, v34
    v_and_b32 v13, 0xffff0000, v34
    v_fmac_f32 v108, v12, v120
    v_fmac_f32 v109, v13, v120
    v_lshlrev_b32 v12, 16, v35
    v_and_b32 v13, 0xffff0000, v35
    v_fmac_f32 v110, v12, v120
    v_fmac_f32 v111, v13, v120
    s_waitcnt vmcnt(22)
    v_lshlrev_b32 v12, 16, v36
    v_and_b32 v13, 0xffff0000, v36
    v_fmac_f32 v104, v12, v121
    v_fmac_f32 v105, v13, v121
    v_lshlrev_b32 v12, 16, v37
    v_and_b32 v13, 0xffff0000, v37
    v_fmac_f32 v106, v12, v121
    v_fmac_f32 v107, v13, v121
    v_lshlrev_b32 v12, 16, v38
    v_and_b32 v13, 0xffff0000, v38
    v_fmac_f32 v108, v12, v121
    v_fmac_f32 v109, v13, v121
    v_lshlrev_b32 v12, 16, v39
    v_and_b32 v13, 0xffff0000, v39
    v_fmac_f32 v110, v12, v121
    v_fmac_f32 v111, v13, v121
    s_waitcnt vmcnt(21)
    v_lshlrev_b32 v12, 16, v40
    v_and_b32 v13, 0xffff0000, v40
    v_fmac_f32 v104, v12, v122
    v_fmac_f32 v105, v13, v122
    v_lshlrev_b32 v12, 16, v41
    v_and_b32 v13, 0xffff0000, v41
    v_fmac_f32 v106, v12, v122
    v_fmac_f32 v107, v13, v122
    v_lshlrev_b32 v12, 16, v42
    v_and_b32 v13, 0xffff0000, v42
    v_fmac_f32 v108, v12, v122
    v_fmac_f32 v109, v13, v122
    v_lshlrev_b32 v12, 16, v43
    v_and_b32 v13, 0xffff0000, v43
    v_fmac_f32 v110, v12, v122
    v_fmac_f32 v111, v13, v122
    s_waitcnt vmcnt(20)
    v_lshlrev_b32 v12, 16, v44
    v_and_b32 v13, 0xffff0000, v44
    v_fmac_f32 v104, v12, v123
    v_fmac_f32 v105, v13, v123
    v_lshlrev_b32 v12, 16, v45
    v_and_b32 v13, 0xffff0000, v45
    v_fmac_f32 v106, v12, v123
    v_fmac_f32 v107, v13, v123
    v_lshlrev_b32 v12, 16, v46
    v_and_b32 v13, 0xffff0000, v46
    v_fmac_f32 v108, v12, v123
    v_fmac_f32 v109, v13, v123
    v_lshlrev_b32 v12, 16, v47
    v_and_b32 v13, 0xffff0000, v47
    v_fmac_f32 v110, v12, v123
    v_fmac_f32 v111, v13, v123
    s_waitcnt vmcnt(19)
    v_lshlrev_b32 v12, 16, v48
    v_and_b32 v13, 0xffff0000, v48
    v_fmac_f32 v104, v12, v124
    v_fmac_f32 v105, v13, v124
    v_lshlrev_b32 v12, 16, v49
    v_and_b32 v13, 0xffff0000, v49
    v_fmac_f32 v106, v12, v124
    v_fmac_f32 v107, v13, v124
    v_lshlrev_b32 v12, 16, v50
    v_and_b32 v13, 0xffff0000, v50
    v_fmac_f32 v108, v12, v124
    v_fmac_f32 v109, v13, v124
    v_lshlrev_b32 v12, 16, v51
    v_and_b32 v13, 0xffff0000, v51
    v_fmac_f32 v110, v12, v124
    v_fmac_f32 v111, v13, v124
    s_waitcnt vmcnt(18)
    v_lshlrev_b32 v12, 16, v52
    v_and_b32 v13, 0xffff0000, v52
    v_fmac_f32 v104, v12, v125
    v_fmac_f32 v105, v13, v125
    v_lshlrev_b32 v12, 16, v53
    v_and_b32 v13, 0xffff0000, v53
    v_fmac_f32 v106, v12, v125
    v_fmac_f32 v107, v13, v125
    v_lshlrev_b32 v12, 16, v54
    v_and_b32 v13, 0xffff0000, v54
    v_fmac_f32 v108, v12, v125
    v_fmac_f32 v109, v13, v125
    v_lshlrev_b32 v12, 16, v55
    v_and_b32 v13, 0xffff0000, v55
    v_fmac_f32 v110, v12, v125
    v_fmac_f32 v111, v13, v125
    s_waitcnt vmcnt(17)
    v_lshlrev_b32 v12, 16, v56
    v_and_b32 v13, 0xffff0000, v56
    v_fmac_f32 v104, v12, v126
    v_fmac_f32 v105, v13, v126
    v_lshlrev_b32 v12, 16, v57
    v_and_b32 v13, 0xffff0000, v57
    v_fmac_f32 v106, v12, v126
    v_fmac_f32 v107, v13, v126
    v_lshlrev_b32 v12, 16, v58
    v_and_b32 v13, 0xffff0000, v58
    v_fmac_f32 v108, v12, v126
    v_fmac_f32 v109, v13, v126
    v_lshlrev_b32 v12, 16, v59
    v_and_b32 v13, 0xffff0000, v59
    v_fmac_f32 v110, v12, v126
    v_fmac_f32 v111, v13, v126
    s_waitcnt vmcnt(16)
    v_lshlrev_b32 v12, 16, v60
    v_and_b32 v13, 0xffff0000, v60
    v_fmac_f32 v104, v12, v127
    v_fmac_f32 v105, v13, v127
    v_lshlrev_b32 v12, 16, v61
    v_and_b32 v13, 0xffff0000, v61
    v_fmac_f32 v106, v12, v127
    v_fmac_f32 v107, v13, v127
    v_lshlrev_b32 v12, 16, v62
    v_and_b32 v13, 0xffff0000, v62
    v_fmac_f32 v108, v12, v127
    v_fmac_f32 v109, v13, v127
    v_lshlrev_b32 v12, 16, v63
    v_and_b32 v13, 0xffff0000, v63
    v_fmac_f32 v110, v12, v127
    v_fmac_f32 v111, v13, v127
    s_waitcnt vmcnt(15)
    v_lshlrev_b32 v12, 16, v64
    v_and_b32 v13, 0xffff0000, v64
    v_fmac_f32 v104, v12, v128
    v_fmac_f32 v105, v13, v128
    v_lshlrev_b32 v12, 16, v65
    v_and_b32 v13, 0xffff0000, v65
    v_fmac_f32 v106, v12, v128
    v_fmac_f32 v107, v13, v128
    v_lshlrev_b32 v12, 16, v66
    v_and_b32 v13, 0xffff0000, v66
    v_fmac_f32 v108, v12, v128
    v_fmac_f32 v109, v13, v128
    v_lshlrev_b32 v12, 16, v67
    v_and_b32 v13, 0xffff0000, v67
    v_fmac_f32 v110, v12, v128
    v_fmac_f32 v111, v13, v128
    s_waitcnt vmcnt(14)
    v_lshlrev_b32 v12, 16, v68
    v_and_b32 v13, 0xffff0000, v68
    v_fmac_f32 v104, v12, v129
    v_fmac_f32 v105, v13, v129
    v_lshlrev_b32 v12, 16, v69
    v_and_b32 v13, 0xffff0000, v69
    v_fmac_f32 v106, v12, v129
    v_fmac_f32 v107, v13, v129
    v_lshlrev_b32 v12, 16, v70
    v_and_b32 v13, 0xffff0000, v70
    v_fmac_f32 v108, v12, v129
    v_fmac_f32 v109, v13, v129
    v_lshlrev_b32 v12, 16, v71
    v_and_b32 v13, 0xffff0000, v71
    v_fmac_f32 v110, v12, v129
    v_fmac_f32 v111, v13, v129
    s_waitcnt vmcnt(13)
    v_lshlrev_b32 v12, 16, v72
    v_and_b32 v13, 0xffff0000, v72
    v_fmac_f32 v104, v12, v130
    v_fmac_f32 v105, v13, v130
    v_lshlrev_b32 v12, 16, v73
    v_and_b32 v13, 0xffff0000, v73
    v_fmac_f32 v106, v12, v130
    v_fmac_f32 v107, v13, v130
    v_lshlrev_b32 v12, 16, v74
    v_and_b32 v13, 0xffff0000, v74
    v_fmac_f32 v108, v12, v130
    v_fmac_f32 v109, v13, v130
    v_lshlrev_b32 v12, 16, v75
    v_and_b32 v13, 0xffff0000, v75
    v_fmac_f32 v110, v12, v130
    v_fmac_f32 v111, v13, v130
    s_waitcnt vmcnt(12)
    v_lshlrev_b32 v12, 16, v76
    v_and_b32 v13, 0xffff0000, v76
    v_fmac_f32 v104, v12, v131
    v_fmac_f32 v105, v13, v131
    v_lshlrev_b32 v12, 16, v77
    v_and_b32 v13, 0xffff0000, v77
    v_fmac_f32 v106, v12, v131
    v_fmac_f32 v107, v13, v131
    v_lshlrev_b32 v12, 16, v78
    v_and_b32 v13, 0xffff0000, v78
    v_fmac_f32 v108, v12, v131
    v_fmac_f32 v109, v13, v131
    v_lshlrev_b32 v12, 16, v79
    v_and_b32 v13, 0xffff0000, v79
    v_fmac_f32 v110, v12, v131
    v_fmac_f32 v111, v13, v131
    s_waitcnt vmcnt(11)
    v_lshlrev_b32 v12, 16, v80
    v_and_b32 v13, 0xffff0000, v80
    v_fmac_f32 v104, v12, v132
    v_fmac_f32 v105, v13, v132
    v_lshlrev_b32 v12, 16, v81
    v_and_b32 v13, 0xffff0000, v81
    v_fmac_f32 v106, v12, v132
    v_fmac_f32 v107, v13, v132
    v_lshlrev_b32 v12, 16, v82
    v_and_b32 v13, 0xffff0000, v82
    v_fmac_f32 v108, v12, v132
    v_fmac_f32 v109, v13, v132
    v_lshlrev_b32 v12, 16, v83
    v_and_b32 v13, 0xffff0000, v83
    v_fmac_f32 v110, v12, v132
    v_fmac_f32 v111, v13, v132
    s_waitcnt vmcnt(10)
    v_lshlrev_b32 v12, 16, v84
    v_and_b32 v13, 0xffff0000, v84
    v_fmac_f32 v104, v12, v133
    v_fmac_f32 v105, v13, v133
    v_lshlrev_b32 v12, 16, v85
    v_and_b32 v13, 0xffff0000, v85
    v_fmac_f32 v106, v12, v133
    v_fmac_f32 v107, v13, v133
    v_lshlrev_b32 v12, 16, v86
    v_and_b32 v13, 0xffff0000, v86
    v_fmac_f32 v108, v12, v133
    v_fmac_f32 v109, v13, v133
    v_lshlrev_b32 v12, 16, v87
    v_and_b32 v13, 0xffff0000, v87
    v_fmac_f32 v110, v12, v133
    v_fmac_f32 v111, v13, v133
    s_waitcnt vmcnt(9)
    v_lshlrev_b32 v12, 16, v88
    v_and_b32 v13, 0xffff0000, v88
    v_fmac_f32 v104, v12, v134
    v_fmac_f32 v105, v13, v134
    v_lshlrev_b32 v12, 16, v89
    v_and_b32 v13, 0xffff0000, v89
    v_fmac_f32 v106, v12, v134
    v_fmac_f32 v107, v13, v134
    v_lshlrev_b32 v12, 16, v90
    v_and_b32 v13, 0xffff0000, v90
    v_fmac_f32 v108, v12, v134
    v_fmac_f32 v109, v13, v134
    v_lshlrev_b32 v12, 16, v91
    v_and_b32 v13, 0xffff0000, v91
    v_fmac_f32 v110, v12, v134
    v_fmac_f32 v111, v13, v134
    s_waitcnt vmcnt(8)
    v_lshlrev_b32 v12, 16, v92
    v_and_b32 v13, 0xffff0000, v92
    v_fmac_f32 v104, v12, v135
    v_fmac_f32 v105, v13, v135
    v_lshlrev_b32 v12, 16, v93
    v_and_b32 v13, 0xffff0000, v93
    v_fmac_f32 v106, v12, v135
    v_fmac_f32 v107, v13, v135
    v_lshlrev_b32 v12, 16, v94
    v_and_b32 v13, 0xffff0000, v94
    v_fmac_f32 v108, v12, v135
    v_fmac_f32 v109, v13, v135
    v_lshlrev_b32 v12, 16, v95
    v_and_b32 v13, 0xffff0000, v95
    v_fmac_f32 v110, v12, v135
    v_fmac_f32 v111, v13, v135
    v_lshlrev_b32 v12, 8, v9
    v_lshl_add_u32 v12, v8, 5, v12
    ds_write_b128 v12, v[104:107]
    ds_write_b128 v12, v[108:111] offset:16
    s_waitcnt lgkmcnt(0)
    s_barrier
    s_cmp_lg_u32 s3, 0
    s_cbranch_scc1 boot_nrm0
    v_lshlrev_b32 v12, 2, v0

    ds_read_b32 v16, v12 offset:0
    ds_read_b32 v17, v12 offset:256
    ds_read_b32 v18, v12 offset:512
    ds_read_b32 v19, v12 offset:768
    ds_read_b32 v20, v12 offset:1024
    ds_read_b32 v21, v12 offset:1280
    ds_read_b32 v22, v12 offset:1536
    ds_read_b32 v23, v12 offset:1792
    ds_read_b32 v24, v12 offset:2048
    ds_read_b32 v25, v12 offset:2304
    ds_read_b32 v26, v12 offset:2560
    ds_read_b32 v27, v12 offset:2816
    ds_read_b32 v28, v12 offset:3072
    ds_read_b32 v29, v12 offset:3328
    ds_read_b32 v30, v12 offset:3584
    ds_read_b32 v31, v12 offset:3840
    s_waitcnt lgkmcnt(0)
    ds_read_b32 v32, v12 offset:4096
    ds_read_b32 v33, v12 offset:4352
    ds_read_b32 v34, v12 offset:4608
    ds_read_b32 v35, v12 offset:4864
    ds_read_b32 v36, v12 offset:5120
    ds_read_b32 v37, v12 offset:5376
    ds_read_b32 v38, v12 offset:5632
    ds_read_b32 v39, v12 offset:5888
    ds_read_b32 v40, v12 offset:6144
    ds_read_b32 v41, v12 offset:6400
    ds_read_b32 v42, v12 offset:6656
    ds_read_b32 v43, v12 offset:6912
    ds_read_b32 v44, v12 offset:7168
    ds_read_b32 v45, v12 offset:7424
    ds_read_b32 v46, v12 offset:7680
    ds_read_b32 v47, v12 offset:7936
    s_waitcnt lgkmcnt(0)
    v_add_f32 v16, v16, v17
    v_add_f32 v16, v16, v18
    v_add_f32 v16, v16, v19
    v_add_f32 v16, v16, v20
    v_add_f32 v16, v16, v21
    v_add_f32 v16, v16, v22
    v_add_f32 v16, v16, v23
    v_add_f32 v16, v16, v24
    v_add_f32 v16, v16, v25
    v_add_f32 v16, v16, v26
    v_add_f32 v16, v16, v27
    v_add_f32 v16, v16, v28
    v_add_f32 v16, v16, v29
    v_add_f32 v16, v16, v30
    v_add_f32 v16, v16, v31
    v_add_f32 v16, v16, v32
    v_add_f32 v16, v16, v33
    v_add_f32 v16, v16, v34
    v_add_f32 v16, v16, v35
    v_add_f32 v16, v16, v36
    v_add_f32 v16, v16, v37
    v_add_f32 v16, v16, v38
    v_add_f32 v16, v16, v39
    v_add_f32 v16, v16, v40
    v_add_f32 v16, v16, v41
    v_add_f32 v16, v16, v42
    v_add_f32 v16, v16, v43
    v_add_f32 v16, v16, v44
    v_add_f32 v16, v16, v45
    v_add_f32 v16, v16, v46
    v_add_f32 v16, v16, v47
    v_cvt_pk_bf16_f32 v16, v16, v16
    v_and_b32 v16, 0xffff0000, v16
    s_lshl_b32 s41, s35, 8
    buffer_store_dword v16, v12, s[8:11], s41 offen offset:0 sc1
    s_waitcnt vmcnt(0)
    s_mov_b64 exec, 1
    s_cmp_ge_u32 s35, 20
    s_cbranch_scc1 boot_mod_no20

    v_mov_b32 v17, 1
    buffer_atomic_add v17, off, s[12:15], 0 offset:36 sc0
    s_waitcnt vmcnt(0)
    v_cmp_eq_u32 vcc, 19, v17
    v_mov_b32 v17, 1
    s_cbranch_vccz ar_148
    buffer_store_dword v17, off, s[12:15], 0 offset:164 sc1
ar_148:

boot_mod_no20:
    v_mov_b32 v17, 1
    buffer_atomic_add v17, off, s[12:15], 0 offset:40 sc0
    s_waitcnt vmcnt(0)
    v_cmp_eq_u32 vcc, 59, v17
    v_mov_b32 v17, 1
    s_cbranch_vccz ar_149
    buffer_store_dword v17, off, s[12:15], 0 offset:168 sc1
ar_149:

    s_mov_b64 exec, -1
boot_nrm0:
    s_mov_b32 s46, 0
    s_waitcnt vmcnt(0)
boot_nrm:
    v_lshlrev_b32 v16, 16, v160
    v_and_b32 v17, 0xffff0000, v160
    v_lshlrev_b32 v18, 16, v161
    v_and_b32 v19, 0xffff0000, v161
    v_lshlrev_b32 v20, 16, v162
    v_and_b32 v21, 0xffff0000, v162
    v_lshlrev_b32 v22, 16, v163
    v_and_b32 v23, 0xffff0000, v163
    v_lshlrev_b32 v24, 16, v164
    v_and_b32 v25, 0xffff0000, v164
    v_lshlrev_b32 v26, 16, v165
    v_and_b32 v27, 0xffff0000, v165
    v_lshlrev_b32 v28, 16, v166
    v_and_b32 v29, 0xffff0000, v166
    v_lshlrev_b32 v30, 16, v167
    v_and_b32 v31, 0xffff0000, v167
    v_mov_b32 v160, v168
    v_mov_b32 v200, v208
    v_mov_b32 v161, v169
    v_mov_b32 v201, v209
    v_mov_b32 v162, v170
    v_mov_b32 v202, v210
    v_mov_b32 v163, v171
    v_mov_b32 v203, v211
    v_mov_b32 v164, v172
    v_mov_b32 v204, v212
    v_mov_b32 v165, v173
    v_mov_b32 v205, v213
    v_mov_b32 v166, v174
    v_mov_b32 v206, v214
    v_mov_b32 v167, v175
    v_mov_b32 v207, v215
    v_mov_b32 v168, v176
    v_mov_b32 v208, v216
    v_mov_b32 v169, v177
    v_mov_b32 v209, v217
    v_mov_b32 v170, v178
    v_mov_b32 v210, v218
    v_mov_b32 v171, v179
    v_mov_b32 v211, v219
    v_mov_b32 v172, v180
    v_mov_b32 v212, v220
    v_mov_b32 v173, v181
    v_mov_b32 v213, v221
    v_mov_b32 v174, v182
    v_mov_b32 v214, v222
    v_mov_b32 v175, v183
    v_mov_b32 v215, v223
    v_mov_b32 v176, v184
    v_mov_b32 v216, v224
    v_mov_b32 v177, v185
    v_mov_b32 v217, v225
    v_mov_b32 v178, v186
    v_mov_b32 v218, v226
    v_mov_b32 v179, v187
    v_mov_b32 v219, v227
    v_mov_b32 v180, v188
    v_mov_b32 v220, v228
    v_mov_b32 v181, v189
    v_mov_b32 v221, v229
    v_mov_b32 v182, v190
    v_mov_b32 v222, v230
    v_mov_b32 v183, v191
    v_mov_b32 v223, v231
    v_add_f32 v12, v16, v17
    v_add_f32 v12, v12, v18
    v_add_f32 v12, v12, v19
    v_add_f32 v12, v12, v20
    v_add_f32 v12, v12, v21
    v_add_f32 v12, v12, v22
    v_add_f32 v12, v12, v23
    v_add_f32 v12, v12, v24
    v_add_f32 v12, v12, v25
    v_add_f32 v12, v12, v26
    v_add_f32 v12, v12, v27
    v_add_f32 v12, v12, v28
    v_add_f32 v12, v12, v29
    v_add_f32 v12, v12, v30
    v_add_f32 v12, v12, v31
    s_nop 1
    v_add_f32_dpp v12, v12, v12 quad_perm:[1,0,3,2] row_mask:0xf bank_mask:0xf
    s_nop 1
    v_add_f32_dpp v12, v12, v12 quad_perm:[2,3,0,1] row_mask:0xf bank_mask:0xf
    s_nop 1
    v_add_f32_dpp v12, v12, v12 row_half_mirror row_mask:0xf bank_mask:0xf
    s_nop 1
    v_add_f32_dpp v12, v12, v12 row_mirror row_mask:0xf bank_mask:0xf
    s_nop 0
    v_readlane_b32 s72, v12, 0
    v_readlane_b32 s73, v12, 16
    v_readlane_b32 s74, v12, 32
    s_nop 1
    v_mov_b32 v12, s72
    v_add_f32 v12, s73, v12
    v_add_f32 v12, s74, v12
    v_mul_f32 v12, 0x3acccccd, v12
    v_sub_f32 v14, v16, v12
    v_mul_f32 v13, v14, v14
    v_sub_f32 v14, v17, v12
    v_fmac_f32 v13, v14, v14
    v_sub_f32 v14, v18, v12
    v_fmac_f32 v13, v14, v14
    v_sub_f32 v14, v19, v12
    v_fmac_f32 v13, v14, v14
    v_sub_f32 v14, v20, v12
    v_fmac_f32 v13, v14, v14
    v_sub_f32 v14, v21, v12
    v_fmac_f32 v13, v14, v14
    v_sub_f32 v14, v22, v12
    v_fmac_f32 v13, v14, v14
    v_sub_f32 v14, v23, v12
    v_fmac_f32 v13, v14, v14
    v_sub_f32 v14, v24, v12
    v_fmac_f32 v13, v14, v14
    v_sub_f32 v14, v25, v12
    v_fmac_f32 v13, v14, v14
    v_sub_f32 v14, v26, v12
    v_fmac_f32 v13, v14, v14
    v_sub_f32 v14, v27, v12
    v_fmac_f32 v13, v14, v14
    v_sub_f32 v14, v28, v12
    v_fmac_f32 v13, v14, v14
    v_sub_f32 v14, v29, v12
    v_fmac_f32 v13, v14, v14
    v_sub_f32 v14, v30, v12
    v_fmac_f32 v13, v14, v14
    v_sub_f32 v14, v31, v12
    v_fmac_f32 v13, v14, v14
    v_cndmask_b32 v13, 0, v13, s[76:77]
    s_nop 1
    v_add_f32_dpp v13, v13, v13 quad_perm:[1,0,3,2] row_mask:0xf bank_mask:0xf
    s_nop 1
    v_add_f32_dpp v13, v13, v13 quad_perm:[2,3,0,1] row_mask:0xf bank_mask:0xf
    s_nop 1
    v_add_f32_dpp v13, v13, v13 row_half_mirror row_mask:0xf bank_mask:0xf
    s_nop 1
    v_add_f32_dpp v13, v13, v13 row_mirror row_mask:0xf bank_mask:0xf
    s_nop 0
    v_readlane_b32 s72, v13, 0
    v_readlane_b32 s73, v13, 16
    v_readlane_b32 s74, v13, 32
    s_nop 1
    v_mov_b32 v13, s72
    v_add_f32 v13, s73, v13
    v_add_f32 v13, s74, v13
    v_mul_f32 v13, 0x3acccccd, v13
    v_cvt_pk_bf16_f32 v13, v13, v13
    v_and_b32 v13, 0xffff0000, v13
    v_add_f32 v13, 0x3727c5ac, v13
    v_cvt_pk_bf16_f32 v13, v13, v13
    v_and_b32 v13, 0xffff0000, v13
    v_sqrt_f32 v13, v13
    s_nop 0
    v_cvt_pk_bf16_f32 v13, v13, v13
    v_and_b32 v13, 0xffff0000, v13
    v_rcp_f32 v13, v13
    v_cvt_pk_bf16_f32 v12, v12, v12
    v_and_b32 v12, 0xffff0000, v12
    v_sub_f32 v16, v16, v12
    v_sub_f32 v17, v17, v12
    v_cvt_pk_bf16_f32 v14, v16, v17
    v_lshlrev_b32 v16, 16, v14
    v_and_b32 v17, 0xffff0000, v14
    v_mul_f32 v16, v16, v13
    v_mul_f32 v17, v17, v13
    v_cvt_pk_bf16_f32 v224, v16, v17

    v_sub_f32 v18, v18, v12
    v_sub_f32 v19, v19, v12
    v_cvt_pk_bf16_f32 v14, v18, v19
    v_lshlrev_b32 v18, 16, v14
    v_and_b32 v19, 0xffff0000, v14
    v_mul_f32 v18, v18, v13
    v_mul_f32 v19, v19, v13
    v_cvt_pk_bf16_f32 v225, v18, v19

    v_sub_f32 v20, v20, v12
    v_sub_f32 v21, v21, v12
    v_cvt_pk_bf16_f32 v14, v20, v21
    v_lshlrev_b32 v20, 16, v14
    v_and_b32 v21, 0xffff0000, v14
    v_mul_f32 v20, v20, v13
    v_mul_f32 v21, v21, v13
    v_cvt_pk_bf16_f32 v226, v20, v21

    v_sub_f32 v22, v22, v12
    v_sub_f32 v23, v23, v12
    v_cvt_pk_bf16_f32 v14, v22, v23
    v_lshlrev_b32 v22, 16, v14
    v_and_b32 v23, 0xffff0000, v14
    v_mul_f32 v22, v22, v13
    v_mul_f32 v23, v23, v13
    v_cvt_pk_bf16_f32 v227, v22, v23

    v_sub_f32 v24, v24, v12
    v_sub_f32 v25, v25, v12
    v_cvt_pk_bf16_f32 v14, v24, v25
    v_lshlrev_b32 v24, 16, v14
    v_and_b32 v25, 0xffff0000, v14
    v_mul_f32 v24, v24, v13
    v_mul_f32 v25, v25, v13
    v_cvt_pk_bf16_f32 v228, v24, v25

    v_sub_f32 v26, v26, v12
    v_sub_f32 v27, v27, v12
    v_cvt_pk_bf16_f32 v14, v26, v27
    v_lshlrev_b32 v26, 16, v14
    v_and_b32 v27, 0xffff0000, v14
    v_mul_f32 v26, v26, v13
    v_mul_f32 v27, v27, v13
    v_cvt_pk_bf16_f32 v229, v26, v27

    v_sub_f32 v28, v28, v12
    v_sub_f32 v29, v29, v12
    v_cvt_pk_bf16_f32 v14, v28, v29
    v_lshlrev_b32 v28, 16, v14
    v_and_b32 v29, 0xffff0000, v14
    v_mul_f32 v28, v28, v13
    v_mul_f32 v29, v29, v13
    v_cvt_pk_bf16_f32 v230, v28, v29

    v_sub_f32 v30, v30, v12
    v_sub_f32 v31, v31, v12
    v_cvt_pk_bf16_f32 v14, v30, v31
    v_lshlrev_b32 v30, 16, v14
    v_and_b32 v31, 0xffff0000, v14
    v_mul_f32 v30, v30, v13
    v_mul_f32 v31, v31, v13
    v_cvt_pk_bf16_f32 v231, v30, v31

    s_add_u32 s46, s46, 1
    s_cmp_lt_u32 s46, 4
    s_cbranch_scc1 boot_nrm
    s_cmp_lg_u32 s3, 0
    s_cbranch_scc1 boot_go2

dw_150:
    buffer_load_dword v12, off, s[12:15], 0 offset:164 sc1
    s_waitcnt vmcnt(0)
    v_readfirstlane_b32 s44, v12
    s_sub_u32 s30, s30, 1
    s_cmp_lt_i32 s30, 0
    s_cbranch_scc1 dwd_151
    s_cmp_ge_u32 s44, 1
    s_cbranch_scc1 dwd_151
    s_sleep 4
    s_branch dw_150

dwd_151:
boot_go2:
    s_barrier
    s_mov_b32 s40, 2560
    s_mov_b32 s41, 0

    buffer_load_dwordx4 v[32:35], v101, s[8:11], s40 offen offset:0 sc1
    buffer_load_dwordx4 v[36:39], v101, s[8:11], s40 offen offset:16 sc1
    buffer_load_dwordx4 v[40:43], v101, s[8:11], s40 offen offset:32 sc1
    buffer_load_dwordx4 v[44:47], v101, s[8:11], s40 offen offset:48 sc1
    buffer_load_dwordx4 v[48:51], v101, s[8:11], s41 offen offset:0 sc1
    buffer_load_dwordx4 v[52:55], v101, s[8:11], s41 offen offset:16 sc1
    buffer_load_dwordx4 v[56:59], v101, s[8:11], s41 offen offset:32 sc1
    buffer_load_dwordx4 v[60:63], v101, s[8:11], s41 offen offset:48 sc1
    v_lshlrev_b32 v100, 8, v2
    s_lshl_b32 s40, s3, 5
    v_add_u32 v100, s40, v100
    v_mov_b32 v10, 0x8000
    v_cndmask_b32 v100, v10, v100, s[76:77]
    v_lshrrev_b32 v10, 7, v3
    v_lshlrev_b32 v10, 8, v10
    v_and_b32 v11, 127, v3
    v_add_u32 v102, v10, v11
    s_lshr_b32 s40, s31, 1
    s_mul_i32 s40, s40, 20480
    s_and_b32 s41, s31, 1
    s_lshl_b32 s41, s41, 7
    s_add_u32 s40, s40, s41
    s_add_u32 s33, s40, 0x2400000
    s_add_u32 s34, s33, 1310720
    s_waitcnt vmcnt(0)

    v_add_f32 v32, 1.0, v32
    v_add_f32 v33, 1.0, v33
    v_cvt_pk_bf16_f32 v14, v32, v33
    v_lshlrev_b32 v32, 16, v14
    v_and_b32 v33, 0xffff0000, v14

    v_add_f32 v34, 1.0, v34
    v_add_f32 v35, 1.0, v35
    v_cvt_pk_bf16_f32 v14, v34, v35
    v_lshlrev_b32 v34, 16, v14
    v_and_b32 v35, 0xffff0000, v14

    v_add_f32 v36, 1.0, v36
    v_add_f32 v37, 1.0, v37
    v_cvt_pk_bf16_f32 v14, v36, v37
    v_lshlrev_b32 v36, 16, v14
    v_and_b32 v37, 0xffff0000, v14

    v_add_f32 v38, 1.0, v38
    v_add_f32 v39, 1.0, v39
    v_cvt_pk_bf16_f32 v14, v38, v39
    v_lshlrev_b32 v38, 16, v14
    v_and_b32 v39, 0xffff0000, v14

    v_add_f32 v40, 1.0, v40
    v_add_f32 v41, 1.0, v41
    v_cvt_pk_bf16_f32 v14, v40, v41
    v_lshlrev_b32 v40, 16, v14
    v_and_b32 v41, 0xffff0000, v14

    v_add_f32 v42, 1.0, v42
    v_add_f32 v43, 1.0, v43
    v_cvt_pk_bf16_f32 v14, v42, v43
    v_lshlrev_b32 v42, 16, v14
    v_and_b32 v43, 0xffff0000, v14

    v_add_f32 v44, 1.0, v44
    v_add_f32 v45, 1.0, v45
    v_cvt_pk_bf16_f32 v14, v44, v45
    v_lshlrev_b32 v44, 16, v14
    v_and_b32 v45, 0xffff0000, v14

    v_add_f32 v46, 1.0, v46
    v_add_f32 v47, 1.0, v47
    v_cvt_pk_bf16_f32 v14, v46, v47
    v_lshlrev_b32 v46, 16, v14
    v_and_b32 v47, 0xffff0000, v14

    s_lshr_b32 s47, s31, 5
    s_lshl_b32 s47, s47, 2
    s_mov_b32 s46, 0

boot_out:
    v_lshlrev_b32 v12, 16, v200
    v_and_b32 v13, 0xffff0000, v200
    v_mul_f32 v12, v12, v32
    v_mul_f32 v13, v13, v33
    v_cvt_pk_bf16_f32 v14, v12, v13
    v_lshlrev_b32 v12, 16, v14
    v_and_b32 v13, 0xffff0000, v14
    v_add_f32 v12, v12, v48
    v_add_f32 v13, v13, v49
    v_cvt_pk_bf16_f32 v64, v12, v13
    v_mov_b32 v200, v216

    v_lshlrev_b32 v12, 16, v208
    v_and_b32 v13, 0xffff0000, v208
    v_mul_f32 v12, v12, v32
    v_mul_f32 v13, v13, v33
    v_cvt_pk_bf16_f32 v14, v12, v13
    v_lshlrev_b32 v12, 16, v14
    v_and_b32 v13, 0xffff0000, v14
    v_add_f32 v12, v12, v48
    v_add_f32 v13, v13, v49
    v_cvt_pk_bf16_f32 v72, v12, v13
    v_mov_b32 v208, v224

    v_lshlrev_b32 v12, 16, v201
    v_and_b32 v13, 0xffff0000, v201
    v_mul_f32 v12, v12, v34
    v_mul_f32 v13, v13, v35
    v_cvt_pk_bf16_f32 v14, v12, v13
    v_lshlrev_b32 v12, 16, v14
    v_and_b32 v13, 0xffff0000, v14
    v_add_f32 v12, v12, v50
    v_add_f32 v13, v13, v51
    v_cvt_pk_bf16_f32 v66, v12, v13
    v_mov_b32 v201, v217

    v_lshlrev_b32 v12, 16, v209
    v_and_b32 v13, 0xffff0000, v209
    v_mul_f32 v12, v12, v34
    v_mul_f32 v13, v13, v35
    v_cvt_pk_bf16_f32 v14, v12, v13
    v_lshlrev_b32 v12, 16, v14
    v_and_b32 v13, 0xffff0000, v14
    v_add_f32 v12, v12, v50
    v_add_f32 v13, v13, v51
    v_cvt_pk_bf16_f32 v74, v12, v13
    v_mov_b32 v209, v225

    v_lshlrev_b32 v12, 16, v202
    v_and_b32 v13, 0xffff0000, v202
    v_mul_f32 v12, v12, v36
    v_mul_f32 v13, v13, v37
    v_cvt_pk_bf16_f32 v14, v12, v13
    v_lshlrev_b32 v12, 16, v14
    v_and_b32 v13, 0xffff0000, v14
    v_add_f32 v12, v12, v52
    v_add_f32 v13, v13, v53
    v_cvt_pk_bf16_f32 v68, v12, v13
    v_mov_b32 v202, v218

    v_lshlrev_b32 v12, 16, v210
    v_and_b32 v13, 0xffff0000, v210
    v_mul_f32 v12, v12, v36
    v_mul_f32 v13, v13, v37
    v_cvt_pk_bf16_f32 v14, v12, v13
    v_lshlrev_b32 v12, 16, v14
    v_and_b32 v13, 0xffff0000, v14
    v_add_f32 v12, v12, v52
    v_add_f32 v13, v13, v53
    v_cvt_pk_bf16_f32 v76, v12, v13
    v_mov_b32 v210, v226

    v_lshlrev_b32 v12, 16, v203
    v_and_b32 v13, 0xffff0000, v203
    v_mul_f32 v12, v12, v38
    v_mul_f32 v13, v13, v39
    v_cvt_pk_bf16_f32 v14, v12, v13
    v_lshlrev_b32 v12, 16, v14
    v_and_b32 v13, 0xffff0000, v14
    v_add_f32 v12, v12, v54
    v_add_f32 v13, v13, v55
    v_cvt_pk_bf16_f32 v70, v12, v13
    v_mov_b32 v203, v219

    v_lshlrev_b32 v12, 16, v211
    v_and_b32 v13, 0xffff0000, v211
    v_mul_f32 v12, v12, v38
    v_mul_f32 v13, v13, v39
    v_cvt_pk_bf16_f32 v14, v12, v13
    v_lshlrev_b32 v12, 16, v14
    v_and_b32 v13, 0xffff0000, v14
    v_add_f32 v12, v12, v54
    v_add_f32 v13, v13, v55
    v_cvt_pk_bf16_f32 v78, v12, v13
    v_mov_b32 v211, v227

    v_lshlrev_b32 v12, 16, v204
    v_and_b32 v13, 0xffff0000, v204
    v_mul_f32 v12, v12, v40
    v_mul_f32 v13, v13, v41
    v_cvt_pk_bf16_f32 v14, v12, v13
    v_lshlrev_b32 v12, 16, v14
    v_and_b32 v13, 0xffff0000, v14
    v_add_f32 v12, v12, v56
    v_add_f32 v13, v13, v57
    v_cvt_pk_bf16_f32 v65, v12, v13
    v_mov_b32 v204, v220

    v_lshlrev_b32 v12, 16, v212
    v_and_b32 v13, 0xffff0000, v212
    v_mul_f32 v12, v12, v40
    v_mul_f32 v13, v13, v41
    v_cvt_pk_bf16_f32 v14, v12, v13
    v_lshlrev_b32 v12, 16, v14
    v_and_b32 v13, 0xffff0000, v14
    v_add_f32 v12, v12, v56
    v_add_f32 v13, v13, v57
    v_cvt_pk_bf16_f32 v73, v12, v13
    v_mov_b32 v212, v228

    v_lshlrev_b32 v12, 16, v205
    v_and_b32 v13, 0xffff0000, v205
    v_mul_f32 v12, v12, v42
    v_mul_f32 v13, v13, v43
    v_cvt_pk_bf16_f32 v14, v12, v13
    v_lshlrev_b32 v12, 16, v14
    v_and_b32 v13, 0xffff0000, v14
    v_add_f32 v12, v12, v58
    v_add_f32 v13, v13, v59
    v_cvt_pk_bf16_f32 v67, v12, v13
    v_mov_b32 v205, v221

    v_lshlrev_b32 v12, 16, v213
    v_and_b32 v13, 0xffff0000, v213
    v_mul_f32 v12, v12, v42
    v_mul_f32 v13, v13, v43
    v_cvt_pk_bf16_f32 v14, v12, v13
    v_lshlrev_b32 v12, 16, v14
    v_and_b32 v13, 0xffff0000, v14
    v_add_f32 v12, v12, v58
    v_add_f32 v13, v13, v59
    v_cvt_pk_bf16_f32 v75, v12, v13
    v_mov_b32 v213, v229

    v_lshlrev_b32 v12, 16, v206
    v_and_b32 v13, 0xffff0000, v206
    v_mul_f32 v12, v12, v44
    v_mul_f32 v13, v13, v45
    v_cvt_pk_bf16_f32 v14, v12, v13
    v_lshlrev_b32 v12, 16, v14
    v_and_b32 v13, 0xffff0000, v14
    v_add_f32 v12, v12, v60
    v_add_f32 v13, v13, v61
    v_cvt_pk_bf16_f32 v69, v12, v13
    v_mov_b32 v206, v222

    v_lshlrev_b32 v12, 16, v214
    v_and_b32 v13, 0xffff0000, v214
    v_mul_f32 v12, v12, v44
    v_mul_f32 v13, v13, v45
    v_cvt_pk_bf16_f32 v14, v12, v13
    v_lshlrev_b32 v12, 16, v14
    v_and_b32 v13, 0xffff0000, v14
    v_add_f32 v12, v12, v60
    v_add_f32 v13, v13, v61
    v_cvt_pk_bf16_f32 v77, v12, v13
    v_mov_b32 v214, v230

    v_lshlrev_b32 v12, 16, v207
    v_and_b32 v13, 0xffff0000, v207
    v_mul_f32 v12, v12, v46
    v_mul_f32 v13, v13, v47
    v_cvt_pk_bf16_f32 v14, v12, v13
    v_lshlrev_b32 v12, 16, v14
    v_and_b32 v13, 0xffff0000, v14
    v_add_f32 v12, v12, v62
    v_add_f32 v13, v13, v63
    v_cvt_pk_bf16_f32 v71, v12, v13
    v_mov_b32 v207, v223

    v_lshlrev_b32 v12, 16, v215
    v_and_b32 v13, 0xffff0000, v215
    v_mul_f32 v12, v12, v46
    v_mul_f32 v13, v13, v47
    v_cvt_pk_bf16_f32 v14, v12, v13
    v_lshlrev_b32 v12, 16, v14
    v_and_b32 v13, 0xffff0000, v14
    v_add_f32 v12, v12, v62
    v_add_f32 v13, v13, v63
    v_cvt_pk_bf16_f32 v79, v12, v13
    v_mov_b32 v215, v231

    ds_write_b128 v100, v[64:67] offset:0
    ds_write_b128 v100, v[68:71] offset:128
    ds_write_b128 v100, v[72:75] offset:16
    ds_write_b128 v100, v[76:79] offset:144
    s_waitcnt lgkmcnt(0)
    s_barrier
    ds_read_b128 v[16:19], v3 offset:0
    ds_read_b128 v[20:23], v3 offset:4096
    ds_read_b128 v[24:27], v3 offset:8192
    s_waitcnt lgkmcnt(0)
    s_add_u32 s40, s33, 0
    buffer_store_dwordx4 v[16:19], v102, s[8:11], s40 offen sc1
    s_add_u32 s40, s33, 8192
    buffer_store_dwordx4 v[20:23], v102, s[8:11], s40 offen sc1
    s_cmp_ge_u32 s3, 2
    s_cbranch_scc1 boot_st
    s_add_u32 s40, s33, 16384
    buffer_store_dwordx4 v[24:27], v102, s[8:11], s40 offen sc1
boot_st:
    s_waitcnt vmcnt(0)
    s_barrier

    s_cmp_lg_u32 s3, 3
    s_cbranch_scc1 da_152
    s_mov_b64 exec, 1

    v_mov_b32 v12, 1
    buffer_atomic_add v12, off, s[12:15], s47 offset:64 sc0
    s_waitcnt vmcnt(0)
    v_cmp_eq_u32 vcc, 31, v12
    v_mov_b32 v12, 1
    s_cbranch_vccz ar_153
    buffer_store_dword v12, off, s[12:15], s47 offset:192 sc1
ar_153:

    s_mov_b64 exec, -1
da_152:

    s_mov_b32 s33, s34
    s_add_u32 s47, s47, 16
    s_add_u32 s46, s46, 1
    s_cmp_lt_u32 s46, 2
    s_cbranch_scc1 boot_out

    s_cmp_lg_u32 s3, 0
    s_cbranch_scc1 dwg_154

dw_155:
    buffer_load_dword v12, off, s[12:15], 0 offset:160 sc1
    s_waitcnt vmcnt(0)
    v_readfirstlane_b32 s44, v12
    s_sub_u32 s30, s30, 1
    s_cmp_lt_i32 s30, 0
    s_cbranch_scc1 dwd_156
    s_cmp_ge_u32 s44, 1
    s_cbranch_scc1 dwd_156
    s_sleep 6
    s_branch dw_155

dwd_156:
dw_157:
    buffer_load_dword v12, off, s[12:15], 0 offset:168 sc1
    s_waitcnt vmcnt(0)
    v_readfirstlane_b32 s44, v12
    s_sub_u32 s30, s30, 1
    s_cmp_lt_i32 s30, 0
    s_cbranch_scc1 dwd_158
    s_cmp_ge_u32 s44, 1
    s_cbranch_scc1 dwd_158
    s_sleep 6
    s_branch dw_157

dwd_158:
dwg_154:
    s_barrier
    s_branch boot_done
role_f:
    s_load_dwordx4 s[64:67], s[0:1], 64
    s_load_dwordx2 s[68:69], s[0:1], 80
    s_load_dwordx2 s[70:71], s[0:1], 104
    v_lshlrev_b32 v9, 7, v2
    s_mov_b32 s45, 0x10000
    s_mov_b32 s46, 1
    s_mov_b32 s47, 0
    s_waitcnt lgkmcnt(0)

wf_159:
    s_cmp_ge_u32 s47, s46
    s_cbranch_scc1 wfd_160
    buffer_load_dword v3, off, s[8:11], s45 sc1
    s_waitcnt vmcnt(0)
    v_readfirstlane_b32 s47, v3
    s_nop 3
    s_cmp_ge_u32 s47, s46
    s_cbranch_scc1 wfd_160
    s_sub_u32 s30, s30, 1
    s_cmp_lt_i32 s30, 0
    s_cbranch_scc1 wfd_160
    s_sleep 16
    s_branch wf_159

wfd_160:
    s_cmp_ge_u32 s28, 239
    s_cbranch_scc1 role_f2

    s_mov_b32 s31, s100
    s_sub_u32 s32, s28, 212
    s_cmp_ge_u32 s3, 2
    s_cselect_b32 s72, s66, s64
    s_cselect_b32 s73, s67, s65

    s_mov_b32 s16, s72
    s_and_b32 s17, s73, 0xffff
    s_mov_b32 s18, 0x21c000
    s_mov_b32 s19, 0x00020000
    v_lshrrev_b32 v10, 3, v2
    v_and_b32 v11, 7, v2
    v_bfe_u32 v12, v10, 1, 1
    s_and_b32 s40, s3, 1
    s_lshl_b32 s41, s40, 1
    v_or_b32 v12, s41, v12
    v_lshlrev_b32 v12, 1, v12
    v_xor_b32 v11, v11, v12
    v_lshlrev_b32 v11, 4, v11
    s_lshl_b32 s41, s40, 3
    v_add_u32 v10, s41, v10
    v_mul_u32_u24 v10, 3456, v10
    v_add_u32 v11, v10, v11
    s_lshl_b32 s42, s32, 7
    s_lshr_b32 s43, s3, 1
    s_mul_i32 s43, s43, 40960
    s_lshl_b32 s41, s41, 7
    s_add_u32 s43, s43, s41
    v_lshrrev_b32 v12, 4, v2
    v_bfe_u32 v13, v2, 2, 2
    v_and_b32 v14, 3, v2
    v_lshl_add_u32 v15, v12, 3, v13
    v_lshlrev_b32 v15, 7, v15
    v_lshl_add_u32 v15, v14, 3, v15
    v_lshrrev_b32 v13, 1, v13
    v_and_b32 v12, 1, v12
    v_lshl_or_b32 v13, v12, 1, v13
    v_lshl_or_b32 v15, v13, 5, v15
    s_lshl_b32 s41, s40, 6
    v_xor_b32 v16, s41, v15
    v_xor_b32 v17, 32, v16
    v_add_u32 v18, 40960, v16
    v_add_u32 v19, 40960, v17

    s_mov_b32 s44, s43
    s_mov_b32 m0, s44
    s_add_u32 s44, s44, 2048
    buffer_load_dwordx4 v11, s[16:19], s42 offen lds
    s_add_u32 s42, s42, 55296

    s_mov_b32 m0, s44
    s_add_u32 s44, s44, 2048
    buffer_load_dwordx4 v11, s[16:19], s42 offen lds
    s_add_u32 s42, s42, 55296

    s_mov_b32 m0, s44
    s_add_u32 s44, s44, 2048
    buffer_load_dwordx4 v11, s[16:19], s42 offen lds
    s_add_u32 s42, s42, 55296

    s_mov_b32 m0, s44
    s_add_u32 s44, s44, 2048
    buffer_load_dwordx4 v11, s[16:19], s42 offen lds
    s_add_u32 s42, s42, 55296

    s_mov_b32 m0, s44
    s_add_u32 s44, s44, 2048
    buffer_load_dwordx4 v11, s[16:19], s42 offen lds
    s_add_u32 s42, s42, 55296

    s_mov_b32 m0, s44
    s_add_u32 s44, s44, 2048
    buffer_load_dwordx4 v11, s[16:19], s42 offen lds
    s_add_u32 s42, s42, 55296

    s_mov_b32 m0, s44
    s_add_u32 s44, s44, 2048
    buffer_load_dwordx4 v11, s[16:19], s42 offen lds
    s_add_u32 s42, s42, 55296

    s_mov_b32 m0, s44
    s_add_u32 s44, s44, 2048
    buffer_load_dwordx4 v11, s[16:19], s42 offen lds
    s_add_u32 s42, s42, 55296

    s_mov_b32 m0, s44
    s_add_u32 s44, s44, 2048
    buffer_load_dwordx4 v11, s[16:19], s42 offen lds
    s_add_u32 s42, s42, 55296

    s_mov_b32 m0, s44
    s_add_u32 s44, s44, 2048
    buffer_load_dwordx4 v11, s[16:19], s42 offen lds
    s_add_u32 s42, s42, 55296

    s_mov_b32 m0, s44
    s_add_u32 s44, s44, 2048
    buffer_load_dwordx4 v11, s[16:19], s42 offen lds
    s_add_u32 s42, s42, 55296

    s_mov_b32 m0, s44
    s_add_u32 s44, s44, 2048
    buffer_load_dwordx4 v11, s[16:19], s42 offen lds
    s_add_u32 s42, s42, 55296

    s_mov_b32 m0, s44
    s_add_u32 s44, s44, 2048
    buffer_load_dwordx4 v11, s[16:19], s42 offen lds
    s_add_u32 s42, s42, 55296

    s_mov_b32 m0, s44
    s_add_u32 s44, s44, 2048
    buffer_load_dwordx4 v11, s[16:19], s42 offen lds
    s_add_u32 s42, s42, 55296

    s_mov_b32 m0, s44
    s_add_u32 s44, s44, 2048
    buffer_load_dwordx4 v11, s[16:19], s42 offen lds
    s_add_u32 s42, s42, 55296

    s_mov_b32 m0, s44
    s_add_u32 s44, s44, 2048
    buffer_load_dwordx4 v11, s[16:19], s42 offen lds
    s_add_u32 s42, s42, 55296

    s_mov_b32 m0, s44
    s_add_u32 s44, s44, 2048
    buffer_load_dwordx4 v11, s[16:19], s42 offen lds
    s_add_u32 s42, s42, 55296

    s_mov_b32 m0, s44
    s_add_u32 s44, s44, 2048
    buffer_load_dwordx4 v11, s[16:19], s42 offen lds
    s_add_u32 s42, s42, 55296

    s_mov_b32 m0, s44
    s_add_u32 s44, s44, 2048
    buffer_load_dwordx4 v11, s[16:19], s42 offen lds
    s_add_u32 s42, s42, 55296

    s_mov_b32 m0, s44
    s_add_u32 s44, s44, 2048
    buffer_load_dwordx4 v11, s[16:19], s42 offen lds
    s_add_u32 s42, s42, 55296

    s_waitcnt vmcnt(0)
    s_barrier
    ds_read_b64_tr_b16 a[0:1], v16 offset:0
    ds_read_b64_tr_b16 a[2:3], v16 offset:512
    ds_read_b64_tr_b16 a[80:81], v17 offset:0
    ds_read_b64_tr_b16 a[82:83], v17 offset:512
    ds_read_b64_tr_b16 a[160:161], v18 offset:0
    ds_read_b64_tr_b16 a[162:163], v18 offset:512
    ds_read_b64_tr_b16 a[240:241], v19 offset:0
    ds_read_b64_tr_b16 a[242:243], v19 offset:512
    s_waitcnt lgkmcnt(0)
    ds_read_b64_tr_b16 a[4:5], v16 offset:4096
    ds_read_b64_tr_b16 a[6:7], v16 offset:4608
    ds_read_b64_tr_b16 a[84:85], v17 offset:4096
    ds_read_b64_tr_b16 a[86:87], v17 offset:4608
    ds_read_b64_tr_b16 a[164:165], v18 offset:4096
    ds_read_b64_tr_b16 a[166:167], v18 offset:4608
    ds_read_b64_tr_b16 a[244:245], v19 offset:4096
    ds_read_b64_tr_b16 a[246:247], v19 offset:4608
    s_waitcnt lgkmcnt(0)
    ds_read_b64_tr_b16 a[8:9], v16 offset:8192
    ds_read_b64_tr_b16 a[10:11], v16 offset:8704
    ds_read_b64_tr_b16 a[88:89], v17 offset:8192
    ds_read_b64_tr_b16 a[90:91], v17 offset:8704
    ds_read_b64_tr_b16 a[168:169], v18 offset:8192
    ds_read_b64_tr_b16 a[170:171], v18 offset:8704
    ds_read_b64_tr_b16 a[248:249], v19 offset:8192
    ds_read_b64_tr_b16 a[250:251], v19 offset:8704
    s_waitcnt lgkmcnt(0)
    ds_read_b64_tr_b16 a[12:13], v16 offset:12288
    ds_read_b64_tr_b16 a[14:15], v16 offset:12800
    ds_read_b64_tr_b16 a[92:93], v17 offset:12288
    ds_read_b64_tr_b16 a[94:95], v17 offset:12800
    ds_read_b64_tr_b16 a[172:173], v18 offset:12288
    ds_read_b64_tr_b16 a[174:175], v18 offset:12800
    ds_read_b64_tr_b16 a[252:253], v19 offset:12288
    ds_read_b64_tr_b16 a[254:255], v19 offset:12800
    s_waitcnt lgkmcnt(0)
    ds_read_b64_tr_b16 a[16:17], v16 offset:16384
    ds_read_b64_tr_b16 a[18:19], v16 offset:16896
    ds_read_b64_tr_b16 a[96:97], v17 offset:16384
    ds_read_b64_tr_b16 a[98:99], v17 offset:16896
    ds_read_b64_tr_b16 a[176:177], v18 offset:16384
    ds_read_b64_tr_b16 a[178:179], v18 offset:16896
    ds_read_b64_tr_b16 v[192:193], v19 offset:16384
    ds_read_b64_tr_b16 v[194:195], v19 offset:16896
    s_waitcnt lgkmcnt(0)
    ds_read_b64_tr_b16 a[20:21], v16 offset:20480
    ds_read_b64_tr_b16 a[22:23], v16 offset:20992
    ds_read_b64_tr_b16 a[100:101], v17 offset:20480
    ds_read_b64_tr_b16 a[102:103], v17 offset:20992
    ds_read_b64_tr_b16 a[180:181], v18 offset:20480
    ds_read_b64_tr_b16 a[182:183], v18 offset:20992
    ds_read_b64_tr_b16 v[196:197], v19 offset:20480
    ds_read_b64_tr_b16 v[198:199], v19 offset:20992
    s_waitcnt lgkmcnt(0)
    ds_read_b64_tr_b16 a[24:25], v16 offset:24576
    ds_read_b64_tr_b16 a[26:27], v16 offset:25088
    ds_read_b64_tr_b16 a[104:105], v17 offset:24576
    ds_read_b64_tr_b16 a[106:107], v17 offset:25088
    ds_read_b64_tr_b16 a[184:185], v18 offset:24576
    ds_read_b64_tr_b16 a[186:187], v18 offset:25088
    ds_read_b64_tr_b16 v[200:201], v19 offset:24576
    ds_read_b64_tr_b16 v[202:203], v19 offset:25088
    s_waitcnt lgkmcnt(0)
    ds_read_b64_tr_b16 a[28:29], v16 offset:28672
    ds_read_b64_tr_b16 a[30:31], v16 offset:29184
    ds_read_b64_tr_b16 a[108:109], v17 offset:28672
    ds_read_b64_tr_b16 a[110:111], v17 offset:29184
    ds_read_b64_tr_b16 a[188:189], v18 offset:28672
    ds_read_b64_tr_b16 a[190:191], v18 offset:29184
    ds_read_b64_tr_b16 v[204:205], v19 offset:28672
    ds_read_b64_tr_b16 v[206:207], v19 offset:29184
    s_waitcnt lgkmcnt(0)
    ds_read_b64_tr_b16 a[32:33], v16 offset:32768
    ds_read_b64_tr_b16 a[34:35], v16 offset:33280
    ds_read_b64_tr_b16 a[112:113], v17 offset:32768
    ds_read_b64_tr_b16 a[114:115], v17 offset:33280
    ds_read_b64_tr_b16 a[192:193], v18 offset:32768
    ds_read_b64_tr_b16 a[194:195], v18 offset:33280
    ds_read_b64_tr_b16 v[208:209], v19 offset:32768
    ds_read_b64_tr_b16 v[210:211], v19 offset:33280
    s_waitcnt lgkmcnt(0)
    ds_read_b64_tr_b16 a[36:37], v16 offset:36864
    ds_read_b64_tr_b16 a[38:39], v16 offset:37376
    ds_read_b64_tr_b16 a[116:117], v17 offset:36864
    ds_read_b64_tr_b16 a[118:119], v17 offset:37376
    ds_read_b64_tr_b16 a[196:197], v18 offset:36864
    ds_read_b64_tr_b16 a[198:199], v18 offset:37376
    ds_read_b64_tr_b16 v[212:213], v19 offset:36864
    ds_read_b64_tr_b16 v[214:215], v19 offset:37376
    s_waitcnt lgkmcnt(0)
    s_barrier
    s_mov_b32 s44, s43
    s_mov_b32 m0, s44
    s_add_u32 s44, s44, 2048
    buffer_load_dwordx4 v11, s[16:19], s42 offen lds
    s_add_u32 s42, s42, 55296

    s_mov_b32 m0, s44
    s_add_u32 s44, s44, 2048
    buffer_load_dwordx4 v11, s[16:19], s42 offen lds
    s_add_u32 s42, s42, 55296

    s_mov_b32 m0, s44
    s_add_u32 s44, s44, 2048
    buffer_load_dwordx4 v11, s[16:19], s42 offen lds
    s_add_u32 s42, s42, 55296

    s_mov_b32 m0, s44
    s_add_u32 s44, s44, 2048
    buffer_load_dwordx4 v11, s[16:19], s42 offen lds
    s_add_u32 s42, s42, 55296

    s_mov_b32 m0, s44
    s_add_u32 s44, s44, 2048
    buffer_load_dwordx4 v11, s[16:19], s42 offen lds
    s_add_u32 s42, s42, 55296

    s_mov_b32 m0, s44
    s_add_u32 s44, s44, 2048
    buffer_load_dwordx4 v11, s[16:19], s42 offen lds
    s_add_u32 s42, s42, 55296

    s_mov_b32 m0, s44
    s_add_u32 s44, s44, 2048
    buffer_load_dwordx4 v11, s[16:19], s42 offen lds
    s_add_u32 s42, s42, 55296

    s_mov_b32 m0, s44
    s_add_u32 s44, s44, 2048
    buffer_load_dwordx4 v11, s[16:19], s42 offen lds
    s_add_u32 s42, s42, 55296

    s_mov_b32 m0, s44
    s_add_u32 s44, s44, 2048
    buffer_load_dwordx4 v11, s[16:19], s42 offen lds
    s_add_u32 s42, s42, 55296

    s_mov_b32 m0, s44
    s_add_u32 s44, s44, 2048
    buffer_load_dwordx4 v11, s[16:19], s42 offen lds
    s_add_u32 s42, s42, 55296

    s_mov_b32 m0, s44
    s_add_u32 s44, s44, 2048
    buffer_load_dwordx4 v11, s[16:19], s42 offen lds
    s_add_u32 s42, s42, 55296

    s_mov_b32 m0, s44
    s_add_u32 s44, s44, 2048
    buffer_load_dwordx4 v11, s[16:19], s42 offen lds
    s_add_u32 s42, s42, 55296

    s_mov_b32 m0, s44
    s_add_u32 s44, s44, 2048
    buffer_load_dwordx4 v11, s[16:19], s42 offen lds
    s_add_u32 s42, s42, 55296

    s_mov_b32 m0, s44
    s_add_u32 s44, s44, 2048
    buffer_load_dwordx4 v11, s[16:19], s42 offen lds
    s_add_u32 s42, s42, 55296

    s_mov_b32 m0, s44
    s_add_u32 s44, s44, 2048
    buffer_load_dwordx4 v11, s[16:19], s42 offen lds
    s_add_u32 s42, s42, 55296

    s_mov_b32 m0, s44
    s_add_u32 s44, s44, 2048
    buffer_load_dwordx4 v11, s[16:19], s42 offen lds
    s_add_u32 s42, s42, 55296

    s_mov_b32 m0, s44
    s_add_u32 s44, s44, 2048
    buffer_load_dwordx4 v11, s[16:19], s42 offen lds
    s_add_u32 s42, s42, 55296

    s_mov_b32 m0, s44
    s_add_u32 s44, s44, 2048
    buffer_load_dwordx4 v11, s[16:19], s42 offen lds
    s_add_u32 s42, s42, 55296

    s_mov_b32 m0, s44
    s_add_u32 s44, s44, 2048
    buffer_load_dwordx4 v11, s[16:19], s42 offen lds
    s_add_u32 s42, s42, 55296

    s_mov_b32 m0, s44
    s_add_u32 s44, s44, 2048
    buffer_load_dwordx4 v11, s[16:19], s42 offen lds
    s_add_u32 s42, s42, 55296

    s_waitcnt vmcnt(0)
    s_barrier
    ds_read_b64_tr_b16 a[40:41], v16 offset:0
    ds_read_b64_tr_b16 a[42:43], v16 offset:512
    ds_read_b64_tr_b16 a[120:121], v17 offset:0
    ds_read_b64_tr_b16 a[122:123], v17 offset:512
    ds_read_b64_tr_b16 a[200:201], v18 offset:0
    ds_read_b64_tr_b16 a[202:203], v18 offset:512
    ds_read_b64_tr_b16 v[216:217], v19 offset:0
    ds_read_b64_tr_b16 v[218:219], v19 offset:512
    s_waitcnt lgkmcnt(0)
    ds_read_b64_tr_b16 a[44:45], v16 offset:4096
    ds_read_b64_tr_b16 a[46:47], v16 offset:4608
    ds_read_b64_tr_b16 a[124:125], v17 offset:4096
    ds_read_b64_tr_b16 a[126:127], v17 offset:4608
    ds_read_b64_tr_b16 a[204:205], v18 offset:4096
    ds_read_b64_tr_b16 a[206:207], v18 offset:4608
    ds_read_b64_tr_b16 v[220:221], v19 offset:4096
    ds_read_b64_tr_b16 v[222:223], v19 offset:4608
    s_waitcnt lgkmcnt(0)
    ds_read_b64_tr_b16 a[48:49], v16 offset:8192
    ds_read_b64_tr_b16 a[50:51], v16 offset:8704
    ds_read_b64_tr_b16 a[128:129], v17 offset:8192
    ds_read_b64_tr_b16 a[130:131], v17 offset:8704
    ds_read_b64_tr_b16 a[208:209], v18 offset:8192
    ds_read_b64_tr_b16 a[210:211], v18 offset:8704
    ds_read_b64_tr_b16 v[224:225], v19 offset:8192
    ds_read_b64_tr_b16 v[226:227], v19 offset:8704
    s_waitcnt lgkmcnt(0)
    ds_read_b64_tr_b16 a[52:53], v16 offset:12288
    ds_read_b64_tr_b16 a[54:55], v16 offset:12800
    ds_read_b64_tr_b16 a[132:133], v17 offset:12288
    ds_read_b64_tr_b16 a[134:135], v17 offset:12800
    ds_read_b64_tr_b16 a[212:213], v18 offset:12288
    ds_read_b64_tr_b16 a[214:215], v18 offset:12800
    ds_read_b64_tr_b16 v[228:229], v19 offset:12288
    ds_read_b64_tr_b16 v[230:231], v19 offset:12800
    s_waitcnt lgkmcnt(0)
    ds_read_b64_tr_b16 a[56:57], v16 offset:16384
    ds_read_b64_tr_b16 a[58:59], v16 offset:16896
    ds_read_b64_tr_b16 a[136:137], v17 offset:16384
    ds_read_b64_tr_b16 a[138:139], v17 offset:16896
    ds_read_b64_tr_b16 a[216:217], v18 offset:16384
    ds_read_b64_tr_b16 a[218:219], v18 offset:16896
    ds_read_b64_tr_b16 v[232:233], v19 offset:16384
    ds_read_b64_tr_b16 v[234:235], v19 offset:16896
    s_waitcnt lgkmcnt(0)
    ds_read_b64_tr_b16 a[60:61], v16 offset:20480
    ds_read_b64_tr_b16 a[62:63], v16 offset:20992
    ds_read_b64_tr_b16 a[140:141], v17 offset:20480
    ds_read_b64_tr_b16 a[142:143], v17 offset:20992
    ds_read_b64_tr_b16 a[220:221], v18 offset:20480
    ds_read_b64_tr_b16 a[222:223], v18 offset:20992
    ds_read_b64_tr_b16 v[236:237], v19 offset:20480
    ds_read_b64_tr_b16 v[238:239], v19 offset:20992
    s_waitcnt lgkmcnt(0)
    ds_read_b64_tr_b16 a[64:65], v16 offset:24576
    ds_read_b64_tr_b16 a[66:67], v16 offset:25088
    ds_read_b64_tr_b16 a[144:145], v17 offset:24576
    ds_read_b64_tr_b16 a[146:147], v17 offset:25088
    ds_read_b64_tr_b16 a[224:225], v18 offset:24576
    ds_read_b64_tr_b16 a[226:227], v18 offset:25088
    ds_read_b64_tr_b16 v[240:241], v19 offset:24576
    ds_read_b64_tr_b16 v[242:243], v19 offset:25088
    s_waitcnt lgkmcnt(0)
    ds_read_b64_tr_b16 a[68:69], v16 offset:28672
    ds_read_b64_tr_b16 a[70:71], v16 offset:29184
    ds_read_b64_tr_b16 a[148:149], v17 offset:28672
    ds_read_b64_tr_b16 a[150:151], v17 offset:29184
    ds_read_b64_tr_b16 a[228:229], v18 offset:28672
    ds_read_b64_tr_b16 a[230:231], v18 offset:29184
    ds_read_b64_tr_b16 v[244:245], v19 offset:28672
    ds_read_b64_tr_b16 v[246:247], v19 offset:29184
    s_waitcnt lgkmcnt(0)
    ds_read_b64_tr_b16 a[72:73], v16 offset:32768
    ds_read_b64_tr_b16 a[74:75], v16 offset:33280
    ds_read_b64_tr_b16 a[152:153], v17 offset:32768
    ds_read_b64_tr_b16 a[154:155], v17 offset:33280
    ds_read_b64_tr_b16 a[232:233], v18 offset:32768
    ds_read_b64_tr_b16 a[234:235], v18 offset:33280
    ds_read_b64_tr_b16 v[248:249], v19 offset:32768
    ds_read_b64_tr_b16 v[250:251], v19 offset:33280
    s_waitcnt lgkmcnt(0)
    ds_read_b64_tr_b16 a[76:77], v16 offset:36864
    ds_read_b64_tr_b16 a[78:79], v16 offset:37376
    ds_read_b64_tr_b16 a[156:157], v17 offset:36864
    ds_read_b64_tr_b16 a[158:159], v17 offset:37376
    ds_read_b64_tr_b16 a[236:237], v18 offset:36864
    ds_read_b64_tr_b16 a[238:239], v18 offset:37376
    ds_read_b64_tr_b16 v[252:253], v19 offset:36864
    ds_read_b64_tr_b16 v[254:255], v19 offset:37376
    s_waitcnt lgkmcnt(0)
    s_barrier
    v_lshrrev_b32 v10, 3, v2
    v_and_b32 v15, 7, v2
    v_xor_b32 v15, v15, v10
    v_lshlrev_b32 v15, 4, v15
    v_mul_u32_u24 v10, 1280, v10
    v_add_u32 v15, v15, v10

    v_and_b32 v10, 7, v2
    v_lshrrev_b32 v11, 4, v2
    v_xor_b32 v11, v11, v10
    v_lshlrev_b32 v11, 4, v11
    v_lshl_add_u32 v11, v10, 7, v11
    v_bfe_u32 v10, v2, 3, 1
    v_mul_u32_u24 v10, 10240, v10
    v_add_u32 v23, v10, v11

    s_mov_b32 s33, s31
    s_mov_b32 s34, 0
    s_mov_b32 s35, 0x18200
    s_lshl_b32 s36, s32, 7
    s_lshl_b32 s40, s3, 2
    s_add_u32 s36, s36, s40
    s_add_u32 s36, s36, 0x19400
    s_mul_i32 s37, s31, 40960
    s_add_u32 s37, s37, 0x2c00000
    s_mov_b32 s38, 0
    s_lshl_b32 s40, s31, 1
    s_lshr_b32 s41, s3, 1
    s_add_u32 s40, s40, s41
    s_mul_i32 s39, s40, 55296
    s_lshl_b32 s40, s32, 1
    s_and_b32 s42, s3, 1
    s_add_u32 s40, s40, s42
    s_lshl_b32 s40, s40, 10
    s_add_u32 s39, s39, s40
    s_add_u32 s39, s39, 0x3000000
    s_mul_i32 s47, s41, 20480
    s_mov_b32 s57, 0xbfb8aa3b
    s_mov_b32 s46, 0
    s_add_u32 s56, s33, 1
    s_cmp_eq_u32 s100, 0
    s_cbranch_scc1 f1_prim
    s_add_u32 s36, s36, 15360

wa_161:
    s_mov_b32 exec_lo, 0xffffffff
    s_mov_b32 exec_hi, 0
    buffer_load_dword v20, v9, s[8:11], s35 offen sc1
    s_waitcnt vmcnt(0)

    v_cmp_gt_u32 vcc, s33, v20
    s_mov_b64 exec, -1
    s_cbranch_vccz wad_162
    s_sub_u32 s30, s30, 1
    s_cmp_lt_i32 s30, 0
    s_cbranch_scc1 wad_162
    s_sleep 32
    s_branch wa_161

wad_162:
f1_prim:
wa_163:
    s_mov_b32 exec_lo, 0xffffffff
    s_mov_b32 exec_hi, 0
    buffer_load_dword v20, v9, s[8:11], s35 offen sc1
    s_waitcnt vmcnt(0)

    v_cmp_gt_u32 vcc, s56, v20
    s_mov_b64 exec, -1
    s_cbranch_vccz wad_164
    s_sub_u32 s30, s30, 1
    s_cmp_lt_i32 s30, 0
    s_cbranch_scc1 wad_164
    s_sleep 4
    s_branch wa_163

wad_164:
    s_mul_i32 s43, s3, 10240
    s_add_u32 s44, s43, s37
    s_add_u32 s43, s43, s38

    s_mov_b32 m0, s43
    s_add_u32 s43, s43, 1024
    buffer_load_dwordx4 v15, s[8:11], s44 offen sc1 lds
    s_add_u32 s44, s44, 128

    s_mov_b32 m0, s43
    s_add_u32 s43, s43, 1024
    buffer_load_dwordx4 v15, s[8:11], s44 offen sc1 lds
    s_add_u32 s44, s44, 128

    s_mov_b32 m0, s43
    s_add_u32 s43, s43, 1024
    buffer_load_dwordx4 v15, s[8:11], s44 offen sc1 lds
    s_add_u32 s44, s44, 128

    s_mov_b32 m0, s43
    s_add_u32 s43, s43, 1024
    buffer_load_dwordx4 v15, s[8:11], s44 offen sc1 lds
    s_add_u32 s44, s44, 128

    s_mov_b32 m0, s43
    s_add_u32 s43, s43, 1024
    buffer_load_dwordx4 v15, s[8:11], s44 offen sc1 lds
    s_add_u32 s44, s44, 128

    s_mov_b32 m0, s43
    s_add_u32 s43, s43, 1024
    buffer_load_dwordx4 v15, s[8:11], s44 offen sc1 lds
    s_add_u32 s44, s44, 128

    s_mov_b32 m0, s43
    s_add_u32 s43, s43, 1024
    buffer_load_dwordx4 v15, s[8:11], s44 offen sc1 lds
    s_add_u32 s44, s44, 128

    s_mov_b32 m0, s43
    s_add_u32 s43, s43, 1024
    buffer_load_dwordx4 v15, s[8:11], s44 offen sc1 lds
    s_add_u32 s44, s44, 128

    s_mov_b32 m0, s43
    s_add_u32 s43, s43, 1024
    buffer_load_dwordx4 v15, s[8:11], s44 offen sc1 lds
    s_add_u32 s44, s44, 128

    s_mov_b32 m0, s43
    s_add_u32 s43, s43, 1024
    buffer_load_dwordx4 v15, s[8:11], s44 offen sc1 lds
    s_add_u32 s44, s44, 128

f1_loop:
    v_mov_b32 v3, s34
    s_add_u32 s40, s38, s47
    v_add_u32 v14, s40, v23
    v_xor_b32 v13, 64, v14
    s_sub_u32 s38, 40960, s38
    s_add_u32 s61, s33, 1
    s_cmp_ge_u32 s33, 54
    s_cselect_b32 s58, 2, 1
    s_mul_i32 s40, s58, 40960
    s_add_u32 s37, s37, s40
    s_add_u32 s33, s33, s58
    s_add_u32 s56, s33, 1
    s_cmp_lg_u32 s46, 0
    s_cbranch_scc1 f1_w1
    s_waitcnt vmcnt(0)
f1_w1:
    s_waitcnt vmcnt(2)
    s_cmp_eq_u32 s46, 2
    s_cbranch_scc0 f1_w2
    s_waitcnt vmcnt(1)
f1_w2:
    s_mov_b32 exec_lo, -1
    s_mov_b32 exec_hi, 0
    v_cmp_gt_u32 vcc, s56, v20
    s_mov_b64 exec, -1
    s_barrier

    s_mov_b32 s46, 0
    s_cbranch_vccnz f1_plain
    s_mov_b32 s46, 1

    s_mul_i32 s43, s3, 10240
    s_add_u32 s44, s43, s37
    s_add_u32 s43, s43, s38

    ds_read_b128 v[24:27], v14 offset:0
    ds_read_b128 v[28:31], v13 offset:0
    ds_read_b128 v[32:35], v14 offset:1024
    ds_read_b128 v[36:39], v13 offset:1024
    s_waitcnt lgkmcnt(3)
    v_mfma_f32_16x16x32_bf16 v[40:43], a[0:3], v[24:27], 0
    v_mfma_f32_16x16x32_bf16 v[44:47], a[80:83], v[24:27], 0
    s_mov_b32 m0, s43
    s_add_u32 s43, s43, 1024
    buffer_load_dwordx4 v15, s[8:11], s44 offen sc1 lds
    s_add_u32 s44, s44, 128

    v_mfma_f32_16x16x32_bf16 v[48:51], a[160:163], v[24:27], 0
    v_mfma_f32_16x16x32_bf16 v[52:55], a[240:243], v[24:27], 0
    ds_read_b128 v[24:27], v14 offset:2048
    s_waitcnt lgkmcnt(3)
    v_mfma_f32_16x16x32_bf16 v[40:43], a[4:7], v[28:31], v[40:43]
    v_mfma_f32_16x16x32_bf16 v[44:47], a[84:87], v[28:31], v[44:47]
    s_mov_b32 m0, s43
    s_add_u32 s43, s43, 1024
    buffer_load_dwordx4 v15, s[8:11], s44 offen sc1 lds
    s_add_u32 s44, s44, 128

    v_mfma_f32_16x16x32_bf16 v[48:51], a[164:167], v[28:31], v[48:51]
    v_mfma_f32_16x16x32_bf16 v[52:55], a[244:247], v[28:31], v[52:55]
    ds_read_b128 v[28:31], v13 offset:2048
    s_waitcnt lgkmcnt(3)
    v_mfma_f32_16x16x32_bf16 v[40:43], a[8:11], v[32:35], v[40:43]
    v_mfma_f32_16x16x32_bf16 v[44:47], a[88:91], v[32:35], v[44:47]
    v_mfma_f32_16x16x32_bf16 v[48:51], a[168:171], v[32:35], v[48:51]
    v_mfma_f32_16x16x32_bf16 v[52:55], a[248:251], v[32:35], v[52:55]
    ds_read_b128 v[32:35], v14 offset:3072
    s_waitcnt lgkmcnt(3)
    v_mfma_f32_16x16x32_bf16 v[40:43], a[12:15], v[36:39], v[40:43]
    v_mfma_f32_16x16x32_bf16 v[44:47], a[92:95], v[36:39], v[44:47]
    s_mov_b32 m0, s43
    s_add_u32 s43, s43, 1024
    buffer_load_dwordx4 v15, s[8:11], s44 offen sc1 lds
    s_add_u32 s44, s44, 128

    v_mfma_f32_16x16x32_bf16 v[48:51], a[172:175], v[36:39], v[48:51]
    v_mfma_f32_16x16x32_bf16 v[52:55], a[252:255], v[36:39], v[52:55]
    ds_read_b128 v[36:39], v13 offset:3072
    s_waitcnt lgkmcnt(3)
    v_mfma_f32_16x16x32_bf16 v[40:43], a[16:19], v[24:27], v[40:43]
    v_mfma_f32_16x16x32_bf16 v[44:47], a[96:99], v[24:27], v[44:47]
    s_mov_b32 m0, s43
    s_add_u32 s43, s43, 1024
    buffer_load_dwordx4 v15, s[8:11], s44 offen sc1 lds
    s_add_u32 s44, s44, 128

    v_mfma_f32_16x16x32_bf16 v[48:51], a[176:179], v[24:27], v[48:51]
    v_mfma_f32_16x16x32_bf16 v[52:55], v[192:195], v[24:27], v[52:55]
    ds_read_b128 v[24:27], v14 offset:4096
    s_waitcnt lgkmcnt(3)
    v_mfma_f32_16x16x32_bf16 v[40:43], a[20:23], v[28:31], v[40:43]
    v_mfma_f32_16x16x32_bf16 v[44:47], a[100:103], v[28:31], v[44:47]
    v_mfma_f32_16x16x32_bf16 v[48:51], a[180:183], v[28:31], v[48:51]
    v_mfma_f32_16x16x32_bf16 v[52:55], v[196:199], v[28:31], v[52:55]
    ds_read_b128 v[28:31], v13 offset:4096
    s_waitcnt lgkmcnt(3)
    v_mfma_f32_16x16x32_bf16 v[40:43], a[24:27], v[32:35], v[40:43]
    v_mfma_f32_16x16x32_bf16 v[44:47], a[104:107], v[32:35], v[44:47]
    s_mov_b32 m0, s43
    s_add_u32 s43, s43, 1024
    buffer_load_dwordx4 v15, s[8:11], s44 offen sc1 lds
    s_add_u32 s44, s44, 128

    v_mfma_f32_16x16x32_bf16 v[48:51], a[184:187], v[32:35], v[48:51]
    v_mfma_f32_16x16x32_bf16 v[52:55], v[200:203], v[32:35], v[52:55]
    ds_read_b128 v[32:35], v14 offset:5120
    s_waitcnt lgkmcnt(3)
    v_mfma_f32_16x16x32_bf16 v[40:43], a[28:31], v[36:39], v[40:43]
    v_mfma_f32_16x16x32_bf16 v[44:47], a[108:111], v[36:39], v[44:47]
    s_mov_b32 m0, s43
    s_add_u32 s43, s43, 1024
    buffer_load_dwordx4 v15, s[8:11], s44 offen sc1 lds
    s_add_u32 s44, s44, 128

    v_mfma_f32_16x16x32_bf16 v[48:51], a[188:191], v[36:39], v[48:51]
    v_mfma_f32_16x16x32_bf16 v[52:55], v[204:207], v[36:39], v[52:55]
    ds_read_b128 v[36:39], v13 offset:5120
    s_waitcnt lgkmcnt(3)
    v_mfma_f32_16x16x32_bf16 v[40:43], a[32:35], v[24:27], v[40:43]
    v_mfma_f32_16x16x32_bf16 v[44:47], a[112:115], v[24:27], v[44:47]
    v_mfma_f32_16x16x32_bf16 v[48:51], a[192:195], v[24:27], v[48:51]
    v_mfma_f32_16x16x32_bf16 v[52:55], v[208:211], v[24:27], v[52:55]
    ds_read_b128 v[24:27], v14 offset:6144
    s_waitcnt lgkmcnt(3)
    v_mfma_f32_16x16x32_bf16 v[40:43], a[36:39], v[28:31], v[40:43]
    v_mfma_f32_16x16x32_bf16 v[44:47], a[116:119], v[28:31], v[44:47]
    s_mov_b32 m0, s43
    s_add_u32 s43, s43, 1024
    buffer_load_dwordx4 v15, s[8:11], s44 offen sc1 lds
    s_add_u32 s44, s44, 128

    v_mfma_f32_16x16x32_bf16 v[48:51], a[196:199], v[28:31], v[48:51]
    v_mfma_f32_16x16x32_bf16 v[52:55], v[212:215], v[28:31], v[52:55]
    ds_read_b128 v[28:31], v13 offset:6144
    s_waitcnt lgkmcnt(3)
    v_mfma_f32_16x16x32_bf16 v[40:43], a[40:43], v[32:35], v[40:43]
    v_mfma_f32_16x16x32_bf16 v[44:47], a[120:123], v[32:35], v[44:47]
    s_mov_b32 m0, s43
    s_add_u32 s43, s43, 1024
    buffer_load_dwordx4 v15, s[8:11], s44 offen sc1 lds
    s_add_u32 s44, s44, 128

    v_mfma_f32_16x16x32_bf16 v[48:51], a[200:203], v[32:35], v[48:51]
    v_mfma_f32_16x16x32_bf16 v[52:55], v[216:219], v[32:35], v[52:55]
    ds_read_b128 v[32:35], v14 offset:7168
    s_waitcnt lgkmcnt(3)
    v_mfma_f32_16x16x32_bf16 v[40:43], a[44:47], v[36:39], v[40:43]
    v_mfma_f32_16x16x32_bf16 v[44:47], a[124:127], v[36:39], v[44:47]
    v_mfma_f32_16x16x32_bf16 v[48:51], a[204:207], v[36:39], v[48:51]
    v_mfma_f32_16x16x32_bf16 v[52:55], v[220:223], v[36:39], v[52:55]
    ds_read_b128 v[36:39], v13 offset:7168
    s_waitcnt lgkmcnt(3)
    v_mfma_f32_16x16x32_bf16 v[40:43], a[48:51], v[24:27], v[40:43]
    v_mfma_f32_16x16x32_bf16 v[44:47], a[128:131], v[24:27], v[44:47]
    s_mov_b32 m0, s43
    s_add_u32 s43, s43, 1024
    buffer_load_dwordx4 v15, s[8:11], s44 offen sc1 lds
    s_add_u32 s44, s44, 128

    v_mfma_f32_16x16x32_bf16 v[48:51], a[208:211], v[24:27], v[48:51]
    v_mfma_f32_16x16x32_bf16 v[52:55], v[224:227], v[24:27], v[52:55]
    ds_read_b128 v[24:27], v14 offset:8192
    s_waitcnt lgkmcnt(3)
    v_mfma_f32_16x16x32_bf16 v[40:43], a[52:55], v[28:31], v[40:43]
    v_mfma_f32_16x16x32_bf16 v[44:47], a[132:135], v[28:31], v[44:47]
    s_mov_b32 m0, s43
    s_add_u32 s43, s43, 1024
    buffer_load_dwordx4 v15, s[8:11], s44 offen sc1 lds
    s_add_u32 s44, s44, 128

    v_mfma_f32_16x16x32_bf16 v[48:51], a[212:215], v[28:31], v[48:51]
    v_mfma_f32_16x16x32_bf16 v[52:55], v[228:231], v[28:31], v[52:55]
    ds_read_b128 v[28:31], v13 offset:8192
    s_waitcnt lgkmcnt(3)
    v_mfma_f32_16x16x32_bf16 v[40:43], a[56:59], v[32:35], v[40:43]
    v_mfma_f32_16x16x32_bf16 v[44:47], a[136:139], v[32:35], v[44:47]
    v_mfma_f32_16x16x32_bf16 v[48:51], a[216:219], v[32:35], v[48:51]
    v_mfma_f32_16x16x32_bf16 v[52:55], v[232:235], v[32:35], v[52:55]
    ds_read_b128 v[32:35], v14 offset:9216
    s_waitcnt lgkmcnt(3)
    v_mfma_f32_16x16x32_bf16 v[40:43], a[60:63], v[36:39], v[40:43]
    v_mfma_f32_16x16x32_bf16 v[44:47], a[140:143], v[36:39], v[44:47]
    s_mov_b32 exec_lo, -1
    s_mov_b32 exec_hi, 0
    buffer_load_dword v20, v9, s[8:11], s35 offen sc1
    s_mov_b64 exec, -1

    v_mfma_f32_16x16x32_bf16 v[48:51], a[220:223], v[36:39], v[48:51]
    v_mfma_f32_16x16x32_bf16 v[52:55], v[236:239], v[36:39], v[52:55]
    ds_read_b128 v[36:39], v13 offset:9216
    s_waitcnt lgkmcnt(3)
    v_mfma_f32_16x16x32_bf16 v[40:43], a[64:67], v[24:27], v[40:43]
    v_mfma_f32_16x16x32_bf16 v[44:47], a[144:147], v[24:27], v[44:47]
    v_mfma_f32_16x16x32_bf16 v[48:51], a[224:227], v[24:27], v[48:51]
    v_mfma_f32_16x16x32_bf16 v[52:55], v[240:243], v[24:27], v[52:55]
    s_waitcnt lgkmcnt(2)
    v_mfma_f32_16x16x32_bf16 v[40:43], a[68:71], v[28:31], v[40:43]
    v_mfma_f32_16x16x32_bf16 v[44:47], a[148:151], v[28:31], v[44:47]
    v_mfma_f32_16x16x32_bf16 v[48:51], a[228:231], v[28:31], v[48:51]
    v_mfma_f32_16x16x32_bf16 v[52:55], v[244:247], v[28:31], v[52:55]
    s_waitcnt lgkmcnt(1)
    v_mfma_f32_16x16x32_bf16 v[40:43], a[72:75], v[32:35], v[40:43]
    v_mfma_f32_16x16x32_bf16 v[44:47], a[152:155], v[32:35], v[44:47]
    v_mfma_f32_16x16x32_bf16 v[48:51], a[232:235], v[32:35], v[48:51]
    v_mfma_f32_16x16x32_bf16 v[52:55], v[248:251], v[32:35], v[52:55]
    s_waitcnt lgkmcnt(0)
    v_mfma_f32_16x16x32_bf16 v[40:43], a[76:79], v[36:39], v[40:43]
    v_mfma_f32_16x16x32_bf16 v[44:47], a[156:159], v[36:39], v[44:47]
    v_mfma_f32_16x16x32_bf16 v[48:51], a[236:239], v[36:39], v[48:51]
    v_mfma_f32_16x16x32_bf16 v[52:55], v[252:255], v[36:39], v[52:55]
    s_waitcnt vmcnt(11)
    s_mov_b64 exec, 1
    buffer_store_dword v3, off, s[8:11], s36 sc1
    s_mov_b64 exec, -1
    s_branch f1_epi

f1_plain:
    s_mov_b32 exec_lo, -1
    s_mov_b32 exec_hi, 0
    buffer_load_dword v20, v9, s[8:11], s35 offen sc1
    s_mov_b64 exec, -1

    ds_read_b128 v[24:27], v14 offset:0
    ds_read_b128 v[28:31], v13 offset:0
    ds_read_b128 v[32:35], v14 offset:1024
    ds_read_b128 v[36:39], v13 offset:1024
    s_waitcnt lgkmcnt(3)
    v_mfma_f32_16x16x32_bf16 v[40:43], a[0:3], v[24:27], 0
    v_mfma_f32_16x16x32_bf16 v[44:47], a[80:83], v[24:27], 0
    v_mfma_f32_16x16x32_bf16 v[48:51], a[160:163], v[24:27], 0
    v_mfma_f32_16x16x32_bf16 v[52:55], a[240:243], v[24:27], 0
    ds_read_b128 v[24:27], v14 offset:2048
    s_waitcnt lgkmcnt(3)
    v_mfma_f32_16x16x32_bf16 v[40:43], a[4:7], v[28:31], v[40:43]
    v_mfma_f32_16x16x32_bf16 v[44:47], a[84:87], v[28:31], v[44:47]
    v_mfma_f32_16x16x32_bf16 v[48:51], a[164:167], v[28:31], v[48:51]
    v_mfma_f32_16x16x32_bf16 v[52:55], a[244:247], v[28:31], v[52:55]
    ds_read_b128 v[28:31], v13 offset:2048
    s_waitcnt lgkmcnt(3)
    v_mfma_f32_16x16x32_bf16 v[40:43], a[8:11], v[32:35], v[40:43]
    v_mfma_f32_16x16x32_bf16 v[44:47], a[88:91], v[32:35], v[44:47]
    v_mfma_f32_16x16x32_bf16 v[48:51], a[168:171], v[32:35], v[48:51]
    v_mfma_f32_16x16x32_bf16 v[52:55], a[248:251], v[32:35], v[52:55]
    ds_read_b128 v[32:35], v14 offset:3072
    s_waitcnt lgkmcnt(3)
    v_mfma_f32_16x16x32_bf16 v[40:43], a[12:15], v[36:39], v[40:43]
    v_mfma_f32_16x16x32_bf16 v[44:47], a[92:95], v[36:39], v[44:47]
    v_mfma_f32_16x16x32_bf16 v[48:51], a[172:175], v[36:39], v[48:51]
    v_mfma_f32_16x16x32_bf16 v[52:55], a[252:255], v[36:39], v[52:55]
    ds_read_b128 v[36:39], v13 offset:3072
    s_waitcnt lgkmcnt(3)
    v_mfma_f32_16x16x32_bf16 v[40:43], a[16:19], v[24:27], v[40:43]
    v_mfma_f32_16x16x32_bf16 v[44:47], a[96:99], v[24:27], v[44:47]
    v_mfma_f32_16x16x32_bf16 v[48:51], a[176:179], v[24:27], v[48:51]
    v_mfma_f32_16x16x32_bf16 v[52:55], v[192:195], v[24:27], v[52:55]
    ds_read_b128 v[24:27], v14 offset:4096
    s_waitcnt lgkmcnt(3)
    v_mfma_f32_16x16x32_bf16 v[40:43], a[20:23], v[28:31], v[40:43]
    v_mfma_f32_16x16x32_bf16 v[44:47], a[100:103], v[28:31], v[44:47]
    v_mfma_f32_16x16x32_bf16 v[48:51], a[180:183], v[28:31], v[48:51]
    v_mfma_f32_16x16x32_bf16 v[52:55], v[196:199], v[28:31], v[52:55]
    ds_read_b128 v[28:31], v13 offset:4096
    s_waitcnt lgkmcnt(3)
    v_mfma_f32_16x16x32_bf16 v[40:43], a[24:27], v[32:35], v[40:43]
    v_mfma_f32_16x16x32_bf16 v[44:47], a[104:107], v[32:35], v[44:47]
    v_mfma_f32_16x16x32_bf16 v[48:51], a[184:187], v[32:35], v[48:51]
    v_mfma_f32_16x16x32_bf16 v[52:55], v[200:203], v[32:35], v[52:55]
    ds_read_b128 v[32:35], v14 offset:5120
    s_waitcnt lgkmcnt(3)
    v_mfma_f32_16x16x32_bf16 v[40:43], a[28:31], v[36:39], v[40:43]
    v_mfma_f32_16x16x32_bf16 v[44:47], a[108:111], v[36:39], v[44:47]
    v_mfma_f32_16x16x32_bf16 v[48:51], a[188:191], v[36:39], v[48:51]
    v_mfma_f32_16x16x32_bf16 v[52:55], v[204:207], v[36:39], v[52:55]
    ds_read_b128 v[36:39], v13 offset:5120
    s_waitcnt lgkmcnt(3)
    v_mfma_f32_16x16x32_bf16 v[40:43], a[32:35], v[24:27], v[40:43]
    v_mfma_f32_16x16x32_bf16 v[44:47], a[112:115], v[24:27], v[44:47]
    v_mfma_f32_16x16x32_bf16 v[48:51], a[192:195], v[24:27], v[48:51]
    v_mfma_f32_16x16x32_bf16 v[52:55], v[208:211], v[24:27], v[52:55]
    ds_read_b128 v[24:27], v14 offset:6144
    s_waitcnt lgkmcnt(3)
    v_mfma_f32_16x16x32_bf16 v[40:43], a[36:39], v[28:31], v[40:43]
    v_mfma_f32_16x16x32_bf16 v[44:47], a[116:119], v[28:31], v[44:47]
    v_mfma_f32_16x16x32_bf16 v[48:51], a[196:199], v[28:31], v[48:51]
    v_mfma_f32_16x16x32_bf16 v[52:55], v[212:215], v[28:31], v[52:55]
    ds_read_b128 v[28:31], v13 offset:6144
    s_waitcnt lgkmcnt(3)
    v_mfma_f32_16x16x32_bf16 v[40:43], a[40:43], v[32:35], v[40:43]
    v_mfma_f32_16x16x32_bf16 v[44:47], a[120:123], v[32:35], v[44:47]
    v_mfma_f32_16x16x32_bf16 v[48:51], a[200:203], v[32:35], v[48:51]
    v_mfma_f32_16x16x32_bf16 v[52:55], v[216:219], v[32:35], v[52:55]
    ds_read_b128 v[32:35], v14 offset:7168
    s_waitcnt lgkmcnt(3)
    v_mfma_f32_16x16x32_bf16 v[40:43], a[44:47], v[36:39], v[40:43]
    v_mfma_f32_16x16x32_bf16 v[44:47], a[124:127], v[36:39], v[44:47]
    v_mfma_f32_16x16x32_bf16 v[48:51], a[204:207], v[36:39], v[48:51]
    v_mfma_f32_16x16x32_bf16 v[52:55], v[220:223], v[36:39], v[52:55]
    ds_read_b128 v[36:39], v13 offset:7168
    s_waitcnt lgkmcnt(3)
    v_mfma_f32_16x16x32_bf16 v[40:43], a[48:51], v[24:27], v[40:43]
    v_mfma_f32_16x16x32_bf16 v[44:47], a[128:131], v[24:27], v[44:47]
    v_mfma_f32_16x16x32_bf16 v[48:51], a[208:211], v[24:27], v[48:51]
    v_mfma_f32_16x16x32_bf16 v[52:55], v[224:227], v[24:27], v[52:55]
    ds_read_b128 v[24:27], v14 offset:8192
    s_waitcnt lgkmcnt(3)
    v_mfma_f32_16x16x32_bf16 v[40:43], a[52:55], v[28:31], v[40:43]
    v_mfma_f32_16x16x32_bf16 v[44:47], a[132:135], v[28:31], v[44:47]
    v_mfma_f32_16x16x32_bf16 v[48:51], a[212:215], v[28:31], v[48:51]
    v_mfma_f32_16x16x32_bf16 v[52:55], v[228:231], v[28:31], v[52:55]
    ds_read_b128 v[28:31], v13 offset:8192
    s_waitcnt lgkmcnt(3)
    v_mfma_f32_16x16x32_bf16 v[40:43], a[56:59], v[32:35], v[40:43]
    v_mfma_f32_16x16x32_bf16 v[44:47], a[136:139], v[32:35], v[44:47]
    v_mfma_f32_16x16x32_bf16 v[48:51], a[216:219], v[32:35], v[48:51]
    v_mfma_f32_16x16x32_bf16 v[52:55], v[232:235], v[32:35], v[52:55]
    ds_read_b128 v[32:35], v14 offset:9216
    s_waitcnt lgkmcnt(3)
    v_mfma_f32_16x16x32_bf16 v[40:43], a[60:63], v[36:39], v[40:43]
    v_mfma_f32_16x16x32_bf16 v[44:47], a[140:143], v[36:39], v[44:47]
    v_mfma_f32_16x16x32_bf16 v[48:51], a[220:223], v[36:39], v[48:51]
    v_mfma_f32_16x16x32_bf16 v[52:55], v[236:239], v[36:39], v[52:55]
    ds_read_b128 v[36:39], v13 offset:9216
    s_waitcnt lgkmcnt(3)
    v_mfma_f32_16x16x32_bf16 v[40:43], a[64:67], v[24:27], v[40:43]
    v_mfma_f32_16x16x32_bf16 v[44:47], a[144:147], v[24:27], v[44:47]
    v_mfma_f32_16x16x32_bf16 v[48:51], a[224:227], v[24:27], v[48:51]
    v_mfma_f32_16x16x32_bf16 v[52:55], v[240:243], v[24:27], v[52:55]
    s_waitcnt lgkmcnt(2)
    v_mfma_f32_16x16x32_bf16 v[40:43], a[68:71], v[28:31], v[40:43]
    v_mfma_f32_16x16x32_bf16 v[44:47], a[148:151], v[28:31], v[44:47]
    v_mfma_f32_16x16x32_bf16 v[48:51], a[228:231], v[28:31], v[48:51]
    v_mfma_f32_16x16x32_bf16 v[52:55], v[244:247], v[28:31], v[52:55]
    s_waitcnt lgkmcnt(1)
    v_mfma_f32_16x16x32_bf16 v[40:43], a[72:75], v[32:35], v[40:43]
    v_mfma_f32_16x16x32_bf16 v[44:47], a[152:155], v[32:35], v[44:47]
    v_mfma_f32_16x16x32_bf16 v[48:51], a[232:235], v[32:35], v[48:51]
    v_mfma_f32_16x16x32_bf16 v[52:55], v[248:251], v[32:35], v[52:55]
    s_waitcnt lgkmcnt(0)
    v_mfma_f32_16x16x32_bf16 v[40:43], a[76:79], v[36:39], v[40:43]
    v_mfma_f32_16x16x32_bf16 v[44:47], a[156:159], v[36:39], v[44:47]
    v_mfma_f32_16x16x32_bf16 v[48:51], a[236:239], v[36:39], v[48:51]
    v_mfma_f32_16x16x32_bf16 v[52:55], v[252:255], v[36:39], v[52:55]
    s_waitcnt vmcnt(0)
    s_mov_b64 exec, 1
    buffer_store_dword v3, off, s[8:11], s36 sc1
    s_mov_b32 exec_lo, -1
    s_mov_b32 exec_hi, 0
    v_cmp_gt_u32 vcc, s56, v20
    s_mov_b64 exec, -1
    s_cbranch_vccnz f1_epi
    s_mov_b32 s46, 2

    s_mul_i32 s43, s3, 10240
    s_add_u32 s44, s43, s37
    s_add_u32 s43, s43, s38

    s_mov_b32 m0, s43
    s_add_u32 s43, s43, 1024
    buffer_load_dwordx4 v15, s[8:11], s44 offen sc1 lds
    s_add_u32 s44, s44, 128

    s_mov_b32 m0, s43
    s_add_u32 s43, s43, 1024
    buffer_load_dwordx4 v15, s[8:11], s44 offen sc1 lds
    s_add_u32 s44, s44, 128

    s_mov_b32 m0, s43
    s_add_u32 s43, s43, 1024
    buffer_load_dwordx4 v15, s[8:11], s44 offen sc1 lds
    s_add_u32 s44, s44, 128

    s_mov_b32 m0, s43
    s_add_u32 s43, s43, 1024
    buffer_load_dwordx4 v15, s[8:11], s44 offen sc1 lds
    s_add_u32 s44, s44, 128

    s_mov_b32 m0, s43
    s_add_u32 s43, s43, 1024
    buffer_load_dwordx4 v15, s[8:11], s44 offen sc1 lds
    s_add_u32 s44, s44, 128

    s_mov_b32 m0, s43
    s_add_u32 s43, s43, 1024
    buffer_load_dwordx4 v15, s[8:11], s44 offen sc1 lds
    s_add_u32 s44, s44, 128

    s_mov_b32 m0, s43
    s_add_u32 s43, s43, 1024
    buffer_load_dwordx4 v15, s[8:11], s44 offen sc1 lds
    s_add_u32 s44, s44, 128

    s_mov_b32 m0, s43
    s_add_u32 s43, s43, 1024
    buffer_load_dwordx4 v15, s[8:11], s44 offen sc1 lds
    s_add_u32 s44, s44, 128

    s_mov_b32 m0, s43
    s_add_u32 s43, s43, 1024
    buffer_load_dwordx4 v15, s[8:11], s44 offen sc1 lds
    s_add_u32 s44, s44, 128

    s_mov_b32 m0, s43
    s_add_u32 s43, s43, 1024
    buffer_load_dwordx4 v15, s[8:11], s44 offen sc1 lds
    s_add_u32 s44, s44, 128

f1_epi:
    s_nop 3
    v_cvt_pk_bf16_f32 v64, v40, v41
    v_lshlrev_b32 v40, 16, v64
    v_and_b32 v41, 0xffff0000, v64
    v_cvt_pk_bf16_f32 v65, v48, v49
    v_lshlrev_b32 v48, 16, v65
    v_and_b32 v49, 0xffff0000, v65
    v_mul_f32 v66, s57, v40
    v_mul_f32 v67, s57, v41
    v_exp_f32 v66, v66
    v_exp_f32 v67, v67
    s_nop 0
    v_add_f32 v66, 1.0, v66
    v_add_f32 v67, 1.0, v67
    v_rcp_f32 v66, v66
    v_rcp_f32 v67, v67
    s_nop 0
    v_mul_f32 v40, v40, v66
    v_mul_f32 v41, v41, v67

    v_cvt_pk_bf16_f32 v64, v40, v41
    v_lshlrev_b32 v40, 16, v64
    v_and_b32 v41, 0xffff0000, v64
    v_mul_f32 v40, v40, v48
    v_mul_f32 v41, v41, v49
    v_cvt_pk_bf16_f32 v60, v40, v41

    v_cvt_pk_bf16_f32 v64, v42, v43
    v_lshlrev_b32 v42, 16, v64
    v_and_b32 v43, 0xffff0000, v64
    v_cvt_pk_bf16_f32 v65, v50, v51
    v_lshlrev_b32 v50, 16, v65
    v_and_b32 v51, 0xffff0000, v65
    v_mul_f32 v66, s57, v42
    v_mul_f32 v67, s57, v43
    v_exp_f32 v66, v66
    v_exp_f32 v67, v67
    s_nop 0
    v_add_f32 v66, 1.0, v66
    v_add_f32 v67, 1.0, v67
    v_rcp_f32 v66, v66
    v_rcp_f32 v67, v67
    s_nop 0
    v_mul_f32 v42, v42, v66
    v_mul_f32 v43, v43, v67

    v_cvt_pk_bf16_f32 v64, v42, v43
    v_lshlrev_b32 v42, 16, v64
    v_and_b32 v43, 0xffff0000, v64
    v_mul_f32 v42, v42, v50
    v_mul_f32 v43, v43, v51
    v_cvt_pk_bf16_f32 v61, v42, v43

    v_cvt_pk_bf16_f32 v64, v44, v45
    v_lshlrev_b32 v44, 16, v64
    v_and_b32 v45, 0xffff0000, v64
    v_cvt_pk_bf16_f32 v65, v52, v53
    v_lshlrev_b32 v52, 16, v65
    v_and_b32 v53, 0xffff0000, v65
    v_mul_f32 v66, s57, v44
    v_mul_f32 v67, s57, v45
    v_exp_f32 v66, v66
    v_exp_f32 v67, v67
    s_nop 0
    v_add_f32 v66, 1.0, v66
    v_add_f32 v67, 1.0, v67
    v_rcp_f32 v66, v66
    v_rcp_f32 v67, v67
    s_nop 0
    v_mul_f32 v44, v44, v66
    v_mul_f32 v45, v45, v67

    v_cvt_pk_bf16_f32 v64, v44, v45
    v_lshlrev_b32 v44, 16, v64
    v_and_b32 v45, 0xffff0000, v64
    v_mul_f32 v44, v44, v52
    v_mul_f32 v45, v45, v53
    v_cvt_pk_bf16_f32 v62, v44, v45

    v_cvt_pk_bf16_f32 v64, v46, v47
    v_lshlrev_b32 v46, 16, v64
    v_and_b32 v47, 0xffff0000, v64
    v_cvt_pk_bf16_f32 v65, v54, v55
    v_lshlrev_b32 v54, 16, v65
    v_and_b32 v55, 0xffff0000, v65
    v_mul_f32 v66, s57, v46
    v_mul_f32 v67, s57, v47
    v_exp_f32 v66, v66
    v_exp_f32 v67, v67
    s_nop 0
    v_add_f32 v66, 1.0, v66
    v_add_f32 v67, 1.0, v67
    v_rcp_f32 v66, v66
    v_rcp_f32 v67, v67
    s_nop 0
    v_mul_f32 v46, v46, v66
    v_mul_f32 v47, v47, v67

    v_cvt_pk_bf16_f32 v64, v46, v47
    v_lshlrev_b32 v46, 16, v64
    v_and_b32 v47, 0xffff0000, v64
    v_mul_f32 v46, v46, v54
    v_mul_f32 v47, v47, v55
    v_cvt_pk_bf16_f32 v63, v46, v47

    v_min_u32 v60, -2, v60
    v_min_u32 v61, -2, v61
    v_min_u32 v62, -2, v62
    v_min_u32 v63, -2, v63
    buffer_store_dwordx4 v[60:63], v5, s[8:11], s39 offen sc1
    s_mul_i32 s40, s58, 110592
    s_add_u32 s39, s39, s40
    s_mov_b32 s34, s61

    s_add_u32 s29, s29, 1
    s_cmp_ge_u32 s33, 64
    s_cbranch_scc1 f1_fin
    s_cmp_lg_u32 s46, 0
    s_cbranch_scc1 f1_loop
    s_cmp_gt_u32 s34, 56
    s_cbranch_scc1 f1_late
    v_mov_b32 v3, s34
    s_waitcnt vmcnt(0)
    s_mov_b64 exec, 1
    buffer_store_dword v3, off, s[8:11], s36 sc1
    s_mov_b64 exec, -1
    s_cmp_ge_u32 s33, 56
    s_cbranch_scc1 f1_late

wa_165:
    s_mov_b32 exec_lo, 0xffffffff
    s_mov_b32 exec_hi, 0
    buffer_load_dword v20, v9, s[8:11], s35 offen sc1
    s_waitcnt vmcnt(0)

    v_cmp_gt_u32 vcc, s56, v20
    s_mov_b64 exec, -1
    s_cbranch_vccz wad_166
    s_sub_u32 s30, s30, 1
    s_cmp_lt_i32 s30, 0
    s_cbranch_scc1 wad_166
    s_sleep 4
    s_branch wa_165

wad_166:
    s_mul_i32 s43, s3, 10240
    s_add_u32 s44, s43, s37
    s_add_u32 s43, s43, s38

    s_mov_b32 m0, s43
    s_add_u32 s43, s43, 1024
    buffer_load_dwordx4 v15, s[8:11], s44 offen sc1 lds
    s_add_u32 s44, s44, 128

    s_mov_b32 m0, s43
    s_add_u32 s43, s43, 1024
    buffer_load_dwordx4 v15, s[8:11], s44 offen sc1 lds
    s_add_u32 s44, s44, 128

    s_mov_b32 m0, s43
    s_add_u32 s43, s43, 1024
    buffer_load_dwordx4 v15, s[8:11], s44 offen sc1 lds
    s_add_u32 s44, s44, 128

    s_mov_b32 m0, s43
    s_add_u32 s43, s43, 1024
    buffer_load_dwordx4 v15, s[8:11], s44 offen sc1 lds
    s_add_u32 s44, s44, 128

    s_mov_b32 m0, s43
    s_add_u32 s43, s43, 1024
    buffer_load_dwordx4 v15, s[8:11], s44 offen sc1 lds
    s_add_u32 s44, s44, 128

    s_mov_b32 m0, s43
    s_add_u32 s43, s43, 1024
    buffer_load_dwordx4 v15, s[8:11], s44 offen sc1 lds
    s_add_u32 s44, s44, 128

    s_mov_b32 m0, s43
    s_add_u32 s43, s43, 1024
    buffer_load_dwordx4 v15, s[8:11], s44 offen sc1 lds
    s_add_u32 s44, s44, 128

    s_mov_b32 m0, s43
    s_add_u32 s43, s43, 1024
    buffer_load_dwordx4 v15, s[8:11], s44 offen sc1 lds
    s_add_u32 s44, s44, 128

    s_mov_b32 m0, s43
    s_add_u32 s43, s43, 1024
    buffer_load_dwordx4 v15, s[8:11], s44 offen sc1 lds
    s_add_u32 s44, s44, 128

    s_mov_b32 m0, s43
    s_add_u32 s43, s43, 1024
    buffer_load_dwordx4 v15, s[8:11], s44 offen sc1 lds
    s_add_u32 s44, s44, 128

    s_branch f1_loop
f1_late:
    s_lshl_b32 s45, s33, 7
    s_add_u32 s45, s45, 0x1a500
    s_mov_b32 s59, 20
    s_mov_b32 s60, 0

wf_167:
    s_cmp_ge_u32 s60, s59
    s_cbranch_scc1 wfd_168
    buffer_load_dword v22, off, s[8:11], s45 sc1
    s_waitcnt vmcnt(0)
    v_readfirstlane_b32 s60, v22
    s_nop 3
    s_cmp_ge_u32 s60, s59
    s_cbranch_scc1 wfd_168
    s_sub_u32 s30, s30, 1
    s_cmp_lt_i32 s30, 0
    s_cbranch_scc1 wfd_168
    s_sleep 3
    s_branch wf_167

wfd_168:
f1_late2:
    s_mul_i32 s43, s3, 10240
    s_add_u32 s44, s43, s37
    s_add_u32 s43, s43, s38

    s_mov_b32 m0, s43
    s_add_u32 s43, s43, 1024
    buffer_load_dwordx4 v15, s[8:11], s44 offen sc1 lds
    s_add_u32 s44, s44, 128

    s_mov_b32 m0, s43
    s_add_u32 s43, s43, 1024
    buffer_load_dwordx4 v15, s[8:11], s44 offen sc1 lds
    s_add_u32 s44, s44, 128

    s_mov_b32 m0, s43
    s_add_u32 s43, s43, 1024
    buffer_load_dwordx4 v15, s[8:11], s44 offen sc1 lds
    s_add_u32 s44, s44, 128

    s_mov_b32 m0, s43
    s_add_u32 s43, s43, 1024
    buffer_load_dwordx4 v15, s[8:11], s44 offen sc1 lds
    s_add_u32 s44, s44, 128

    s_mov_b32 m0, s43
    s_add_u32 s43, s43, 1024
    buffer_load_dwordx4 v15, s[8:11], s44 offen sc1 lds
    s_add_u32 s44, s44, 128

    s_mov_b32 m0, s43
    s_add_u32 s43, s43, 1024
    buffer_load_dwordx4 v15, s[8:11], s44 offen sc1 lds
    s_add_u32 s44, s44, 128

    s_mov_b32 m0, s43
    s_add_u32 s43, s43, 1024
    buffer_load_dwordx4 v15, s[8:11], s44 offen sc1 lds
    s_add_u32 s44, s44, 128

    s_mov_b32 m0, s43
    s_add_u32 s43, s43, 1024
    buffer_load_dwordx4 v15, s[8:11], s44 offen sc1 lds
    s_add_u32 s44, s44, 128

    s_mov_b32 m0, s43
    s_add_u32 s43, s43, 1024
    buffer_load_dwordx4 v15, s[8:11], s44 offen sc1 lds
    s_add_u32 s44, s44, 128

    s_mov_b32 m0, s43
    s_add_u32 s43, s43, 1024
    buffer_load_dwordx4 v15, s[8:11], s44 offen sc1 lds
    s_add_u32 s44, s44, 128

    s_sub_u32 s43, s43, 10240
    v_add_u32 v21, s43, v5
    s_waitcnt vmcnt(0)

    ds_read_b128 v[72:75], v21 offset:0
    ds_read_b128 v[76:79], v21 offset:1024
    ds_read_b128 v[80:83], v21 offset:2048
    ds_read_b128 v[84:87], v21 offset:3072
    ds_read_b128 v[88:91], v21 offset:4096
    ds_read_b128 v[92:95], v21 offset:5120
    ds_read_b128 v[96:99], v21 offset:6144
    ds_read_b128 v[100:103], v21 offset:7168
    ds_read_b128 v[104:107], v21 offset:8192
    ds_read_b128 v[108:111], v21 offset:9216
    s_waitcnt lgkmcnt(0)
    v_max3_u32 v22, v72, v73, v74
    v_max3_u32 v22, v22, v75, v76
    v_max3_u32 v22, v22, v77, v78
    v_max3_u32 v22, v22, v79, v80
    v_max3_u32 v22, v22, v81, v82
    v_max3_u32 v22, v22, v83, v84
    v_max3_u32 v22, v22, v85, v86
    v_max3_u32 v22, v22, v87, v88
    v_max3_u32 v22, v22, v89, v90
    v_max3_u32 v22, v22, v91, v92
    v_max3_u32 v22, v22, v93, v94
    v_max3_u32 v22, v22, v95, v96
    v_max3_u32 v22, v22, v97, v98
    v_max3_u32 v22, v22, v99, v100
    v_max3_u32 v22, v22, v101, v102
    v_max3_u32 v22, v22, v103, v104
    v_max3_u32 v22, v22, v105, v106
    v_max3_u32 v22, v22, v107, v108
    v_max3_u32 v22, v22, v109, v110
    v_max_u32 v22, v22, v111
    v_cmp_eq_u32 vcc, -1, v22
    s_cbranch_vccz pok_169
    s_sub_u32 s30, s30, 1
    s_cmp_lt_i32 s30, 0
    s_cbranch_scc1 pok_169
    s_sleep 3
    s_branch f1_late2

pok_169:
    s_branch f1_loop
f1_fin:
    v_mov_b32 v3, s34
    s_waitcnt vmcnt(0)
    s_mov_b64 exec, 1
    buffer_store_dword v3, off, s[8:11], s36 sc1
    s_endpgm

role_f2:
    s_mov_b32 s16, s68
    s_and_b32 s17, s69, 0xffff
    s_mov_b32 s18, 0x21c000
    s_mov_b32 s19, 0x00020000
    s_mov_b32 s20, s70
    s_and_b32 s21, s71, 0xffff
    s_mov_b32 s22, 0x280000
    s_mov_b32 s23, 0x00020000
    s_sub_u32 s40, s28, 239
    s_mul_i32 s31, s40, 6554
    s_lshr_b32 s31, s31, 16
    s_mul_i32 s41, s31, 10
    s_sub_u32 s32, s40, s41
    s_mul_i32 s37, s3, 13
    s_min_u32 s40, s3, 1
    s_add_u32 s37, s37, s40
    v_lshrrev_b32 v10, 3, v2
    v_and_b32 v11, 7, v2
    v_bfe_u32 v12, v10, 1, 2
    v_lshlrev_b32 v12, 1, v12
    v_xor_b32 v11, v11, v12
    v_lshlrev_b32 v11, 4, v11
    v_mul_u32_u24 v10, 1280, v10
    v_add_u32 v11, v10, v11
    s_mul_i32 s42, s37, 40960
    s_lshl_b32 s40, s32, 7
    s_add_u32 s42, s42, s40
    s_mul_i32 s43, s3, 28672
    v_lshrrev_b32 v12, 4, v2
    v_bfe_u32 v13, v2, 2, 2
    v_and_b32 v14, 3, v2
    v_lshl_add_u32 v15, v12, 2, v13
    v_lshlrev_b32 v15, 7, v15
    v_lshl_add_u32 v15, v14, 3, v15
    v_lshrrev_b32 v13, 1, v13
    v_and_b32 v12, 1, v12
    v_lshl_or_b32 v13, v12, 1, v13
    v_lshl_or_b32 v15, v13, 5, v15

    v_xor_b32 v16, 0, v15
    v_add_u32 v16, s43, v16
    v_xor_b32 v17, 32, v15
    v_add_u32 v17, s43, v17
    v_xor_b32 v18, 64, v15
    v_add_u32 v18, s43, v18
    v_xor_b32 v19, 96, v15
    v_add_u32 v19, s43, v19
    s_mov_b32 s44, s43
    s_mov_b32 m0, s44
    s_add_u32 s44, s44, 1024
    buffer_load_dwordx4 v11, s[16:19], s42 offen lds
    s_add_u32 s42, s42, 10240

    s_mov_b32 m0, s44
    s_add_u32 s44, s44, 1024
    buffer_load_dwordx4 v11, s[16:19], s42 offen lds
    s_add_u32 s42, s42, 10240

    s_mov_b32 m0, s44
    s_add_u32 s44, s44, 1024
    buffer_load_dwordx4 v11, s[16:19], s42 offen lds
    s_add_u32 s42, s42, 10240

    s_mov_b32 m0, s44
    s_add_u32 s44, s44, 1024
    buffer_load_dwordx4 v11, s[16:19], s42 offen lds
    s_add_u32 s42, s42, 10240

    s_mov_b32 m0, s44
    s_add_u32 s44, s44, 1024
    buffer_load_dwordx4 v11, s[16:19], s42 offen lds
    s_add_u32 s42, s42, 10240

    s_mov_b32 m0, s44
    s_add_u32 s44, s44, 1024
    buffer_load_dwordx4 v11, s[16:19], s42 offen lds
    s_add_u32 s42, s42, 10240

    s_mov_b32 m0, s44
    s_add_u32 s44, s44, 1024
    buffer_load_dwordx4 v11, s[16:19], s42 offen lds
    s_add_u32 s42, s42, 10240

    s_mov_b32 m0, s44
    s_add_u32 s44, s44, 1024
    buffer_load_dwordx4 v11, s[16:19], s42 offen lds
    s_add_u32 s42, s42, 10240

    s_mov_b32 m0, s44
    s_add_u32 s44, s44, 1024
    buffer_load_dwordx4 v11, s[16:19], s42 offen lds
    s_add_u32 s42, s42, 10240

    s_mov_b32 m0, s44
    s_add_u32 s44, s44, 1024
    buffer_load_dwordx4 v11, s[16:19], s42 offen lds
    s_add_u32 s42, s42, 10240

    s_mov_b32 m0, s44
    s_add_u32 s44, s44, 1024
    buffer_load_dwordx4 v11, s[16:19], s42 offen lds
    s_add_u32 s42, s42, 10240

    s_mov_b32 m0, s44
    s_add_u32 s44, s44, 1024
    buffer_load_dwordx4 v11, s[16:19], s42 offen lds
    s_add_u32 s42, s42, 10240

    s_mov_b32 m0, s44
    s_add_u32 s44, s44, 1024
    buffer_load_dwordx4 v11, s[16:19], s42 offen lds
    s_add_u32 s42, s42, 10240

    s_mov_b32 m0, s44
    s_add_u32 s44, s44, 1024
    buffer_load_dwordx4 v11, s[16:19], s42 offen lds
    s_add_u32 s42, s42, 10240

    s_mov_b32 m0, s44
    s_add_u32 s44, s44, 1024
    buffer_load_dwordx4 v11, s[16:19], s42 offen lds
    s_add_u32 s42, s42, 10240

    s_mov_b32 m0, s44
    s_add_u32 s44, s44, 1024
    buffer_load_dwordx4 v11, s[16:19], s42 offen lds
    s_add_u32 s42, s42, 10240

    s_mov_b32 m0, s44
    s_add_u32 s44, s44, 1024
    buffer_load_dwordx4 v11, s[16:19], s42 offen lds
    s_add_u32 s42, s42, 10240

    s_mov_b32 m0, s44
    s_add_u32 s44, s44, 1024
    buffer_load_dwordx4 v11, s[16:19], s42 offen lds
    s_add_u32 s42, s42, 10240

    s_mov_b32 m0, s44
    s_add_u32 s44, s44, 1024
    buffer_load_dwordx4 v11, s[16:19], s42 offen lds
    s_add_u32 s42, s42, 10240

    s_mov_b32 m0, s44
    s_add_u32 s44, s44, 1024
    buffer_load_dwordx4 v11, s[16:19], s42 offen lds
    s_add_u32 s42, s42, 10240

    s_mov_b32 m0, s44
    s_add_u32 s44, s44, 1024
    buffer_load_dwordx4 v11, s[16:19], s42 offen lds
    s_add_u32 s42, s42, 10240

    s_mov_b32 m0, s44
    s_add_u32 s44, s44, 1024
    buffer_load_dwordx4 v11, s[16:19], s42 offen lds
    s_add_u32 s42, s42, 10240

    s_mov_b32 m0, s44
    s_add_u32 s44, s44, 1024
    buffer_load_dwordx4 v11, s[16:19], s42 offen lds
    s_add_u32 s42, s42, 10240

    s_mov_b32 m0, s44
    s_add_u32 s44, s44, 1024
    buffer_load_dwordx4 v11, s[16:19], s42 offen lds
    s_add_u32 s42, s42, 10240

    s_mov_b32 m0, s44
    s_add_u32 s44, s44, 1024
    buffer_load_dwordx4 v11, s[16:19], s42 offen lds
    s_add_u32 s42, s42, 10240

    s_mov_b32 m0, s44
    s_add_u32 s44, s44, 1024
    buffer_load_dwordx4 v11, s[16:19], s42 offen lds
    s_add_u32 s42, s42, 10240

    s_mov_b32 m0, s44
    s_add_u32 s44, s44, 1024
    buffer_load_dwordx4 v11, s[16:19], s42 offen lds
    s_add_u32 s42, s42, 10240

    s_mov_b32 m0, s44
    s_add_u32 s44, s44, 1024
    buffer_load_dwordx4 v11, s[16:19], s42 offen lds
    s_add_u32 s42, s42, 10240

    s_waitcnt vmcnt(0)
    ds_read_b64_tr_b16 a[0:1], v16 offset:0
    ds_read_b64_tr_b16 a[2:3], v16 offset:2048
    ds_read_b64_tr_b16 a[4:5], v17 offset:0
    ds_read_b64_tr_b16 a[6:7], v17 offset:2048
    ds_read_b64_tr_b16 a[8:9], v18 offset:0
    ds_read_b64_tr_b16 a[10:11], v18 offset:2048
    ds_read_b64_tr_b16 a[12:13], v19 offset:0
    ds_read_b64_tr_b16 a[14:15], v19 offset:2048
    s_waitcnt lgkmcnt(0)
    ds_read_b64_tr_b16 a[16:17], v16 offset:4096
    ds_read_b64_tr_b16 a[18:19], v16 offset:6144
    ds_read_b64_tr_b16 a[20:21], v17 offset:4096
    ds_read_b64_tr_b16 a[22:23], v17 offset:6144
    ds_read_b64_tr_b16 a[24:25], v18 offset:4096
    ds_read_b64_tr_b16 a[26:27], v18 offset:6144
    ds_read_b64_tr_b16 a[28:29], v19 offset:4096
    ds_read_b64_tr_b16 a[30:31], v19 offset:6144
    s_waitcnt lgkmcnt(0)
    ds_read_b64_tr_b16 a[32:33], v16 offset:8192
    ds_read_b64_tr_b16 a[34:35], v16 offset:10240
    ds_read_b64_tr_b16 a[36:37], v17 offset:8192
    ds_read_b64_tr_b16 a[38:39], v17 offset:10240
    ds_read_b64_tr_b16 a[40:41], v18 offset:8192
    ds_read_b64_tr_b16 a[42:43], v18 offset:10240
    ds_read_b64_tr_b16 a[44:45], v19 offset:8192
    ds_read_b64_tr_b16 a[46:47], v19 offset:10240
    s_waitcnt lgkmcnt(0)
    ds_read_b64_tr_b16 a[48:49], v16 offset:12288
    ds_read_b64_tr_b16 a[50:51], v16 offset:14336
    ds_read_b64_tr_b16 a[52:53], v17 offset:12288
    ds_read_b64_tr_b16 a[54:55], v17 offset:14336
    ds_read_b64_tr_b16 a[56:57], v18 offset:12288
    ds_read_b64_tr_b16 a[58:59], v18 offset:14336
    ds_read_b64_tr_b16 a[60:61], v19 offset:12288
    ds_read_b64_tr_b16 a[62:63], v19 offset:14336
    s_waitcnt lgkmcnt(0)
    ds_read_b64_tr_b16 a[64:65], v16 offset:16384
    ds_read_b64_tr_b16 a[66:67], v16 offset:18432
    ds_read_b64_tr_b16 a[68:69], v17 offset:16384
    ds_read_b64_tr_b16 a[70:71], v17 offset:18432
    ds_read_b64_tr_b16 a[72:73], v18 offset:16384
    ds_read_b64_tr_b16 a[74:75], v18 offset:18432
    ds_read_b64_tr_b16 a[76:77], v19 offset:16384
    ds_read_b64_tr_b16 a[78:79], v19 offset:18432
    s_waitcnt lgkmcnt(0)
    ds_read_b64_tr_b16 a[80:81], v16 offset:20480
    ds_read_b64_tr_b16 a[82:83], v16 offset:22528
    ds_read_b64_tr_b16 a[84:85], v17 offset:20480
    ds_read_b64_tr_b16 a[86:87], v17 offset:22528
    ds_read_b64_tr_b16 a[88:89], v18 offset:20480
    ds_read_b64_tr_b16 a[90:91], v18 offset:22528
    ds_read_b64_tr_b16 a[92:93], v19 offset:20480
    ds_read_b64_tr_b16 a[94:95], v19 offset:22528
    s_waitcnt lgkmcnt(0)
    ds_read_b64_tr_b16 a[96:97], v16 offset:24576
    ds_read_b64_tr_b16 a[98:99], v16 offset:26624
    ds_read_b64_tr_b16 a[100:101], v17 offset:24576
    ds_read_b64_tr_b16 a[102:103], v17 offset:26624
    ds_read_b64_tr_b16 a[104:105], v18 offset:24576
    ds_read_b64_tr_b16 a[106:107], v18 offset:26624
    ds_read_b64_tr_b16 a[108:109], v19 offset:24576
    ds_read_b64_tr_b16 a[110:111], v19 offset:26624
    s_waitcnt lgkmcnt(0)
    s_mov_b32 s44, s43
    s_mov_b32 m0, s44
    s_add_u32 s44, s44, 1024
    buffer_load_dwordx4 v11, s[16:19], s42 offen lds
    s_add_u32 s42, s42, 10240

    s_mov_b32 m0, s44
    s_add_u32 s44, s44, 1024
    buffer_load_dwordx4 v11, s[16:19], s42 offen lds
    s_add_u32 s42, s42, 10240

    s_mov_b32 m0, s44
    s_add_u32 s44, s44, 1024
    buffer_load_dwordx4 v11, s[16:19], s42 offen lds
    s_add_u32 s42, s42, 10240

    s_mov_b32 m0, s44
    s_add_u32 s44, s44, 1024
    buffer_load_dwordx4 v11, s[16:19], s42 offen lds
    s_add_u32 s42, s42, 10240

    s_mov_b32 m0, s44
    s_add_u32 s44, s44, 1024
    buffer_load_dwordx4 v11, s[16:19], s42 offen lds
    s_add_u32 s42, s42, 10240

    s_mov_b32 m0, s44
    s_add_u32 s44, s44, 1024
    buffer_load_dwordx4 v11, s[16:19], s42 offen lds
    s_add_u32 s42, s42, 10240

    s_mov_b32 m0, s44
    s_add_u32 s44, s44, 1024
    buffer_load_dwordx4 v11, s[16:19], s42 offen lds
    s_add_u32 s42, s42, 10240

    s_mov_b32 m0, s44
    s_add_u32 s44, s44, 1024
    buffer_load_dwordx4 v11, s[16:19], s42 offen lds
    s_add_u32 s42, s42, 10240

    s_mov_b32 m0, s44
    s_add_u32 s44, s44, 1024
    buffer_load_dwordx4 v11, s[16:19], s42 offen lds
    s_add_u32 s42, s42, 10240

    s_mov_b32 m0, s44
    s_add_u32 s44, s44, 1024
    buffer_load_dwordx4 v11, s[16:19], s42 offen lds
    s_add_u32 s42, s42, 10240

    s_mov_b32 m0, s44
    s_add_u32 s44, s44, 1024
    buffer_load_dwordx4 v11, s[16:19], s42 offen lds
    s_add_u32 s42, s42, 10240

    s_mov_b32 m0, s44
    s_add_u32 s44, s44, 1024
    buffer_load_dwordx4 v11, s[16:19], s42 offen lds
    s_add_u32 s42, s42, 10240

    s_mov_b32 m0, s44
    s_add_u32 s44, s44, 1024
    buffer_load_dwordx4 v11, s[16:19], s42 offen lds
    s_add_u32 s42, s42, 10240

    s_mov_b32 m0, s44
    s_add_u32 s44, s44, 1024
    buffer_load_dwordx4 v11, s[16:19], s42 offen lds
    s_add_u32 s42, s42, 10240

    s_mov_b32 m0, s44
    s_add_u32 s44, s44, 1024
    buffer_load_dwordx4 v11, s[16:19], s42 offen lds
    s_add_u32 s42, s42, 10240

    s_mov_b32 m0, s44
    s_add_u32 s44, s44, 1024
    buffer_load_dwordx4 v11, s[16:19], s42 offen lds
    s_add_u32 s42, s42, 10240

    s_mov_b32 m0, s44
    s_add_u32 s44, s44, 1024
    buffer_load_dwordx4 v11, s[16:19], s42 offen lds
    s_add_u32 s42, s42, 10240

    s_mov_b32 m0, s44
    s_add_u32 s44, s44, 1024
    buffer_load_dwordx4 v11, s[16:19], s42 offen lds
    s_add_u32 s42, s42, 10240

    s_mov_b32 m0, s44
    s_add_u32 s44, s44, 1024
    buffer_load_dwordx4 v11, s[16:19], s42 offen lds
    s_add_u32 s42, s42, 10240

    s_mov_b32 m0, s44
    s_add_u32 s44, s44, 1024
    buffer_load_dwordx4 v11, s[16:19], s42 offen lds
    s_add_u32 s42, s42, 10240

    s_mov_b32 m0, s44
    s_add_u32 s44, s44, 1024
    buffer_load_dwordx4 v11, s[16:19], s42 offen lds
    s_add_u32 s42, s42, 10240

    s_mov_b32 m0, s44
    s_add_u32 s44, s44, 1024
    buffer_load_dwordx4 v11, s[16:19], s42 offen lds
    s_add_u32 s42, s42, 10240

    s_mov_b32 m0, s44
    s_add_u32 s44, s44, 1024
    buffer_load_dwordx4 v11, s[16:19], s42 offen lds
    s_add_u32 s42, s42, 10240

    s_mov_b32 m0, s44
    s_add_u32 s44, s44, 1024
    buffer_load_dwordx4 v11, s[16:19], s42 offen lds
    s_add_u32 s42, s42, 10240

    s_mov_b32 m0, s44
    s_add_u32 s44, s44, 1024
    buffer_load_dwordx4 v11, s[16:19], s42 offen lds
    s_add_u32 s42, s42, 10240

    s_mov_b32 m0, s44
    s_add_u32 s44, s44, 1024
    buffer_load_dwordx4 v11, s[16:19], s42 offen lds
    s_add_u32 s42, s42, 10240

    s_mov_b32 m0, s44
    s_add_u32 s44, s44, 1024
    buffer_load_dwordx4 v11, s[16:19], s42 offen lds
    s_add_u32 s42, s42, 10240

    s_mov_b32 m0, s44
    s_add_u32 s44, s44, 1024
    buffer_load_dwordx4 v11, s[16:19], s42 offen lds
    s_add_u32 s42, s42, 10240

    s_waitcnt vmcnt(0)
    ds_read_b64_tr_b16 a[112:113], v16 offset:0
    ds_read_b64_tr_b16 a[114:115], v16 offset:2048
    ds_read_b64_tr_b16 a[116:117], v17 offset:0
    ds_read_b64_tr_b16 a[118:119], v17 offset:2048
    ds_read_b64_tr_b16 a[120:121], v18 offset:0
    ds_read_b64_tr_b16 a[122:123], v18 offset:2048
    ds_read_b64_tr_b16 a[124:125], v19 offset:0
    ds_read_b64_tr_b16 a[126:127], v19 offset:2048
    s_waitcnt lgkmcnt(0)
    ds_read_b64_tr_b16 a[128:129], v16 offset:4096
    ds_read_b64_tr_b16 a[130:131], v16 offset:6144
    ds_read_b64_tr_b16 a[132:133], v17 offset:4096
    ds_read_b64_tr_b16 a[134:135], v17 offset:6144
    ds_read_b64_tr_b16 a[136:137], v18 offset:4096
    ds_read_b64_tr_b16 a[138:139], v18 offset:6144
    ds_read_b64_tr_b16 a[140:141], v19 offset:4096
    ds_read_b64_tr_b16 a[142:143], v19 offset:6144
    s_waitcnt lgkmcnt(0)
    ds_read_b64_tr_b16 a[144:145], v16 offset:8192
    ds_read_b64_tr_b16 a[146:147], v16 offset:10240
    ds_read_b64_tr_b16 a[148:149], v17 offset:8192
    ds_read_b64_tr_b16 a[150:151], v17 offset:10240
    ds_read_b64_tr_b16 a[152:153], v18 offset:8192
    ds_read_b64_tr_b16 a[154:155], v18 offset:10240
    ds_read_b64_tr_b16 a[156:157], v19 offset:8192
    ds_read_b64_tr_b16 a[158:159], v19 offset:10240
    s_waitcnt lgkmcnt(0)
    ds_read_b64_tr_b16 a[160:161], v16 offset:12288
    ds_read_b64_tr_b16 a[162:163], v16 offset:14336
    ds_read_b64_tr_b16 a[164:165], v17 offset:12288
    ds_read_b64_tr_b16 a[166:167], v17 offset:14336
    ds_read_b64_tr_b16 a[168:169], v18 offset:12288
    ds_read_b64_tr_b16 a[170:171], v18 offset:14336
    ds_read_b64_tr_b16 a[172:173], v19 offset:12288
    ds_read_b64_tr_b16 a[174:175], v19 offset:14336
    s_waitcnt lgkmcnt(0)
    ds_read_b64_tr_b16 a[176:177], v16 offset:16384
    ds_read_b64_tr_b16 a[178:179], v16 offset:18432
    ds_read_b64_tr_b16 a[180:181], v17 offset:16384
    ds_read_b64_tr_b16 a[182:183], v17 offset:18432
    ds_read_b64_tr_b16 a[184:185], v18 offset:16384
    ds_read_b64_tr_b16 a[186:187], v18 offset:18432
    ds_read_b64_tr_b16 a[188:189], v19 offset:16384
    ds_read_b64_tr_b16 a[190:191], v19 offset:18432
    s_waitcnt lgkmcnt(0)
    ds_read_b64_tr_b16 a[192:193], v16 offset:20480
    ds_read_b64_tr_b16 a[194:195], v16 offset:22528
    ds_read_b64_tr_b16 a[196:197], v17 offset:20480
    ds_read_b64_tr_b16 a[198:199], v17 offset:22528
    ds_read_b64_tr_b16 a[200:201], v18 offset:20480
    ds_read_b64_tr_b16 a[202:203], v18 offset:22528
    ds_read_b64_tr_b16 a[204:205], v19 offset:20480
    ds_read_b64_tr_b16 a[206:207], v19 offset:22528
    s_waitcnt lgkmcnt(0)
    ds_read_b64_tr_b16 a[208:209], v16 offset:24576
    ds_read_b64_tr_b16 a[210:211], v16 offset:26624
    ds_read_b64_tr_b16 a[212:213], v17 offset:24576
    ds_read_b64_tr_b16 a[214:215], v17 offset:26624
    ds_read_b64_tr_b16 a[216:217], v18 offset:24576
    ds_read_b64_tr_b16 a[218:219], v18 offset:26624
    ds_read_b64_tr_b16 a[220:221], v19 offset:24576
    ds_read_b64_tr_b16 a[222:223], v19 offset:26624
    s_waitcnt lgkmcnt(0)
    s_cmp_lt_u32 s3, 2
    s_cbranch_scc1 f2_nz

    v_accvgpr_write_b32 a0, 0
    v_accvgpr_write_b32 a1, 0
    v_accvgpr_write_b32 a2, 0
    v_accvgpr_write_b32 a3, 0
    v_accvgpr_write_b32 a4, 0
    v_accvgpr_write_b32 a5, 0
    v_accvgpr_write_b32 a6, 0
    v_accvgpr_write_b32 a7, 0
    v_accvgpr_write_b32 a8, 0
    v_accvgpr_write_b32 a9, 0
    v_accvgpr_write_b32 a10, 0
    v_accvgpr_write_b32 a11, 0
    v_accvgpr_write_b32 a12, 0
    v_accvgpr_write_b32 a13, 0
    v_accvgpr_write_b32 a14, 0
    v_accvgpr_write_b32 a15, 0
f2_nz:
    s_barrier
    s_mov_b32 s33, s31
    s_mov_b32 s34, 1
    s_lshr_b32 s35, s31, 1
    s_lshl_b32 s35, s35, 12
    s_add_u32 s35, s35, 0x19400
    s_mul_i32 s38, s31, 55296
    s_lshl_b32 s40, s37, 10
    s_add_u32 s38, s38, s40
    s_add_u32 s38, s38, 0x3000000
    s_lshl_b32 s40, s3, 10
    v_add_u32 v12, s40, v5
    s_lshl_b32 s40, s3, 12
    v_add_u32 v13, s40, v5
    v_and_b32 v10, 15, v2
    v_mul_u32_u24 v10, 1280, v10
    v_lshrrev_b32 v11, 4, v2
    v_lshl_add_u32 v14, v11, 3, v10
    v_lshlrev_b32 v11, 4, v11
    s_lshl_b32 s40, s32, 2
    s_add_u32 s40, s40, s3
    s_lshl_b32 s39, s40, 5
    s_mul_i32 s41, s31, 20480
    s_add_u32 s39, s39, s41
    s_lshl_b32 s40, s40, 6
    s_add_u32 s40, s40, 12800
    buffer_load_dwordx4 v[200:203], v11, s[8:11], s40 offen sc1
    v_add_u32 v8, 12288, v5

    s_cmp_lg_u32 s3, 0
    s_cbranch_scc1 dwg_170

dw_171:
    buffer_load_dword v205, off, s[12:15], 0 offset:160 sc1
    s_waitcnt vmcnt(0)
    v_readfirstlane_b32 s44, v205
    s_sub_u32 s30, s30, 1
    s_cmp_lt_i32 s30, 0
    s_cbranch_scc1 dwd_172
    s_cmp_ge_u32 s44, 1
    s_cbranch_scc1 dwd_172
    s_sleep 6
    s_branch dw_171

dwd_172:
dw_173:
    buffer_load_dword v205, off, s[12:15], 0 offset:176 sc1
    s_waitcnt vmcnt(0)
    v_readfirstlane_b32 s44, v205
    s_sub_u32 s30, s30, 1
    s_cmp_lt_i32 s30, 0
    s_cbranch_scc1 dwd_174
    s_cmp_ge_u32 s44, 1
    s_cbranch_scc1 dwd_174
    s_sleep 6
    s_branch dw_173

dwd_174:
dw_175:
    buffer_load_dword v205, off, s[12:15], 0 offset:180 sc1
    s_waitcnt vmcnt(0)
    v_readfirstlane_b32 s44, v205
    s_sub_u32 s30, s30, 1
    s_cmp_lt_i32 s30, 0
    s_cbranch_scc1 dwd_176
    s_cmp_ge_u32 s44, 1
    s_cbranch_scc1 dwd_176
    s_sleep 6
    s_branch dw_175

dwd_176:
dwg_170:
    s_barrier
    buffer_load_dwordx2 v[184:185], off, s[12:15], 0 offset:176 sc1
    s_waitcnt vmcnt(0)
    v_readfirstlane_b32 s98, v184
    v_readfirstlane_b32 s99, v185
    s_nop 3
    s_and_b32 s98, s98, 2
    s_lshl_b32 s98, s98, 12
    s_and_b32 s99, s99, 2
    s_lshl_b32 s99, s99, 12
    v_add_u32 v187, 16384, v5

    s_add_u32 s48, s99, 0x6280000
    s_mov_b32 s46, 0
    s_add_u32 s47, s39, 0x2800000

f2_loop:
    s_cmp_eq_u32 s46, 1
    s_cbranch_scc1 f2_mm0
    s_cmp_eq_u32 s46, 2
    s_cbranch_scc1 f2_sy0
    s_cmp_ge_u32 s33, 112
    s_cbranch_scc1 f2_gate0

wa_177:
    s_mov_b32 exec_lo, 0x7ffffff
    s_mov_b32 exec_hi, 0
    buffer_load_dwordx4 v[204:207], v9, s[8:11], s35 offen sc1
    s_waitcnt vmcnt(0)

    v_min3_u32 v204, v204, v205, v206
    v_min_u32 v204, v204, v207
    v_cmp_gt_u32 vcc, s34, v204
    s_mov_b64 exec, -1
    s_cbranch_vccz wad_178
    s_sub_u32 s30, s30, 1
    s_cmp_lt_i32 s30, 0
    s_cbranch_scc1 wad_178
    s_sleep 8
    s_branch wa_177

wad_178:
f2_sy0:
    s_cmp_ge_u32 s33, 92
    s_cbranch_scc1 fsd_180
    buffer_load_dword v205, off, s[8:11], s48 sc1
    s_waitcnt vmcnt(0)
fs_179:
    buffer_load_dword v206, off, s[8:11], s48 sc1
    s_waitcnt vmcnt(0)
    v_cmp_ne_u32 vcc, v205, v206
    s_cbranch_vccnz fsd_180
    v_cmp_le_u32 vcc, 63, v206
    s_cbranch_vccnz fsd_180
    s_sub_u32 s30, s30, 1
    s_cmp_ge_i32 s30, 0
    s_cbranch_scc1 fs_179
fsd_180:

    s_branch f2_ld0
f2_gate0:
    s_mov_b32 s45, 0x18200
    s_mov_b32 s60, 0

wf_181:
    s_cmp_ge_u32 s60, s34
    s_cbranch_scc1 wfd_182
    buffer_load_dword v204, off, s[8:11], s45 sc1
    s_waitcnt vmcnt(0)
    v_readfirstlane_b32 s60, v204
    s_nop 3
    s_cmp_ge_u32 s60, s34
    s_cbranch_scc1 wfd_182
    s_sub_u32 s30, s30, 1
    s_cmp_lt_i32 s30, 0
    s_cbranch_scc1 wfd_182
    s_sleep 3
    s_branch wf_181

wfd_182:
    s_sleep 4
f2_ld0:
    buffer_load_dwordx4 v[16:19], v5, s[8:11], s38 offen offset:0 sc1
    buffer_load_dwordx4 v[20:23], v5, s[8:11], s38 offen offset:1024 sc1
    buffer_load_dwordx4 v[24:27], v5, s[8:11], s38 offen offset:2048 sc1
    buffer_load_dwordx4 v[28:31], v5, s[8:11], s38 offen offset:3072 sc1
    buffer_load_dwordx4 v[32:35], v6, s[8:11], s38 offen offset:0 sc1
    buffer_load_dwordx4 v[36:39], v6, s[8:11], s38 offen offset:1024 sc1
    buffer_load_dwordx4 v[40:43], v6, s[8:11], s38 offen offset:2048 sc1
    buffer_load_dwordx4 v[44:47], v6, s[8:11], s38 offen offset:3072 sc1
    buffer_load_dwordx4 v[48:51], v7, s[8:11], s38 offen offset:0 sc1
    buffer_load_dwordx4 v[52:55], v7, s[8:11], s38 offen offset:1024 sc1
    buffer_load_dwordx4 v[56:59], v7, s[8:11], s38 offen offset:2048 sc1
    buffer_load_dwordx4 v[60:63], v7, s[8:11], s38 offen offset:3072 sc1
    buffer_load_dwordx4 v[64:67], v8, s[8:11], s38 offen offset:0 sc1
    buffer_load_dwordx4 v[68:71], v8, s[8:11], s38 offen offset:1024 sc1
    buffer_load_dwordx2 v[208:209], v14, s[8:11], s47 offen sc1
f2_mm0:
    s_and_b32 s40, s34, 1
    s_cmp_ge_u32 s34, 54
    s_cselect_b32 s40, s40, 0
    s_mul_i32 s40, s40, 15360
    s_add_u32 s35, s40, 0x19400
    s_mov_b32 exec_lo, 0x7ffffff
    s_mov_b32 exec_hi, 0
    s_cmp_ge_u32 s34, 56
    s_cbranch_scc1 nf_183
    buffer_load_dwordx4 v[216:219], v9, s[8:11], s35 offen sc1
    s_branch nf_184
nf_183:
    s_mov_b32 s45, 0x18200
    v_mov_b32 v217, 64
    v_mov_b32 v218, 64
    v_mov_b32 v219, 64
    buffer_load_dword v216, v9, s[8:11], s45 offen sc1
nf_184:
    s_mov_b64 exec, -1

    v_mov_b32 v204, 0
    s_waitcnt vmcnt(15)
    v_mfma_f32_16x16x32_bf16 v[128:131], a[0:3], v[16:19], 0
    v_max3_u32 v204, v204, v16, v17
    v_mfma_f32_16x16x32_bf16 v[132:135], a[4:7], v[16:19], 0
    v_max3_u32 v204, v204, v18, v19
    v_mfma_f32_16x16x32_bf16 v[136:139], a[8:11], v[16:19], 0
    v_mfma_f32_16x16x32_bf16 v[140:143], a[12:15], v[16:19], 0
    s_waitcnt vmcnt(14)
    v_mfma_f32_16x16x32_bf16 v[128:131], a[16:19], v[20:23], v[128:131]
    v_max3_u32 v204, v204, v20, v21
    v_mfma_f32_16x16x32_bf16 v[132:135], a[20:23], v[20:23], v[132:135]
    v_max3_u32 v204, v204, v22, v23
    v_mfma_f32_16x16x32_bf16 v[136:139], a[24:27], v[20:23], v[136:139]
    v_mfma_f32_16x16x32_bf16 v[140:143], a[28:31], v[20:23], v[140:143]
    s_waitcnt vmcnt(13)
    v_mfma_f32_16x16x32_bf16 v[128:131], a[32:35], v[24:27], v[128:131]
    v_max3_u32 v204, v204, v24, v25
    v_mfma_f32_16x16x32_bf16 v[132:135], a[36:39], v[24:27], v[132:135]
    v_max3_u32 v204, v204, v26, v27
    v_mfma_f32_16x16x32_bf16 v[136:139], a[40:43], v[24:27], v[136:139]
    v_mfma_f32_16x16x32_bf16 v[140:143], a[44:47], v[24:27], v[140:143]
    s_waitcnt vmcnt(12)
    v_mfma_f32_16x16x32_bf16 v[128:131], a[48:51], v[28:31], v[128:131]
    v_max3_u32 v204, v204, v28, v29
    v_mfma_f32_16x16x32_bf16 v[132:135], a[52:55], v[28:31], v[132:135]
    v_max3_u32 v204, v204, v30, v31
    v_mfma_f32_16x16x32_bf16 v[136:139], a[56:59], v[28:31], v[136:139]
    v_mfma_f32_16x16x32_bf16 v[140:143], a[60:63], v[28:31], v[140:143]
    s_waitcnt vmcnt(11)
    v_mfma_f32_16x16x32_bf16 v[128:131], a[64:67], v[32:35], v[128:131]
    v_max3_u32 v204, v204, v32, v33
    v_mfma_f32_16x16x32_bf16 v[132:135], a[68:71], v[32:35], v[132:135]
    v_max3_u32 v204, v204, v34, v35
    v_mfma_f32_16x16x32_bf16 v[136:139], a[72:75], v[32:35], v[136:139]
    v_mfma_f32_16x16x32_bf16 v[140:143], a[76:79], v[32:35], v[140:143]
    s_waitcnt vmcnt(10)
    v_mfma_f32_16x16x32_bf16 v[128:131], a[80:83], v[36:39], v[128:131]
    v_max3_u32 v204, v204, v36, v37
    v_mfma_f32_16x16x32_bf16 v[132:135], a[84:87], v[36:39], v[132:135]
    v_max3_u32 v204, v204, v38, v39
    v_mfma_f32_16x16x32_bf16 v[136:139], a[88:91], v[36:39], v[136:139]
    v_mfma_f32_16x16x32_bf16 v[140:143], a[92:95], v[36:39], v[140:143]
    s_waitcnt vmcnt(9)
    v_mfma_f32_16x16x32_bf16 v[128:131], a[96:99], v[40:43], v[128:131]
    v_max3_u32 v204, v204, v40, v41
    v_mfma_f32_16x16x32_bf16 v[132:135], a[100:103], v[40:43], v[132:135]
    v_max3_u32 v204, v204, v42, v43
    v_mfma_f32_16x16x32_bf16 v[136:139], a[104:107], v[40:43], v[136:139]
    v_mfma_f32_16x16x32_bf16 v[140:143], a[108:111], v[40:43], v[140:143]
    s_waitcnt vmcnt(8)
    v_mfma_f32_16x16x32_bf16 v[128:131], a[112:115], v[44:47], v[128:131]
    v_max3_u32 v204, v204, v44, v45
    v_mfma_f32_16x16x32_bf16 v[132:135], a[116:119], v[44:47], v[132:135]
    v_max3_u32 v204, v204, v46, v47
    v_mfma_f32_16x16x32_bf16 v[136:139], a[120:123], v[44:47], v[136:139]
    v_mfma_f32_16x16x32_bf16 v[140:143], a[124:127], v[44:47], v[140:143]
    s_waitcnt vmcnt(7)
    v_mfma_f32_16x16x32_bf16 v[128:131], a[128:131], v[48:51], v[128:131]
    v_max3_u32 v204, v204, v48, v49
    v_mfma_f32_16x16x32_bf16 v[132:135], a[132:135], v[48:51], v[132:135]
    v_max3_u32 v204, v204, v50, v51
    v_mfma_f32_16x16x32_bf16 v[136:139], a[136:139], v[48:51], v[136:139]
    v_mfma_f32_16x16x32_bf16 v[140:143], a[140:143], v[48:51], v[140:143]
    s_waitcnt vmcnt(6)
    v_mfma_f32_16x16x32_bf16 v[128:131], a[144:147], v[52:55], v[128:131]
    v_max3_u32 v204, v204, v52, v53
    v_mfma_f32_16x16x32_bf16 v[132:135], a[148:151], v[52:55], v[132:135]
    v_max3_u32 v204, v204, v54, v55
    v_mfma_f32_16x16x32_bf16 v[136:139], a[152:155], v[52:55], v[136:139]
    v_mfma_f32_16x16x32_bf16 v[140:143], a[156:159], v[52:55], v[140:143]
    s_waitcnt vmcnt(5)
    v_mfma_f32_16x16x32_bf16 v[128:131], a[160:163], v[56:59], v[128:131]
    v_max3_u32 v204, v204, v56, v57
    v_mfma_f32_16x16x32_bf16 v[132:135], a[164:167], v[56:59], v[132:135]
    v_max3_u32 v204, v204, v58, v59
    v_mfma_f32_16x16x32_bf16 v[136:139], a[168:171], v[56:59], v[136:139]
    v_mfma_f32_16x16x32_bf16 v[140:143], a[172:175], v[56:59], v[140:143]
    s_waitcnt vmcnt(4)
    v_mfma_f32_16x16x32_bf16 v[128:131], a[176:179], v[60:63], v[128:131]
    v_max3_u32 v204, v204, v60, v61
    v_mfma_f32_16x16x32_bf16 v[132:135], a[180:183], v[60:63], v[132:135]
    v_max3_u32 v204, v204, v62, v63
    v_mfma_f32_16x16x32_bf16 v[136:139], a[184:187], v[60:63], v[136:139]
    v_mfma_f32_16x16x32_bf16 v[140:143], a[188:191], v[60:63], v[140:143]
    s_waitcnt vmcnt(3)
    v_mfma_f32_16x16x32_bf16 v[128:131], a[192:195], v[64:67], v[128:131]
    v_max3_u32 v204, v204, v64, v65
    v_mfma_f32_16x16x32_bf16 v[132:135], a[196:199], v[64:67], v[132:135]
    v_max3_u32 v204, v204, v66, v67
    v_mfma_f32_16x16x32_bf16 v[136:139], a[200:203], v[64:67], v[136:139]
    v_mfma_f32_16x16x32_bf16 v[140:143], a[204:207], v[64:67], v[140:143]
    s_waitcnt vmcnt(2)
    v_mfma_f32_16x16x32_bf16 v[128:131], a[208:211], v[68:71], v[128:131]
    v_max3_u32 v204, v204, v68, v69
    v_mfma_f32_16x16x32_bf16 v[132:135], a[212:215], v[68:71], v[132:135]
    v_max3_u32 v204, v204, v70, v71
    v_mfma_f32_16x16x32_bf16 v[136:139], a[216:219], v[68:71], v[136:139]
    v_mfma_f32_16x16x32_bf16 v[140:143], a[220:223], v[68:71], v[140:143]
    s_waitcnt vmcnt(1)
    v_max3_u32 v204, v204, v208, v209
    v_cmp_eq_u32 vcc, -1, v204

    s_cbranch_vccz pok_185
    s_sub_u32 s30, s30, 1
    s_cmp_lt_i32 s30, 0
    s_cbranch_scc1 pok_185
    s_sleep 3
    s_branch f2_ld0

pok_185:
    s_nop 3
    ds_write_b128 v12, v[128:131] offset:0
    ds_write_b128 v12, v[132:135] offset:4096
    ds_write_b128 v12, v[136:139] offset:8192
    ds_write_b128 v12, v[140:143] offset:12288
    s_add_u32 s38, s38, 110592
    s_add_u32 s47, s47, 40960
    s_add_u32 s34, s34, 1
    s_add_u32 s33, s33, 2
    s_waitcnt vmcnt(0)
    v_min3_u32 v216, v216, v217, v218
    v_min_u32 v216, v216, v219
    s_mov_b32 exec_lo, 0x7ffffff
    s_mov_b32 exec_hi, 0
    v_cmp_gt_u32 vcc, s34, v216
    s_mov_b64 exec, -1
    s_mov_b32 s46, 0
    s_waitcnt lgkmcnt(0)
    s_barrier

    ds_read_b128 v[160:163], v13 offset:0
    ds_read_b128 v[164:167], v13 offset:1024
    ds_read_b128 v[168:171], v13 offset:2048
    ds_read_b128 v[172:175], v13 offset:3072
    s_cbranch_vccnz f2_np0
    s_mov_b32 s46, 2
    s_cmp_lt_u32 s33, 92
    s_cbranch_scc1 f2_np0
    s_mov_b32 s46, 1

    buffer_load_dwordx4 v[72:75], v5, s[8:11], s38 offen offset:0 sc1
    buffer_load_dwordx4 v[76:79], v5, s[8:11], s38 offen offset:1024 sc1
    buffer_load_dwordx4 v[80:83], v5, s[8:11], s38 offen offset:2048 sc1
    buffer_load_dwordx4 v[84:87], v5, s[8:11], s38 offen offset:3072 sc1
    buffer_load_dwordx4 v[88:91], v6, s[8:11], s38 offen offset:0 sc1
    buffer_load_dwordx4 v[92:95], v6, s[8:11], s38 offen offset:1024 sc1
    buffer_load_dwordx4 v[96:99], v6, s[8:11], s38 offen offset:2048 sc1
    buffer_load_dwordx4 v[100:103], v6, s[8:11], s38 offen offset:3072 sc1
    buffer_load_dwordx4 v[104:107], v7, s[8:11], s38 offen offset:0 sc1
    buffer_load_dwordx4 v[108:111], v7, s[8:11], s38 offen offset:1024 sc1
    buffer_load_dwordx4 v[112:115], v7, s[8:11], s38 offen offset:2048 sc1
    buffer_load_dwordx4 v[116:119], v7, s[8:11], s38 offen offset:3072 sc1
    buffer_load_dwordx4 v[120:123], v8, s[8:11], s38 offen offset:0 sc1
    buffer_load_dwordx4 v[124:127], v8, s[8:11], s38 offen offset:1024 sc1
    buffer_load_dwordx2 v[210:211], v14, s[8:11], s47 offen sc1
f2_np0:
    s_waitcnt lgkmcnt(0)
    s_barrier

    v_add_f32 v160, v160, v164
    v_add_f32 v168, v168, v172
    v_add_f32 v161, v161, v165
    v_add_f32 v169, v169, v173
    v_add_f32 v162, v162, v166
    v_add_f32 v170, v170, v174
    v_add_f32 v163, v163, v167
    v_add_f32 v171, v171, v175
    v_add_f32 v160, v160, v168
    v_add_f32 v161, v161, v169
    v_add_f32 v162, v162, v170
    v_add_f32 v163, v163, v171
    v_cvt_pk_bf16_f32 v212, v160, v161
    v_lshlrev_b32 v160, 16, v212
    v_and_b32 v161, 0xffff0000, v212
    v_mul_f32 v160, v160, v200
    v_mul_f32 v161, v161, v201
    v_cvt_pk_bf16_f32 v212, v160, v161
    v_lshlrev_b32 v160, 16, v212
    v_and_b32 v161, 0xffff0000, v212
    v_lshlrev_b32 v212, 16, v208
    v_and_b32 v213, 0xffff0000, v208
    v_add_f32 v160, v160, v212
    v_add_f32 v161, v161, v213
    v_cvt_pk_bf16_f32 v164, v160, v161

    v_cvt_pk_bf16_f32 v212, v162, v163
    v_lshlrev_b32 v162, 16, v212
    v_and_b32 v163, 0xffff0000, v212
    v_mul_f32 v162, v162, v202
    v_mul_f32 v163, v163, v203
    v_cvt_pk_bf16_f32 v212, v162, v163
    v_lshlrev_b32 v162, 16, v212
    v_and_b32 v163, 0xffff0000, v212
    v_lshlrev_b32 v212, 16, v209
    v_and_b32 v213, 0xffff0000, v209
    v_add_f32 v162, v162, v212
    v_add_f32 v163, v163, v213
    v_cvt_pk_bf16_f32 v165, v162, v163

    buffer_store_dwordx2 v[164:165], v14, s[20:23], s39 offen
    s_add_u32 s29, s29, 1
    s_add_u32 s39, s39, 40960
    s_cmp_ge_u32 s33, 128
    s_cbranch_scc1 f2_end

    s_cmp_eq_u32 s46, 1
    s_cbranch_scc1 f2_mm1
    s_cmp_eq_u32 s46, 2
    s_cbranch_scc1 f2_sy1
    s_cmp_ge_u32 s33, 112
    s_cbranch_scc1 f2_gate1

wa_186:
    s_mov_b32 exec_lo, 0x7ffffff
    s_mov_b32 exec_hi, 0
    buffer_load_dwordx4 v[204:207], v9, s[8:11], s35 offen sc1
    s_waitcnt vmcnt(0)

    v_min3_u32 v204, v204, v205, v206
    v_min_u32 v204, v204, v207
    v_cmp_gt_u32 vcc, s34, v204
    s_mov_b64 exec, -1
    s_cbranch_vccz wad_187
    s_sub_u32 s30, s30, 1
    s_cmp_lt_i32 s30, 0
    s_cbranch_scc1 wad_187
    s_sleep 8
    s_branch wa_186

wad_187:
f2_sy1:
    s_cmp_ge_u32 s33, 92
    s_cbranch_scc1 fsd_189
    buffer_load_dword v205, off, s[8:11], s48 sc1
    s_waitcnt vmcnt(0)
fs_188:
    buffer_load_dword v206, off, s[8:11], s48 sc1
    s_waitcnt vmcnt(0)
    v_cmp_ne_u32 vcc, v205, v206
    s_cbranch_vccnz fsd_189
    v_cmp_le_u32 vcc, 63, v206
    s_cbranch_vccnz fsd_189
    s_sub_u32 s30, s30, 1
    s_cmp_ge_i32 s30, 0
    s_cbranch_scc1 fs_188
fsd_189:

    s_branch f2_ld1
f2_gate1:
    s_mov_b32 s45, 0x18200
    s_mov_b32 s60, 0

wf_190:
    s_cmp_ge_u32 s60, s34
    s_cbranch_scc1 wfd_191
    buffer_load_dword v204, off, s[8:11], s45 sc1
    s_waitcnt vmcnt(0)
    v_readfirstlane_b32 s60, v204
    s_nop 3
    s_cmp_ge_u32 s60, s34
    s_cbranch_scc1 wfd_191
    s_sub_u32 s30, s30, 1
    s_cmp_lt_i32 s30, 0
    s_cbranch_scc1 wfd_191
    s_sleep 3
    s_branch wf_190

wfd_191:
    s_sleep 4
f2_ld1:
    buffer_load_dwordx4 v[72:75], v5, s[8:11], s38 offen offset:0 sc1
    buffer_load_dwordx4 v[76:79], v5, s[8:11], s38 offen offset:1024 sc1
    buffer_load_dwordx4 v[80:83], v5, s[8:11], s38 offen offset:2048 sc1
    buffer_load_dwordx4 v[84:87], v5, s[8:11], s38 offen offset:3072 sc1
    buffer_load_dwordx4 v[88:91], v6, s[8:11], s38 offen offset:0 sc1
    buffer_load_dwordx4 v[92:95], v6, s[8:11], s38 offen offset:1024 sc1
    buffer_load_dwordx4 v[96:99], v6, s[8:11], s38 offen offset:2048 sc1
    buffer_load_dwordx4 v[100:103], v6, s[8:11], s38 offen offset:3072 sc1
    buffer_load_dwordx4 v[104:107], v7, s[8:11], s38 offen offset:0 sc1
    buffer_load_dwordx4 v[108:111], v7, s[8:11], s38 offen offset:1024 sc1
    buffer_load_dwordx4 v[112:115], v7, s[8:11], s38 offen offset:2048 sc1
    buffer_load_dwordx4 v[116:119], v7, s[8:11], s38 offen offset:3072 sc1
    buffer_load_dwordx4 v[120:123], v8, s[8:11], s38 offen offset:0 sc1
    buffer_load_dwordx4 v[124:127], v8, s[8:11], s38 offen offset:1024 sc1
    buffer_load_dwordx2 v[210:211], v14, s[8:11], s47 offen sc1
f2_mm1:
    s_and_b32 s40, s34, 1
    s_cmp_ge_u32 s34, 54
    s_cselect_b32 s40, s40, 0
    s_mul_i32 s40, s40, 15360
    s_add_u32 s35, s40, 0x19400
    s_mov_b32 exec_lo, 0x7ffffff
    s_mov_b32 exec_hi, 0
    s_cmp_ge_u32 s34, 56
    s_cbranch_scc1 nf_192
    buffer_load_dwordx4 v[216:219], v9, s[8:11], s35 offen sc1
    s_branch nf_193
nf_192:
    s_mov_b32 s45, 0x18200
    v_mov_b32 v217, 64
    v_mov_b32 v218, 64
    v_mov_b32 v219, 64
    buffer_load_dword v216, v9, s[8:11], s45 offen sc1
nf_193:
    s_mov_b64 exec, -1

    v_mov_b32 v204, 0
    s_waitcnt vmcnt(15)
    v_mfma_f32_16x16x32_bf16 v[128:131], a[0:3], v[72:75], 0
    v_max3_u32 v204, v204, v72, v73
    v_mfma_f32_16x16x32_bf16 v[132:135], a[4:7], v[72:75], 0
    v_max3_u32 v204, v204, v74, v75
    v_mfma_f32_16x16x32_bf16 v[136:139], a[8:11], v[72:75], 0
    v_mfma_f32_16x16x32_bf16 v[140:143], a[12:15], v[72:75], 0
    s_waitcnt vmcnt(14)
    v_mfma_f32_16x16x32_bf16 v[128:131], a[16:19], v[76:79], v[128:131]
    v_max3_u32 v204, v204, v76, v77
    v_mfma_f32_16x16x32_bf16 v[132:135], a[20:23], v[76:79], v[132:135]
    v_max3_u32 v204, v204, v78, v79
    v_mfma_f32_16x16x32_bf16 v[136:139], a[24:27], v[76:79], v[136:139]
    v_mfma_f32_16x16x32_bf16 v[140:143], a[28:31], v[76:79], v[140:143]
    s_waitcnt vmcnt(13)
    v_mfma_f32_16x16x32_bf16 v[128:131], a[32:35], v[80:83], v[128:131]
    v_max3_u32 v204, v204, v80, v81
    v_mfma_f32_16x16x32_bf16 v[132:135], a[36:39], v[80:83], v[132:135]
    v_max3_u32 v204, v204, v82, v83
    v_mfma_f32_16x16x32_bf16 v[136:139], a[40:43], v[80:83], v[136:139]
    v_mfma_f32_16x16x32_bf16 v[140:143], a[44:47], v[80:83], v[140:143]
    s_waitcnt vmcnt(12)
    v_mfma_f32_16x16x32_bf16 v[128:131], a[48:51], v[84:87], v[128:131]
    v_max3_u32 v204, v204, v84, v85
    v_mfma_f32_16x16x32_bf16 v[132:135], a[52:55], v[84:87], v[132:135]
    v_max3_u32 v204, v204, v86, v87
    v_mfma_f32_16x16x32_bf16 v[136:139], a[56:59], v[84:87], v[136:139]
    v_mfma_f32_16x16x32_bf16 v[140:143], a[60:63], v[84:87], v[140:143]
    s_waitcnt vmcnt(11)
    v_mfma_f32_16x16x32_bf16 v[128:131], a[64:67], v[88:91], v[128:131]
    v_max3_u32 v204, v204, v88, v89
    v_mfma_f32_16x16x32_bf16 v[132:135], a[68:71], v[88:91], v[132:135]
    v_max3_u32 v204, v204, v90, v91
    v_mfma_f32_16x16x32_bf16 v[136:139], a[72:75], v[88:91], v[136:139]
    v_mfma_f32_16x16x32_bf16 v[140:143], a[76:79], v[88:91], v[140:143]
    s_waitcnt vmcnt(10)
    v_mfma_f32_16x16x32_bf16 v[128:131], a[80:83], v[92:95], v[128:131]
    v_max3_u32 v204, v204, v92, v93
    v_mfma_f32_16x16x32_bf16 v[132:135], a[84:87], v[92:95], v[132:135]
    v_max3_u32 v204, v204, v94, v95
    v_mfma_f32_16x16x32_bf16 v[136:139], a[88:91], v[92:95], v[136:139]
    v_mfma_f32_16x16x32_bf16 v[140:143], a[92:95], v[92:95], v[140:143]
    s_waitcnt vmcnt(9)
    v_mfma_f32_16x16x32_bf16 v[128:131], a[96:99], v[96:99], v[128:131]
    v_max3_u32 v204, v204, v96, v97
    v_mfma_f32_16x16x32_bf16 v[132:135], a[100:103], v[96:99], v[132:135]
    v_max3_u32 v204, v204, v98, v99
    v_mfma_f32_16x16x32_bf16 v[136:139], a[104:107], v[96:99], v[136:139]
    v_mfma_f32_16x16x32_bf16 v[140:143], a[108:111], v[96:99], v[140:143]
    s_waitcnt vmcnt(8)
    v_mfma_f32_16x16x32_bf16 v[128:131], a[112:115], v[100:103], v[128:131]
    v_max3_u32 v204, v204, v100, v101
    v_mfma_f32_16x16x32_bf16 v[132:135], a[116:119], v[100:103], v[132:135]
    v_max3_u32 v204, v204, v102, v103
    v_mfma_f32_16x16x32_bf16 v[136:139], a[120:123], v[100:103], v[136:139]
    v_mfma_f32_16x16x32_bf16 v[140:143], a[124:127], v[100:103], v[140:143]
    s_waitcnt vmcnt(7)
    v_mfma_f32_16x16x32_bf16 v[128:131], a[128:131], v[104:107], v[128:131]
    v_max3_u32 v204, v204, v104, v105
    v_mfma_f32_16x16x32_bf16 v[132:135], a[132:135], v[104:107], v[132:135]
    v_max3_u32 v204, v204, v106, v107
    v_mfma_f32_16x16x32_bf16 v[136:139], a[136:139], v[104:107], v[136:139]
    v_mfma_f32_16x16x32_bf16 v[140:143], a[140:143], v[104:107], v[140:143]
    s_waitcnt vmcnt(6)
    v_mfma_f32_16x16x32_bf16 v[128:131], a[144:147], v[108:111], v[128:131]
    v_max3_u32 v204, v204, v108, v109
    v_mfma_f32_16x16x32_bf16 v[132:135], a[148:151], v[108:111], v[132:135]
    v_max3_u32 v204, v204, v110, v111
    v_mfma_f32_16x16x32_bf16 v[136:139], a[152:155], v[108:111], v[136:139]
    v_mfma_f32_16x16x32_bf16 v[140:143], a[156:159], v[108:111], v[140:143]
    s_waitcnt vmcnt(5)
    v_mfma_f32_16x16x32_bf16 v[128:131], a[160:163], v[112:115], v[128:131]
    v_max3_u32 v204, v204, v112, v113
    v_mfma_f32_16x16x32_bf16 v[132:135], a[164:167], v[112:115], v[132:135]
    v_max3_u32 v204, v204, v114, v115
    v_mfma_f32_16x16x32_bf16 v[136:139], a[168:171], v[112:115], v[136:139]
    v_mfma_f32_16x16x32_bf16 v[140:143], a[172:175], v[112:115], v[140:143]
    s_waitcnt vmcnt(4)
    v_mfma_f32_16x16x32_bf16 v[128:131], a[176:179], v[116:119], v[128:131]
    v_max3_u32 v204, v204, v116, v117
    v_mfma_f32_16x16x32_bf16 v[132:135], a[180:183], v[116:119], v[132:135]
    v_max3_u32 v204, v204, v118, v119
    v_mfma_f32_16x16x32_bf16 v[136:139], a[184:187], v[116:119], v[136:139]
    v_mfma_f32_16x16x32_bf16 v[140:143], a[188:191], v[116:119], v[140:143]
    s_waitcnt vmcnt(3)
    v_mfma_f32_16x16x32_bf16 v[128:131], a[192:195], v[120:123], v[128:131]
    v_max3_u32 v204, v204, v120, v121
    v_mfma_f32_16x16x32_bf16 v[132:135], a[196:199], v[120:123], v[132:135]
    v_max3_u32 v204, v204, v122, v123
    v_mfma_f32_16x16x32_bf16 v[136:139], a[200:203], v[120:123], v[136:139]
    v_mfma_f32_16x16x32_bf16 v[140:143], a[204:207], v[120:123], v[140:143]
    s_waitcnt vmcnt(2)
    v_mfma_f32_16x16x32_bf16 v[128:131], a[208:211], v[124:127], v[128:131]
    v_max3_u32 v204, v204, v124, v125
    v_mfma_f32_16x16x32_bf16 v[132:135], a[212:215], v[124:127], v[132:135]
    v_max3_u32 v204, v204, v126, v127
    v_mfma_f32_16x16x32_bf16 v[136:139], a[216:219], v[124:127], v[136:139]
    v_mfma_f32_16x16x32_bf16 v[140:143], a[220:223], v[124:127], v[140:143]
    s_waitcnt vmcnt(1)
    v_max3_u32 v204, v204, v210, v211
    v_cmp_eq_u32 vcc, -1, v204

    s_cbranch_vccz pok_194
    s_sub_u32 s30, s30, 1
    s_cmp_lt_i32 s30, 0
    s_cbranch_scc1 pok_194
    s_sleep 3
    s_branch f2_ld1

pok_194:
    s_nop 3
    ds_write_b128 v12, v[128:131] offset:0
    ds_write_b128 v12, v[132:135] offset:4096
    ds_write_b128 v12, v[136:139] offset:8192
    ds_write_b128 v12, v[140:143] offset:12288
    s_add_u32 s38, s38, 110592
    s_add_u32 s47, s47, 40960
    s_add_u32 s34, s34, 1
    s_add_u32 s33, s33, 2
    s_waitcnt vmcnt(0)
    v_min3_u32 v216, v216, v217, v218
    v_min_u32 v216, v216, v219
    s_mov_b32 exec_lo, 0x7ffffff
    s_mov_b32 exec_hi, 0
    v_cmp_gt_u32 vcc, s34, v216
    s_mov_b64 exec, -1
    s_mov_b32 s46, 0
    s_waitcnt lgkmcnt(0)
    s_barrier

    ds_read_b128 v[160:163], v13 offset:0
    ds_read_b128 v[164:167], v13 offset:1024
    ds_read_b128 v[168:171], v13 offset:2048
    ds_read_b128 v[172:175], v13 offset:3072
    s_cbranch_vccnz f2_np1
    s_mov_b32 s46, 2
    s_cmp_lt_u32 s33, 92
    s_cbranch_scc1 f2_np1
    s_mov_b32 s46, 1

    buffer_load_dwordx4 v[16:19], v5, s[8:11], s38 offen offset:0 sc1
    buffer_load_dwordx4 v[20:23], v5, s[8:11], s38 offen offset:1024 sc1
    buffer_load_dwordx4 v[24:27], v5, s[8:11], s38 offen offset:2048 sc1
    buffer_load_dwordx4 v[28:31], v5, s[8:11], s38 offen offset:3072 sc1
    buffer_load_dwordx4 v[32:35], v6, s[8:11], s38 offen offset:0 sc1
    buffer_load_dwordx4 v[36:39], v6, s[8:11], s38 offen offset:1024 sc1
    buffer_load_dwordx4 v[40:43], v6, s[8:11], s38 offen offset:2048 sc1
    buffer_load_dwordx4 v[44:47], v6, s[8:11], s38 offen offset:3072 sc1
    buffer_load_dwordx4 v[48:51], v7, s[8:11], s38 offen offset:0 sc1
    buffer_load_dwordx4 v[52:55], v7, s[8:11], s38 offen offset:1024 sc1
    buffer_load_dwordx4 v[56:59], v7, s[8:11], s38 offen offset:2048 sc1
    buffer_load_dwordx4 v[60:63], v7, s[8:11], s38 offen offset:3072 sc1
    buffer_load_dwordx4 v[64:67], v8, s[8:11], s38 offen offset:0 sc1
    buffer_load_dwordx4 v[68:71], v8, s[8:11], s38 offen offset:1024 sc1
    buffer_load_dwordx2 v[208:209], v14, s[8:11], s47 offen sc1
f2_np1:
    s_waitcnt lgkmcnt(0)
    s_barrier

    v_add_f32 v160, v160, v164
    v_add_f32 v168, v168, v172
    v_add_f32 v161, v161, v165
    v_add_f32 v169, v169, v173
    v_add_f32 v162, v162, v166
    v_add_f32 v170, v170, v174
    v_add_f32 v163, v163, v167
    v_add_f32 v171, v171, v175
    v_add_f32 v160, v160, v168
    v_add_f32 v161, v161, v169
    v_add_f32 v162, v162, v170
    v_add_f32 v163, v163, v171
    v_cvt_pk_bf16_f32 v212, v160, v161
    v_lshlrev_b32 v160, 16, v212
    v_and_b32 v161, 0xffff0000, v212
    v_mul_f32 v160, v160, v200
    v_mul_f32 v161, v161, v201
    v_cvt_pk_bf16_f32 v212, v160, v161
    v_lshlrev_b32 v160, 16, v212
    v_and_b32 v161, 0xffff0000, v212
    v_lshlrev_b32 v212, 16, v210
    v_and_b32 v213, 0xffff0000, v210
    v_add_f32 v160, v160, v212
    v_add_f32 v161, v161, v213
    v_cvt_pk_bf16_f32 v164, v160, v161

    v_cvt_pk_bf16_f32 v212, v162, v163
    v_lshlrev_b32 v162, 16, v212
    v_and_b32 v163, 0xffff0000, v212
    v_mul_f32 v162, v162, v202
    v_mul_f32 v163, v163, v203
    v_cvt_pk_bf16_f32 v212, v162, v163
    v_lshlrev_b32 v162, 16, v212
    v_and_b32 v163, 0xffff0000, v212
    v_lshlrev_b32 v212, 16, v211
    v_and_b32 v213, 0xffff0000, v211
    v_add_f32 v162, v162, v212
    v_add_f32 v163, v163, v213
    v_cvt_pk_bf16_f32 v165, v162, v163

    buffer_store_dwordx2 v[164:165], v14, s[20:23], s39 offen
    s_add_u32 s29, s29, 1
    s_add_u32 s39, s39, 40960
    s_cmp_ge_u32 s33, 128
    s_cbranch_scc1 f2_end

    s_branch f2_loop
f2_end:
    s_endpgm
r_end:
    s_endpgm
r_code_end:
.section .rodata,"a"
.p2align 6
.amdhsa_kernel adaLN_cond__memory_aug_recurrent_mem_tr__swiglu_ffn__prompt_kernel
  .amdhsa_next_free_vgpr 512
  .amdhsa_next_free_sgpr 102
  .amdhsa_accum_offset 256
  .amdhsa_group_segment_fixed_size 0
  .amdhsa_kernarg_size 128
  .amdhsa_user_sgpr_count 2
  .amdhsa_user_sgpr_kernarg_segment_ptr 1
  .amdhsa_system_sgpr_workgroup_id_x 1
  .amdhsa_float_denorm_mode_32 3
.end_amdhsa_kernel
```
